```python
import torch

def _softmax(x, axis=-1):
    return torch.softmax(x, dim=axis)

def _gelu(x):
    return torch.nn.functional.gelu(x, approximate='tanh')

def _silu(x):
    return torch.nn.functional.silu(x)

def _sigmoid(x):
    return torch.sigmoid(x)

def _layernorm(x, axis=-1, eps=1e-05):
    m = x.mean(dim=axis, keepdim=True)
    v = x.var(dim=axis, keepdim=True, unbiased=False)
    return (x - m) / torch.sqrt(v + eps)

def _scatter_add(tgt, idx, src, axis=0):
    return tgt.clone().index_add_(axis, idx, src)

def _segment_sum(src, seg, n):
    out = torch.zeros((n,) + src.shape[1:], dtype=src.dtype)
    return out.index_add_(0, seg, src)

def _pad(x, pw):
    flat = tuple((v for pair in reversed(pw) for v in pair))
    return torch.nn.functional.pad(x, flat)
kernel_name = 'gated_mix__ssm_conv_s4__memory_aug_recurrent_mem_tr__prompt'

def setup_inputs():

    _w = lambda a: (lambda t: t.to(torch.bfloat16) if t.is_floating_point() else t)(torch.as_tensor(a))

    def _A_setup():
        B, L, D, N = (1, 2048, 576, 128)
        A_re = -(lambda _x: torch.exp(torch.as_tensor(_x)))((lambda *s: torch.randn(*s, dtype=torch.bfloat16) * 6.4)(D, N))
        A_im = torch.pi * (lambda *s: torch.randn(*s, dtype=torch.bfloat16) * 0.05)(D, N)
        B_re = (lambda *s: torch.randn(*s, dtype=torch.bfloat16) * 0.1)(D, N)
        B_im = (lambda *s: torch.randn(*s, dtype=torch.bfloat16) * 0.1)(D, N)
        C_re = (lambda *s: torch.randn(*s, dtype=torch.bfloat16) * 0.1)(D, N)
        C_im = (lambda *s: torch.randn(*s, dtype=torch.bfloat16) * 0.1)(D, N)
        log_dt = (lambda *s: torch.randn(*s, dtype=torch.bfloat16) * 0.05)(D) * 0.5 - 4.0
        Dskip = (lambda *s: torch.randn(*s, dtype=torch.bfloat16) * 0.05)(D)
        return {'u': _w((lambda *s: torch.randn(*s, dtype=torch.bfloat16) * 0.05)(B, L, D)), 'A_re': _w(A_re), 'A_im': _w(A_im), 'B_re': _w(B_re), 'B_im': _w(B_im), 'C_re': _w(C_re), 'C_im': _w(C_im), 'log_dt': _w(log_dt), 'Dskip': _w(Dskip)}
    _A_in = _A_setup()

    def _B_setup():
        B, S, Dm = (1, 2048, 576)
        H, Dh = (32, 128)
        M, seg = (8, 32)
        seg = min(seg, S)
        S = S // seg * seg
        return {'x': _w((lambda *s: torch.randn(*s, dtype=torch.bfloat16) * 0.05)(B, S, Dm)), 'mem0': _w((lambda *s: torch.randn(*s, dtype=torch.bfloat16) * 0.4)(B, M, Dm)), 'Wq': _w((lambda *s: torch.randn(*s, dtype=torch.bfloat16) * 6.4)(Dm, H, Dh) * Dm ** (-0.5)), 'Wk': _w((lambda *s: torch.randn(*s, dtype=torch.bfloat16) * 6.4)(Dm, H, Dh) * Dm ** (-0.5)), 'Wv': _w((lambda *s: torch.randn(*s, dtype=torch.bfloat16) * 0.4)(Dm, H, Dh) * Dm ** (-0.5)), 'Wo': _w((lambda *s: torch.randn(*s, dtype=torch.bfloat16) * 0.4)(H, Dh, Dm) * (H * Dh) ** (-0.5)), 'seg_len': seg}
    _B_in = _B_setup()
    return {'A_u': _A_in['u'], 'A_A_re': _A_in['A_re'], 'A_A_im': _A_in['A_im'], 'A_B_re': _A_in['B_re'], 'A_B_im': _A_in['B_im'], 'A_C_re': _A_in['C_re'], 'A_C_im': _A_in['C_im'], 'A_log_dt': _A_in['log_dt'], 'A_Dskip': _A_in['Dskip'], 'B_x': _B_in['x'], 'B_mem0': _B_in['mem0'], 'B_Wq': _B_in['Wq'], 'B_Wk': _B_in['Wk'], 'B_Wv': _B_in['Wv'], 'B_Wo': _B_in['Wo'], 'B_seg_len': _B_in['seg_len'], 'gate_w': _w((lambda *s: torch.randn(*s, dtype=torch.bfloat16) * 0.05)(576) * 16.0)}

def reference(A_u, A_A_re, A_A_im, A_B_re, A_B_im, A_C_re, A_C_im, A_log_dt, A_Dskip, B_x, B_mem0, B_Wq, B_Wk, B_Wv, B_Wo, B_seg_len, gate_w):

    def _A_ref(u, A_re, A_im, B_re, B_im, C_re, C_im, log_dt, Dskip):
        Bsz, L, D = u.shape
        dt = torch.exp(log_dt)[:, None]
        A = A_re + 1j * A_im
        Bc = B_re + 1j * B_im
        Cc = C_re + 1j * C_im
        logdA = dt * A
        dB = dt * Bc
        l = (lambda x, dt: x.to(dt))(torch.arange(L), A_re.dtype)
        P = torch.exp(logdA[:, :, None] * l[None, None, :])
        K = torch.einsum('dn,dnl,dn->dl', Cc, P, dB).real
        L2 = 2 * L
        Kp = _pad(K, ((0, 0), (0, L)))
        up = (lambda x, *d: x.permute(*d))(u, 0, 2, 1)
        up = _pad(up, ((0, 0), (0, 0), (0, L)))
        Kf = (lambda x, axes=(-2, -1): torch.fft.rfft2(x.float(), dim=axes))(Kp[:, None, :], axes=(-2, -1))
        Uf = (lambda x, axes=(-2, -1): torch.fft.rfft2(x.float(), dim=axes))(up[:, :, None, :], axes=(-2, -1))
        Yf = Uf * Kf[None, :, :, :]
        y = (lambda x, s, axes=(-2, -1): torch.fft.irfft2(x, s=s, dim=axes).to(torch.bfloat16))(Yf, (1, L2), axes=(-2, -1))[:, :, 0, :L]
        y = (lambda x, *d: x.permute(*d))(y, 0, 2, 1) + u * Dskip[None, None, :]
        return y

    def _B_ref(x, mem0, Wq, Wk, Wv, Wo, seg_len):
        B, S, Dm = x.shape
        H, Dh = (Wq.shape[1], Wq.shape[2])
        M = mem0.shape[1]
        scale = Dh ** (-0.5)
        n_seg = S // seg_len
        L = M + seg_len
        idx = torch.arange(L)
        mask = (idx[:, None] < M) | (idx[:, None] >= idx[None, :])
        mem = mem0
        outs = []
        for s in range(n_seg):
            xs = x[:, s * seg_len:(s + 1) * seg_len, :].clone()
            h = torch.concatenate([mem, xs], axis=1)
            q = torch.einsum('btd,dhe->bhte', h, Wq)
            k = torch.einsum('btd,dhe->bhte', h, Wk)
            v = torch.einsum('btd,dhe->bhte', h, Wv)
            scores = torch.einsum('bhqe,bhke->bhqk', q, k) * scale
            scores = torch.where(mask[None, None], scores, -1000000000.0)
            p = _softmax(scores, axis=-1)
            o = torch.einsum('bhqk,bhke->bhqe', p, v)
            o = torch.einsum('bhte,hed->btd', o, Wo)
            mem = o[:, :M, :].clone()
            outs.append(o[:, M:, :])
        return torch.concatenate(outs, axis=1)
    x = A_u
    g = _sigmoid((x * gate_w).sum(-1, keepdims=True))
    a = _A_ref(x, A_A_re, A_A_im, A_B_re, A_B_im, A_C_re, A_C_im, A_log_dt, A_Dskip)
    b = _B_ref(x, B_mem0, B_Wq, B_Wk, B_Wv, B_Wo, B_seg_len)
    return g * a + (1 - g) * b
```

```asm
; @launch kernel=mega_kernel grid=(256,1,1) block=(256,1,1) lds=163840
.amdgcn_target "amdgcn-amd-amdhsa--gfx950"
.text
.globl mega_kernel
.p2align 8
.type mega_kernel,@function
mega_kernel:
    s_cmp_ge_u32 s2, 256
    s_cbranch_scc1 L_exit
    s_load_dwordx2 s[4:5], s[0:1], 144
    s_load_dwordx2 s[26:27], s[0:1], 152
    s_getreg_b32 s3, hwreg(HW_REG_XCC_ID, 0, 4)
    s_waitcnt lgkmcnt(0)
    s_add_u32 s26, s26, 61865984
    s_addc_u32 s27, s27, 0
    s_cmp_lg_u32 s2, 1
    s_cbranch_scc1 L_noinit
    v_lshlrev_b32 v1, 4, v0
    v_mov_b32 v4, 0
    v_mov_b32 v5, 0
    v_mov_b32 v6, 0
    v_mov_b32 v7, 0
    global_store_dwordx4 v1, v[4:7], s[26:27] sc1
    v_add_u32 v1, 4096, v1
    global_store_dwordx4 v1, v[4:7], s[26:27] sc1
    v_add_u32 v1, 4096, v1
    global_store_dwordx4 v1, v[4:7], s[26:27] sc1
    v_add_u32 v1, 4096, v1
    global_store_dwordx4 v1, v[4:7], s[26:27] sc1
    v_add_u32 v1, 4096, v1
    global_store_dwordx4 v1, v[4:7], s[26:27] sc1
    v_add_u32 v1, 4096, v1
    global_store_dwordx4 v1, v[4:7], s[26:27] sc1
    v_add_u32 v1, 4096, v1
    global_store_dwordx4 v1, v[4:7], s[26:27] sc1
    v_add_u32 v1, 4096, v1
    global_store_dwordx4 v1, v[4:7], s[26:27] sc1
    v_add_u32 v1, 4096, v1
    global_store_dwordx4 v1, v[4:7], s[26:27] sc1
    v_add_u32 v1, 4096, v1
    global_store_dwordx4 v1, v[4:7], s[26:27] sc1
    v_add_u32 v1, 4096, v1
    global_store_dwordx4 v1, v[4:7], s[26:27] sc1
    v_add_u32 v1, 4096, v1
    s_waitcnt vmcnt(0)
    s_barrier
    v_mov_b32 v2, 1
    v_cmp_eq_u32 vcc, 0, v0
    s_nop 0
    s_and_saveexec_b64 s[6:7], vcc
    s_cbranch_execz L_skipin
    global_atomic_add v4, v2, s[4:5] offset:20
L_skipin:
    s_mov_b64 exec, -1
L_noinit:
    s_add_u32 s19, s3, 6
    s_cmp_ge_u32 s19, 7
    s_cselect_b32 s12, 7, 0
    s_sub_u32 s19, s19, s12
    s_cmp_ge_u32 s19, 7
    s_cselect_b32 s19, 0, s19
    s_mov_b32 s20, 0
    s_lshr_b32 s21, s2, 3
    s_and_b32 s21, s21, 1
    s_mov_b32 s18, 32
    s_cmp_lg_u32 s3, 0
    s_cbranch_scc1 L_arrive
    v_mov_b32 v1, 0
    v_mov_b32 v2, 1
    v_cmp_eq_u32 vcc, 0, v0
    s_nop 0
    s_and_saveexec_b64 s[6:7], vcc
    s_cbranch_execz L_skipat
    global_atomic_add v3, v1, v2, s[4:5] offset:0 sc0
    s_waitcnt vmcnt(0)
    ds_write_b32 v1, v3
    s_waitcnt lgkmcnt(0)
L_skipat:
    s_mov_b64 exec, -1
    s_barrier
    ds_read_b32 v3, v1
    s_waitcnt lgkmcnt(0)
    v_readfirstlane_b32 s18, v3
    s_barrier
L_arrive:
    v_mov_b32 v1, 0
    v_mov_b32 v2, 1
    v_cmp_eq_u32 vcc, 0, v0
    s_nop 0
    s_and_saveexec_b64 s[6:7], vcc
    s_cbranch_execz L_skipar
    global_atomic_add v1, v2, s[4:5] offset:8
L_skipar:
    s_mov_b64 exec, -1
    s_mov_b32 s23, 1
    s_cmp_lt_u32 s18, 32
    s_cbranch_scc1 L_chain
    s_mov_b32 s24, 0
L_fetch:
    s_waitcnt vmcnt(0) lgkmcnt(0)
    s_barrier
    s_cmp_lt_u32 s20, 7
    s_cbranch_scc1 L_fetch2
    s_cmp_lg_u32 s24, 0
    s_cbranch_scc1 L_fetch2
    s_mov_b32 s24, 1
    v_mov_b32 v1, 0
L_rolechk:
    global_load_dwordx4 v[4:7], v1, s[4:5] sc1
    global_load_dword v8, v1, s[4:5] offset:20 sc1
    s_waitcnt vmcnt(0)
    v_readfirstlane_b32 s12, v4
    v_readfirstlane_b32 s13, v6
    v_readfirstlane_b32 s14, v8
    s_nop 0
    s_cmp_eq_u32 s14, 0
    s_cbranch_scc1 L_rolechk
    s_cmp_ge_u32 s12, 32
    s_cbranch_scc1 L_rolebar
    s_cmp_ge_u32 s13, 256
    s_cbranch_scc1 L_rolebar
    s_sleep 8
    s_branch L_rolechk
L_rolebar:
    s_barrier
    v_mov_b32 v2, 1
    v_cmp_eq_u32 vcc, 0, v0
    s_nop 0
    s_and_saveexec_b64 s[6:7], vcc
    s_cbranch_execz L_skiprc
    global_load_dword v3, v1, s[4:5] offset:0 sc1
    s_waitcnt vmcnt(0)
    v_cmp_gt_u32 vcc, 32, v3
    s_cbranch_vccz L_rcw
    global_atomic_add v3, v1, v2, s[4:5] offset:0 sc0
    s_waitcnt vmcnt(0)
L_rcw:
    ds_write_b32 v1, v3
    s_waitcnt lgkmcnt(0)
L_skiprc:
    s_mov_b64 exec, -1
    s_barrier
    ds_read_b32 v3, v1
    s_waitcnt lgkmcnt(0)
    v_readfirstlane_b32 s18, v3
    s_barrier
    s_mov_b32 s23, 257
    s_cmp_lt_u32 s18, 32
    s_cbranch_scc1 L_chain
L_fetch2:
    s_lshl_b32 s12, s19, 2
    s_add_u32 s12, s12, 208
    s_cmp_lt_u32 s20, 7
    s_cselect_b32 s22, 1, 0
    s_cmp_lg_u32 s21, 0
    s_cselect_b32 s22, 0, s22
    s_mov_b32 s21, 0
    s_cmp_lg_u32 s22, 0
    s_cselect_b32 s12, s12, 4
    v_mov_b32 v1, 0
    v_mov_b32 v2, 1
    v_mov_b32 v4, s12
    v_cmp_eq_u32 vcc, 0, v0
    s_nop 0
    s_and_saveexec_b64 s[6:7], vcc
    s_cbranch_execz L_skipf
    global_atomic_add v3, v4, v2, s[4:5] sc0
    s_waitcnt vmcnt(0)
    ds_write_b32 v1, v3
    s_waitcnt lgkmcnt(0)
L_skipf:
    s_mov_b64 exec, -1
    s_barrier
    ds_read_b32 v3, v1
    s_waitcnt lgkmcnt(0)
    v_readfirstlane_b32 s8, v3
    s_barrier
    s_cmp_lg_u32 s22, 0
    s_cbranch_scc1 L_qkv
    s_cmp_ge_u32 s8, 1208
    s_cbranch_scc1 L_wexit
    s_cmp_lt_u32 s8, 288
    s_cbranch_scc1 L_s4
    s_cmp_lt_u32 s8, 352
    s_cbranch_scc1 L_gate
    s_cmp_lt_u32 s8, 968
    s_cbranch_scc1 L_ao
    s_branch L_sp
L_fetch_r:
    s_mov_b64 exec, -1
    s_branch L_fetch
L_qkv:
    s_mov_b32 s13, 16384
    s_cmp_lt_u32 s19, 4
    s_cselect_b32 s12, 5, 4
    s_cselect_b32 s13, 13108, s13
    s_lshl_b32 s14, s12, 4
    s_cmp_lt_u32 s8, s14
    s_cbranch_scc1 L_qkv_go
    s_add_u32 s20, s20, 1
    s_add_u32 s19, s19, 1
    s_cmp_ge_u32 s19, 7
    s_cselect_b32 s19, 0, s19
    s_branch L_fetch
L_qkv_go:
    s_mul_i32 s9, s8, s13
    s_lshr_b32 s9, s9, 16
    s_mul_i32 s14, s9, s12
    s_sub_u32 s14, s8, s14
    s_mul_i32 s14, s14, 7
    s_add_u32 s10, s14, s19
    s_load_dwordx2 s[40:41], s[0:1], 0
    s_load_dwordx2 s[42:43], s[0:1], 88
    s_load_dwordx2 s[44:45], s[0:1], 96
    s_load_dwordx2 s[46:47], s[0:1], 104
    s_load_dwordx2 s[48:49], s[0:1], 152
    v_lshrrev_b32 v1, 6, v0
    v_and_b32 v2, 63, v0
    v_readfirstlane_b32 s56, v1
    s_waitcnt lgkmcnt(0)
    s_mov_b32 s52, s48
    s_mov_b32 s53, s49
    s_mov_b32 s54, 268435456
    s_mov_b32 s55, 0x00020000
    v_lshrrev_b32 v5, 3, v2
    v_and_b32 v6, 7, v2
    v_xor_b32 v6, v6, v5
    s_lshl_b32 s57, s9, 7
    s_lshl_b32 s58, s56, 5
    s_add_u32 s57, s57, s58
    v_add_u32 v5, s57, v5
    v_mul_u32_u24 v5, 1152, v5
    v_lshl_add_u32 v3, v6, 4, v5
    v_lshrrev_b32 v5, 4, v2
    v_bfe_u32 v6, v2, 2, 2
    v_xor_b32 v6, v6, v5
    v_and_b32 v7, 3, v2
    v_lshl_add_u32 v6, v6, 2, v7
    s_lshl_b32 s57, s56, 4
    v_add_u32 v5, s57, v5
    v_lshlrev_b32 v5, 13, v5
    v_lshl_add_u32 v5, v6, 4, v5
    s_lshl_b32 s57, s10, 8
    v_add_u32 v4, s57, v5
    v_and_b32 v5, 31, v2
    v_bfe_u32 v6, v5, 3, 1
    v_lshlrev_b32 v6, 4, v6
    v_lshrrev_b32 v7, 4, v5
    v_lshl_add_u32 v6, v7, 3, v6
    v_and_b32 v7, 7, v5
    v_add_u32 v6, v6, v7
    v_mov_b32 v14, v6
    v_lshrrev_b32 v12, 5, v2
    v_add_u32 v13, 0, v12
    v_xor_b32 v13, v13, v7
    v_lshlrev_b32 v13, 4, v13
    v_lshl_add_u32 v8, v6, 7, v13
    v_add_u32 v13, 2, v12
    v_xor_b32 v13, v13, v7
    v_lshlrev_b32 v13, 4, v13
    v_lshl_add_u32 v9, v6, 7, v13
    v_add_u32 v13, 4, v12
    v_xor_b32 v13, v13, v7
    v_lshlrev_b32 v13, 4, v13
    v_lshl_add_u32 v10, v6, 7, v13
    v_add_u32 v13, 6, v12
    v_xor_b32 v13, v13, v7
    v_lshlrev_b32 v13, 4, v13
    v_lshl_add_u32 v11, v6, 7, v13
    v_bfe_u32 v5, v2, 2, 2
    v_and_b32 v6, 3, v2
    v_lshrrev_b32 v7, 1, v6
    v_lshlrev_b32 v7, 5, v7
    v_and_b32 v13, 1, v6
    v_lshl_add_u32 v7, v13, 3, v7
    v_bfe_u32 v13, v2, 4, 1
    v_lshl_add_u32 v7, v13, 4, v7
    v_xor_b32 v13, s56, v5
    v_lshl_add_u32 v7, v13, 6, v7
    v_lshl_add_u32 v13, v12, 3, v5
    v_lshl_add_u32 v7, v13, 8, v7
    v_add_u32 v15, 32768, v7
    v_accvgpr_write_b32 a0, 0
    v_accvgpr_write_b32 a1, 0
    v_accvgpr_write_b32 a2, 0
    v_accvgpr_write_b32 a3, 0
    v_accvgpr_write_b32 a4, 0
    v_accvgpr_write_b32 a5, 0
    v_accvgpr_write_b32 a6, 0
    v_accvgpr_write_b32 a7, 0
    v_accvgpr_write_b32 a8, 0
    v_accvgpr_write_b32 a9, 0
    v_accvgpr_write_b32 a10, 0
    v_accvgpr_write_b32 a11, 0
    v_accvgpr_write_b32 a12, 0
    v_accvgpr_write_b32 a13, 0
    v_accvgpr_write_b32 a14, 0
    v_accvgpr_write_b32 a15, 0
    v_accvgpr_write_b32 a16, 0
    v_accvgpr_write_b32 a17, 0
    v_accvgpr_write_b32 a18, 0
    v_accvgpr_write_b32 a19, 0
    v_accvgpr_write_b32 a20, 0
    v_accvgpr_write_b32 a21, 0
    v_accvgpr_write_b32 a22, 0
    v_accvgpr_write_b32 a23, 0
    v_accvgpr_write_b32 a24, 0
    v_accvgpr_write_b32 a25, 0
    v_accvgpr_write_b32 a26, 0
    v_accvgpr_write_b32 a27, 0
    v_accvgpr_write_b32 a28, 0
    v_accvgpr_write_b32 a29, 0
    v_accvgpr_write_b32 a30, 0
    v_accvgpr_write_b32 a31, 0
    v_accvgpr_write_b32 a32, 0
    v_accvgpr_write_b32 a33, 0
    v_accvgpr_write_b32 a34, 0
    v_accvgpr_write_b32 a35, 0
    v_accvgpr_write_b32 a36, 0
    v_accvgpr_write_b32 a37, 0
    v_accvgpr_write_b32 a38, 0
    v_accvgpr_write_b32 a39, 0
    v_accvgpr_write_b32 a40, 0
    v_accvgpr_write_b32 a41, 0
    v_accvgpr_write_b32 a42, 0
    v_accvgpr_write_b32 a43, 0
    v_accvgpr_write_b32 a44, 0
    v_accvgpr_write_b32 a45, 0
    v_accvgpr_write_b32 a46, 0
    v_accvgpr_write_b32 a47, 0
    v_accvgpr_write_b32 a48, 0
    v_accvgpr_write_b32 a49, 0
    v_accvgpr_write_b32 a50, 0
    v_accvgpr_write_b32 a51, 0
    v_accvgpr_write_b32 a52, 0
    v_accvgpr_write_b32 a53, 0
    v_accvgpr_write_b32 a54, 0
    v_accvgpr_write_b32 a55, 0
    v_accvgpr_write_b32 a56, 0
    v_accvgpr_write_b32 a57, 0
    v_accvgpr_write_b32 a58, 0
    v_accvgpr_write_b32 a59, 0
    v_accvgpr_write_b32 a60, 0
    v_accvgpr_write_b32 a61, 0
    v_accvgpr_write_b32 a62, 0
    v_accvgpr_write_b32 a63, 0
    v_accvgpr_write_b32 a64, 0
    v_accvgpr_write_b32 a65, 0
    v_accvgpr_write_b32 a66, 0
    v_accvgpr_write_b32 a67, 0
    v_accvgpr_write_b32 a68, 0
    v_accvgpr_write_b32 a69, 0
    v_accvgpr_write_b32 a70, 0
    v_accvgpr_write_b32 a71, 0
    v_accvgpr_write_b32 a72, 0
    v_accvgpr_write_b32 a73, 0
    v_accvgpr_write_b32 a74, 0
    v_accvgpr_write_b32 a75, 0
    v_accvgpr_write_b32 a76, 0
    v_accvgpr_write_b32 a77, 0
    v_accvgpr_write_b32 a78, 0
    v_accvgpr_write_b32 a79, 0
    v_accvgpr_write_b32 a80, 0
    v_accvgpr_write_b32 a81, 0
    v_accvgpr_write_b32 a82, 0
    v_accvgpr_write_b32 a83, 0
    v_accvgpr_write_b32 a84, 0
    v_accvgpr_write_b32 a85, 0
    v_accvgpr_write_b32 a86, 0
    v_accvgpr_write_b32 a87, 0
    v_accvgpr_write_b32 a88, 0
    v_accvgpr_write_b32 a89, 0
    v_accvgpr_write_b32 a90, 0
    v_accvgpr_write_b32 a91, 0
    v_accvgpr_write_b32 a92, 0
    v_accvgpr_write_b32 a93, 0
    v_accvgpr_write_b32 a94, 0
    v_accvgpr_write_b32 a95, 0
    v_accvgpr_write_b32 a96, 0
    v_accvgpr_write_b32 a97, 0
    v_accvgpr_write_b32 a98, 0
    v_accvgpr_write_b32 a99, 0
    v_accvgpr_write_b32 a100, 0
    v_accvgpr_write_b32 a101, 0
    v_accvgpr_write_b32 a102, 0
    v_accvgpr_write_b32 a103, 0
    v_accvgpr_write_b32 a104, 0
    v_accvgpr_write_b32 a105, 0
    v_accvgpr_write_b32 a106, 0
    v_accvgpr_write_b32 a107, 0
    v_accvgpr_write_b32 a108, 0
    v_accvgpr_write_b32 a109, 0
    v_accvgpr_write_b32 a110, 0
    v_accvgpr_write_b32 a111, 0
    v_accvgpr_write_b32 a112, 0
    v_accvgpr_write_b32 a113, 0
    v_accvgpr_write_b32 a114, 0
    v_accvgpr_write_b32 a115, 0
    v_accvgpr_write_b32 a116, 0
    v_accvgpr_write_b32 a117, 0
    v_accvgpr_write_b32 a118, 0
    v_accvgpr_write_b32 a119, 0
    v_accvgpr_write_b32 a120, 0
    v_accvgpr_write_b32 a121, 0
    v_accvgpr_write_b32 a122, 0
    v_accvgpr_write_b32 a123, 0
    v_accvgpr_write_b32 a124, 0
    v_accvgpr_write_b32 a125, 0
    v_accvgpr_write_b32 a126, 0
    v_accvgpr_write_b32 a127, 0
    v_accvgpr_write_b32 a128, 0
    v_accvgpr_write_b32 a129, 0
    v_accvgpr_write_b32 a130, 0
    v_accvgpr_write_b32 a131, 0
    v_accvgpr_write_b32 a132, 0
    v_accvgpr_write_b32 a133, 0
    v_accvgpr_write_b32 a134, 0
    v_accvgpr_write_b32 a135, 0
    v_accvgpr_write_b32 a136, 0
    v_accvgpr_write_b32 a137, 0
    v_accvgpr_write_b32 a138, 0
    v_accvgpr_write_b32 a139, 0
    v_accvgpr_write_b32 a140, 0
    v_accvgpr_write_b32 a141, 0
    v_accvgpr_write_b32 a142, 0
    v_accvgpr_write_b32 a143, 0
    v_accvgpr_write_b32 a144, 0
    v_accvgpr_write_b32 a145, 0
    v_accvgpr_write_b32 a146, 0
    v_accvgpr_write_b32 a147, 0
    v_accvgpr_write_b32 a148, 0
    v_accvgpr_write_b32 a149, 0
    v_accvgpr_write_b32 a150, 0
    v_accvgpr_write_b32 a151, 0
    v_accvgpr_write_b32 a152, 0
    v_accvgpr_write_b32 a153, 0
    v_accvgpr_write_b32 a154, 0
    v_accvgpr_write_b32 a155, 0
    v_accvgpr_write_b32 a156, 0
    v_accvgpr_write_b32 a157, 0
    v_accvgpr_write_b32 a158, 0
    v_accvgpr_write_b32 a159, 0
    v_accvgpr_write_b32 a160, 0
    v_accvgpr_write_b32 a161, 0
    v_accvgpr_write_b32 a162, 0
    v_accvgpr_write_b32 a163, 0
    v_accvgpr_write_b32 a164, 0
    v_accvgpr_write_b32 a165, 0
    v_accvgpr_write_b32 a166, 0
    v_accvgpr_write_b32 a167, 0
    v_accvgpr_write_b32 a168, 0
    v_accvgpr_write_b32 a169, 0
    v_accvgpr_write_b32 a170, 0
    v_accvgpr_write_b32 a171, 0
    v_accvgpr_write_b32 a172, 0
    v_accvgpr_write_b32 a173, 0
    v_accvgpr_write_b32 a174, 0
    v_accvgpr_write_b32 a175, 0
    v_accvgpr_write_b32 a176, 0
    v_accvgpr_write_b32 a177, 0
    v_accvgpr_write_b32 a178, 0
    v_accvgpr_write_b32 a179, 0
    v_accvgpr_write_b32 a180, 0
    v_accvgpr_write_b32 a181, 0
    v_accvgpr_write_b32 a182, 0
    v_accvgpr_write_b32 a183, 0
    v_accvgpr_write_b32 a184, 0
    v_accvgpr_write_b32 a185, 0
    v_accvgpr_write_b32 a186, 0
    v_accvgpr_write_b32 a187, 0
    v_accvgpr_write_b32 a188, 0
    v_accvgpr_write_b32 a189, 0
    v_accvgpr_write_b32 a190, 0
    v_accvgpr_write_b32 a191, 0
    v_mov_b32 v76, v15
    v_add_u32 v77, 49152, v15
    s_lshl_b32 s57, s56, 12
    s_add_u32 s60, s57, 0
    s_add_u32 s61, s57, 32768
    v_mov_b32 v5, v3
    s_mov_b32 m0, s60
    s_add_u32 s60, s60, 1024
    global_load_lds_dwordx4 v5, s[40:41]
    v_add_u32 v5, 9216, v5
    s_mov_b32 m0, s60
    s_add_u32 s60, s60, 1024
    global_load_lds_dwordx4 v5, s[40:41]
    v_add_u32 v5, 9216, v5
    s_mov_b32 m0, s60
    s_add_u32 s60, s60, 1024
    global_load_lds_dwordx4 v5, s[40:41]
    v_add_u32 v5, 9216, v5
    s_mov_b32 m0, s60
    s_add_u32 s60, s60, 1024
    global_load_lds_dwordx4 v5, s[40:41]
    v_mov_b32 v5, v4
    s_mov_b32 m0, s61
    s_add_u32 s61, s61, 1024
    global_load_lds_dwordx4 v5, s[42:43]
    v_add_u32 v5, 32768, v5
    s_mov_b32 m0, s61
    s_add_u32 s61, s61, 1024
    global_load_lds_dwordx4 v5, s[42:43]
    v_add_u32 v5, 32768, v5
    s_mov_b32 m0, s61
    s_add_u32 s61, s61, 1024
    global_load_lds_dwordx4 v5, s[42:43]
    v_add_u32 v5, 32768, v5
    s_mov_b32 m0, s61
    s_add_u32 s61, s61, 13312
    global_load_lds_dwordx4 v5, s[42:43]
    v_mov_b32 v5, v4
    s_mov_b32 m0, s61
    s_add_u32 s61, s61, 1024
    global_load_lds_dwordx4 v5, s[44:45]
    v_add_u32 v5, 32768, v5
    s_mov_b32 m0, s61
    s_add_u32 s61, s61, 1024
    global_load_lds_dwordx4 v5, s[44:45]
    v_add_u32 v5, 32768, v5
    s_mov_b32 m0, s61
    s_add_u32 s61, s61, 1024
    global_load_lds_dwordx4 v5, s[44:45]
    v_add_u32 v5, 32768, v5
    s_mov_b32 m0, s61
    s_add_u32 s61, s61, 13312
    global_load_lds_dwordx4 v5, s[44:45]
    v_mov_b32 v5, v4
    s_mov_b32 m0, s61
    s_add_u32 s61, s61, 1024
    global_load_lds_dwordx4 v5, s[46:47]
    v_add_u32 v5, 32768, v5
    s_mov_b32 m0, s61
    s_add_u32 s61, s61, 1024
    global_load_lds_dwordx4 v5, s[46:47]
    v_add_u32 v5, 32768, v5
    s_mov_b32 m0, s61
    s_add_u32 s61, s61, 1024
    global_load_lds_dwordx4 v5, s[46:47]
    v_add_u32 v5, 32768, v5
    s_mov_b32 m0, s61
    s_add_u32 s61, s61, 13312
    global_load_lds_dwordx4 v5, s[46:47]
    v_mov_b32 v5, v4
    v_add_u32 v3, 128, v3
    v_add_u32 v4, 524288, v4
    s_waitcnt vmcnt(0)
    s_barrier
    ds_read_b128 v[16:19], v8 offset:0
    ds_read_b128 v[20:23], v8 offset:4096
    ds_read_b128 v[24:27], v8 offset:8192
    ds_read_b128 v[28:31], v8 offset:12288
    ds_read_b64_tr_b16 v[32:33], v76 offset:0
    ds_read_b64_tr_b16 v[34:35], v76 offset:1024
    ds_read_b64_tr_b16 v[36:37], v76 offset:16384
    ds_read_b64_tr_b16 v[38:39], v76 offset:17408
    ds_read_b64_tr_b16 v[40:41], v76 offset:32768
    ds_read_b64_tr_b16 v[42:43], v76 offset:33792
    ds_read_b128 v[48:51], v9 offset:0
    ds_read_b128 v[52:55], v9 offset:4096
    ds_read_b128 v[56:59], v9 offset:8192
    ds_read_b128 v[60:63], v9 offset:12288
    ds_read_b64_tr_b16 v[64:65], v76 offset:4096
    ds_read_b64_tr_b16 v[66:67], v76 offset:5120
    ds_read_b64_tr_b16 v[68:69], v76 offset:20480
    ds_read_b64_tr_b16 v[70:71], v76 offset:21504
    ds_read_b64_tr_b16 v[72:73], v76 offset:36864
    ds_read_b64_tr_b16 v[74:75], v76 offset:37888
    s_waitcnt lgkmcnt(10)
    v_mfma_f32_32x32x16_bf16 a[0:15], v[32:35], v[16:19], a[0:15]
    v_mfma_f32_32x32x16_bf16 a[16:31], v[32:35], v[20:23], a[16:31]
    s_lshl_b32 s57, s56, 12
    s_add_u32 s60, s57, 16384
    s_add_u32 s61, s57, 81920
    v_mov_b32 v5, v3
    s_mov_b32 m0, s60
    s_add_u32 s60, s60, 1024
    global_load_lds_dwordx4 v5, s[40:41]
    v_add_u32 v5, 9216, v5
    v_mfma_f32_32x32x16_bf16 a[32:47], v[32:35], v[24:27], a[32:47]
    v_mfma_f32_32x32x16_bf16 a[48:63], v[32:35], v[28:31], a[48:63]
    s_mov_b32 m0, s60
    s_add_u32 s60, s60, 1024
    global_load_lds_dwordx4 v5, s[40:41]
    v_add_u32 v5, 9216, v5
    v_mfma_f32_32x32x16_bf16 a[64:79], v[36:39], v[16:19], a[64:79]
    v_mfma_f32_32x32x16_bf16 a[80:95], v[36:39], v[20:23], a[80:95]
    s_mov_b32 m0, s60
    s_add_u32 s60, s60, 1024
    global_load_lds_dwordx4 v5, s[40:41]
    v_add_u32 v5, 9216, v5
    v_mfma_f32_32x32x16_bf16 a[96:111], v[36:39], v[24:27], a[96:111]
    v_mfma_f32_32x32x16_bf16 a[112:127], v[36:39], v[28:31], a[112:127]
    s_mov_b32 m0, s60
    s_add_u32 s60, s60, 1024
    global_load_lds_dwordx4 v5, s[40:41]
    v_mov_b32 v5, v4
    v_mfma_f32_32x32x16_bf16 a[128:143], v[16:19], v[40:43], a[128:143]
    v_mfma_f32_32x32x16_bf16 a[144:159], v[20:23], v[40:43], a[144:159]
    s_mov_b32 m0, s61
    s_add_u32 s61, s61, 1024
    global_load_lds_dwordx4 v5, s[42:43]
    v_add_u32 v5, 32768, v5
    v_mfma_f32_32x32x16_bf16 a[160:175], v[24:27], v[40:43], a[160:175]
    v_mfma_f32_32x32x16_bf16 a[176:191], v[28:31], v[40:43], a[176:191]
    s_mov_b32 m0, s61
    s_add_u32 s61, s61, 1024
    global_load_lds_dwordx4 v5, s[42:43]
    v_add_u32 v5, 32768, v5
    ds_read_b128 v[16:19], v10 offset:0
    ds_read_b128 v[20:23], v10 offset:4096
    ds_read_b128 v[24:27], v10 offset:8192
    ds_read_b128 v[28:31], v10 offset:12288
    ds_read_b64_tr_b16 v[32:33], v76 offset:8192
    ds_read_b64_tr_b16 v[34:35], v76 offset:9216
    ds_read_b64_tr_b16 v[36:37], v76 offset:24576
    ds_read_b64_tr_b16 v[38:39], v76 offset:25600
    ds_read_b64_tr_b16 v[40:41], v76 offset:40960
    ds_read_b64_tr_b16 v[42:43], v76 offset:41984
    s_waitcnt lgkmcnt(10)
    v_mfma_f32_32x32x16_bf16 a[0:15], v[64:67], v[48:51], a[0:15]
    v_mfma_f32_32x32x16_bf16 a[16:31], v[64:67], v[52:55], a[16:31]
    s_mov_b32 m0, s61
    s_add_u32 s61, s61, 1024
    global_load_lds_dwordx4 v5, s[42:43]
    v_add_u32 v5, 32768, v5
    v_mfma_f32_32x32x16_bf16 a[32:47], v[64:67], v[56:59], a[32:47]
    v_mfma_f32_32x32x16_bf16 a[48:63], v[64:67], v[60:63], a[48:63]
    s_mov_b32 m0, s61
    s_add_u32 s61, s61, 13312
    global_load_lds_dwordx4 v5, s[42:43]
    v_mov_b32 v5, v4
    v_mfma_f32_32x32x16_bf16 a[64:79], v[68:71], v[48:51], a[64:79]
    v_mfma_f32_32x32x16_bf16 a[80:95], v[68:71], v[52:55], a[80:95]
    s_mov_b32 m0, s61
    s_add_u32 s61, s61, 1024
    global_load_lds_dwordx4 v5, s[44:45]
    v_add_u32 v5, 32768, v5
    v_mfma_f32_32x32x16_bf16 a[96:111], v[68:71], v[56:59], a[96:111]
    v_mfma_f32_32x32x16_bf16 a[112:127], v[68:71], v[60:63], a[112:127]
    s_mov_b32 m0, s61
    s_add_u32 s61, s61, 1024
    global_load_lds_dwordx4 v5, s[44:45]
    v_add_u32 v5, 32768, v5
    v_mfma_f32_32x32x16_bf16 a[128:143], v[48:51], v[72:75], a[128:143]
    v_mfma_f32_32x32x16_bf16 a[144:159], v[52:55], v[72:75], a[144:159]
    s_mov_b32 m0, s61
    s_add_u32 s61, s61, 1024
    global_load_lds_dwordx4 v5, s[44:45]
    v_add_u32 v5, 32768, v5
    v_mfma_f32_32x32x16_bf16 a[160:175], v[56:59], v[72:75], a[160:175]
    v_mfma_f32_32x32x16_bf16 a[176:191], v[60:63], v[72:75], a[176:191]
    s_mov_b32 m0, s61
    s_add_u32 s61, s61, 13312
    global_load_lds_dwordx4 v5, s[44:45]
    v_mov_b32 v5, v4
    ds_read_b128 v[48:51], v11 offset:0
    ds_read_b128 v[52:55], v11 offset:4096
    ds_read_b128 v[56:59], v11 offset:8192
    ds_read_b128 v[60:63], v11 offset:12288
    ds_read_b64_tr_b16 v[64:65], v76 offset:12288
    ds_read_b64_tr_b16 v[66:67], v76 offset:13312
    ds_read_b64_tr_b16 v[68:69], v76 offset:28672
    ds_read_b64_tr_b16 v[70:71], v76 offset:29696
    ds_read_b64_tr_b16 v[72:73], v76 offset:45056
    ds_read_b64_tr_b16 v[74:75], v76 offset:46080
    s_waitcnt lgkmcnt(10)
    v_mfma_f32_32x32x16_bf16 a[0:15], v[32:35], v[16:19], a[0:15]
    v_mfma_f32_32x32x16_bf16 a[16:31], v[32:35], v[20:23], a[16:31]
    s_mov_b32 m0, s61
    s_add_u32 s61, s61, 1024
    global_load_lds_dwordx4 v5, s[46:47]
    v_add_u32 v5, 32768, v5
    v_mfma_f32_32x32x16_bf16 a[32:47], v[32:35], v[24:27], a[32:47]
    v_mfma_f32_32x32x16_bf16 a[48:63], v[32:35], v[28:31], a[48:63]
    s_mov_b32 m0, s61
    s_add_u32 s61, s61, 1024
    global_load_lds_dwordx4 v5, s[46:47]
    v_add_u32 v5, 32768, v5
    v_mfma_f32_32x32x16_bf16 a[64:79], v[36:39], v[16:19], a[64:79]
    v_mfma_f32_32x32x16_bf16 a[80:95], v[36:39], v[20:23], a[80:95]
    s_mov_b32 m0, s61
    s_add_u32 s61, s61, 1024
    global_load_lds_dwordx4 v5, s[46:47]
    v_add_u32 v5, 32768, v5
    v_mfma_f32_32x32x16_bf16 a[96:111], v[36:39], v[24:27], a[96:111]
    v_mfma_f32_32x32x16_bf16 a[112:127], v[36:39], v[28:31], a[112:127]
    s_mov_b32 m0, s61
    s_add_u32 s61, s61, 13312
    global_load_lds_dwordx4 v5, s[46:47]
    v_mov_b32 v5, v4
    v_add_u32 v3, 128, v3
    v_add_u32 v4, 524288, v4
    v_mfma_f32_32x32x16_bf16 a[128:143], v[16:19], v[40:43], a[128:143]
    v_mfma_f32_32x32x16_bf16 a[144:159], v[20:23], v[40:43], a[144:159]
    v_mfma_f32_32x32x16_bf16 a[160:175], v[24:27], v[40:43], a[160:175]
    v_mfma_f32_32x32x16_bf16 a[176:191], v[28:31], v[40:43], a[176:191]
    s_waitcnt lgkmcnt(0)
    v_mfma_f32_32x32x16_bf16 a[0:15], v[64:67], v[48:51], a[0:15]
    v_mfma_f32_32x32x16_bf16 a[16:31], v[64:67], v[52:55], a[16:31]
    v_mfma_f32_32x32x16_bf16 a[32:47], v[64:67], v[56:59], a[32:47]
    v_mfma_f32_32x32x16_bf16 a[48:63], v[64:67], v[60:63], a[48:63]
    v_mfma_f32_32x32x16_bf16 a[64:79], v[68:71], v[48:51], a[64:79]
    v_mfma_f32_32x32x16_bf16 a[80:95], v[68:71], v[52:55], a[80:95]
    v_mfma_f32_32x32x16_bf16 a[96:111], v[68:71], v[56:59], a[96:111]
    v_mfma_f32_32x32x16_bf16 a[112:127], v[68:71], v[60:63], a[112:127]
    v_mfma_f32_32x32x16_bf16 a[128:143], v[48:51], v[72:75], a[128:143]
    v_mfma_f32_32x32x16_bf16 a[144:159], v[52:55], v[72:75], a[144:159]
    v_mfma_f32_32x32x16_bf16 a[160:175], v[56:59], v[72:75], a[160:175]
    v_mfma_f32_32x32x16_bf16 a[176:191], v[60:63], v[72:75], a[176:191]
    s_waitcnt vmcnt(0)
    s_barrier
    ds_read_b128 v[16:19], v8 offset:16384
    ds_read_b128 v[20:23], v8 offset:20480
    ds_read_b128 v[24:27], v8 offset:24576
    ds_read_b128 v[28:31], v8 offset:28672
    ds_read_b64_tr_b16 v[32:33], v77 offset:0
    ds_read_b64_tr_b16 v[34:35], v77 offset:1024
    ds_read_b64_tr_b16 v[36:37], v77 offset:16384
    ds_read_b64_tr_b16 v[38:39], v77 offset:17408
    ds_read_b64_tr_b16 v[40:41], v77 offset:32768
    ds_read_b64_tr_b16 v[42:43], v77 offset:33792
    ds_read_b128 v[48:51], v9 offset:16384
    ds_read_b128 v[52:55], v9 offset:20480
    ds_read_b128 v[56:59], v9 offset:24576
    ds_read_b128 v[60:63], v9 offset:28672
    ds_read_b64_tr_b16 v[64:65], v77 offset:4096
    ds_read_b64_tr_b16 v[66:67], v77 offset:5120
    ds_read_b64_tr_b16 v[68:69], v77 offset:20480
    ds_read_b64_tr_b16 v[70:71], v77 offset:21504
    ds_read_b64_tr_b16 v[72:73], v77 offset:36864
    ds_read_b64_tr_b16 v[74:75], v77 offset:37888
    s_waitcnt lgkmcnt(10)
    v_mfma_f32_32x32x16_bf16 a[0:15], v[32:35], v[16:19], a[0:15]
    v_mfma_f32_32x32x16_bf16 a[16:31], v[32:35], v[20:23], a[16:31]
    s_lshl_b32 s57, s56, 12
    s_add_u32 s60, s57, 0
    s_add_u32 s61, s57, 32768
    v_mov_b32 v5, v3
    s_mov_b32 m0, s60
    s_add_u32 s60, s60, 1024
    global_load_lds_dwordx4 v5, s[40:41]
    v_add_u32 v5, 9216, v5
    v_mfma_f32_32x32x16_bf16 a[32:47], v[32:35], v[24:27], a[32:47]
    v_mfma_f32_32x32x16_bf16 a[48:63], v[32:35], v[28:31], a[48:63]
    s_mov_b32 m0, s60
    s_add_u32 s60, s60, 1024
    global_load_lds_dwordx4 v5, s[40:41]
    v_add_u32 v5, 9216, v5
    v_mfma_f32_32x32x16_bf16 a[64:79], v[36:39], v[16:19], a[64:79]
    v_mfma_f32_32x32x16_bf16 a[80:95], v[36:39], v[20:23], a[80:95]
    s_mov_b32 m0, s60
    s_add_u32 s60, s60, 1024
    global_load_lds_dwordx4 v5, s[40:41]
    v_add_u32 v5, 9216, v5
    v_mfma_f32_32x32x16_bf16 a[96:111], v[36:39], v[24:27], a[96:111]
    v_mfma_f32_32x32x16_bf16 a[112:127], v[36:39], v[28:31], a[112:127]
    s_mov_b32 m0, s60
    s_add_u32 s60, s60, 1024
    global_load_lds_dwordx4 v5, s[40:41]
    v_mov_b32 v5, v4
    v_mfma_f32_32x32x16_bf16 a[128:143], v[16:19], v[40:43], a[128:143]
    v_mfma_f32_32x32x16_bf16 a[144:159], v[20:23], v[40:43], a[144:159]
    s_mov_b32 m0, s61
    s_add_u32 s61, s61, 1024
    global_load_lds_dwordx4 v5, s[42:43]
    v_add_u32 v5, 32768, v5
    v_mfma_f32_32x32x16_bf16 a[160:175], v[24:27], v[40:43], a[160:175]
    v_mfma_f32_32x32x16_bf16 a[176:191], v[28:31], v[40:43], a[176:191]
    s_mov_b32 m0, s61
    s_add_u32 s61, s61, 1024
    global_load_lds_dwordx4 v5, s[42:43]
    v_add_u32 v5, 32768, v5
    ds_read_b128 v[16:19], v10 offset:16384
    ds_read_b128 v[20:23], v10 offset:20480
    ds_read_b128 v[24:27], v10 offset:24576
    ds_read_b128 v[28:31], v10 offset:28672
    ds_read_b64_tr_b16 v[32:33], v77 offset:8192
    ds_read_b64_tr_b16 v[34:35], v77 offset:9216
    ds_read_b64_tr_b16 v[36:37], v77 offset:24576
    ds_read_b64_tr_b16 v[38:39], v77 offset:25600
    ds_read_b64_tr_b16 v[40:41], v77 offset:40960
    ds_read_b64_tr_b16 v[42:43], v77 offset:41984
    s_waitcnt lgkmcnt(10)
    v_mfma_f32_32x32x16_bf16 a[0:15], v[64:67], v[48:51], a[0:15]
    v_mfma_f32_32x32x16_bf16 a[16:31], v[64:67], v[52:55], a[16:31]
    s_mov_b32 m0, s61
    s_add_u32 s61, s61, 1024
    global_load_lds_dwordx4 v5, s[42:43]
    v_add_u32 v5, 32768, v5
    v_mfma_f32_32x32x16_bf16 a[32:47], v[64:67], v[56:59], a[32:47]
    v_mfma_f32_32x32x16_bf16 a[48:63], v[64:67], v[60:63], a[48:63]
    s_mov_b32 m0, s61
    s_add_u32 s61, s61, 13312
    global_load_lds_dwordx4 v5, s[42:43]
    v_mov_b32 v5, v4
    v_mfma_f32_32x32x16_bf16 a[64:79], v[68:71], v[48:51], a[64:79]
    v_mfma_f32_32x32x16_bf16 a[80:95], v[68:71], v[52:55], a[80:95]
    s_mov_b32 m0, s61
    s_add_u32 s61, s61, 1024
    global_load_lds_dwordx4 v5, s[44:45]
    v_add_u32 v5, 32768, v5
    v_mfma_f32_32x32x16_bf16 a[96:111], v[68:71], v[56:59], a[96:111]
    v_mfma_f32_32x32x16_bf16 a[112:127], v[68:71], v[60:63], a[112:127]
    s_mov_b32 m0, s61
    s_add_u32 s61, s61, 1024
    global_load_lds_dwordx4 v5, s[44:45]
    v_add_u32 v5, 32768, v5
    v_mfma_f32_32x32x16_bf16 a[128:143], v[48:51], v[72:75], a[128:143]
    v_mfma_f32_32x32x16_bf16 a[144:159], v[52:55], v[72:75], a[144:159]
    s_mov_b32 m0, s61
    s_add_u32 s61, s61, 1024
    global_load_lds_dwordx4 v5, s[44:45]
    v_add_u32 v5, 32768, v5
    v_mfma_f32_32x32x16_bf16 a[160:175], v[56:59], v[72:75], a[160:175]
    v_mfma_f32_32x32x16_bf16 a[176:191], v[60:63], v[72:75], a[176:191]
    s_mov_b32 m0, s61
    s_add_u32 s61, s61, 13312
    global_load_lds_dwordx4 v5, s[44:45]
    v_mov_b32 v5, v4
    ds_read_b128 v[48:51], v11 offset:16384
    ds_read_b128 v[52:55], v11 offset:20480
    ds_read_b128 v[56:59], v11 offset:24576
    ds_read_b128 v[60:63], v11 offset:28672
    ds_read_b64_tr_b16 v[64:65], v77 offset:12288
    ds_read_b64_tr_b16 v[66:67], v77 offset:13312
    ds_read_b64_tr_b16 v[68:69], v77 offset:28672
    ds_read_b64_tr_b16 v[70:71], v77 offset:29696
    ds_read_b64_tr_b16 v[72:73], v77 offset:45056
    ds_read_b64_tr_b16 v[74:75], v77 offset:46080
    s_waitcnt lgkmcnt(10)
    v_mfma_f32_32x32x16_bf16 a[0:15], v[32:35], v[16:19], a[0:15]
    v_mfma_f32_32x32x16_bf16 a[16:31], v[32:35], v[20:23], a[16:31]
    s_mov_b32 m0, s61
    s_add_u32 s61, s61, 1024
    global_load_lds_dwordx4 v5, s[46:47]
    v_add_u32 v5, 32768, v5
    v_mfma_f32_32x32x16_bf16 a[32:47], v[32:35], v[24:27], a[32:47]
    v_mfma_f32_32x32x16_bf16 a[48:63], v[32:35], v[28:31], a[48:63]
    s_mov_b32 m0, s61
    s_add_u32 s61, s61, 1024
    global_load_lds_dwordx4 v5, s[46:47]
    v_add_u32 v5, 32768, v5
    v_mfma_f32_32x32x16_bf16 a[64:79], v[36:39], v[16:19], a[64:79]
    v_mfma_f32_32x32x16_bf16 a[80:95], v[36:39], v[20:23], a[80:95]
    s_mov_b32 m0, s61
    s_add_u32 s61, s61, 1024
    global_load_lds_dwordx4 v5, s[46:47]
    v_add_u32 v5, 32768, v5
    v_mfma_f32_32x32x16_bf16 a[96:111], v[36:39], v[24:27], a[96:111]
    v_mfma_f32_32x32x16_bf16 a[112:127], v[36:39], v[28:31], a[112:127]
    s_mov_b32 m0, s61
    s_add_u32 s61, s61, 13312
    global_load_lds_dwordx4 v5, s[46:47]
    v_mov_b32 v5, v4
    v_add_u32 v3, 128, v3
    v_add_u32 v4, 524288, v4
    v_mfma_f32_32x32x16_bf16 a[128:143], v[16:19], v[40:43], a[128:143]
    v_mfma_f32_32x32x16_bf16 a[144:159], v[20:23], v[40:43], a[144:159]
    v_mfma_f32_32x32x16_bf16 a[160:175], v[24:27], v[40:43], a[160:175]
    v_mfma_f32_32x32x16_bf16 a[176:191], v[28:31], v[40:43], a[176:191]
    s_waitcnt lgkmcnt(0)
    v_mfma_f32_32x32x16_bf16 a[0:15], v[64:67], v[48:51], a[0:15]
    v_mfma_f32_32x32x16_bf16 a[16:31], v[64:67], v[52:55], a[16:31]
    v_mfma_f32_32x32x16_bf16 a[32:47], v[64:67], v[56:59], a[32:47]
    v_mfma_f32_32x32x16_bf16 a[48:63], v[64:67], v[60:63], a[48:63]
    v_mfma_f32_32x32x16_bf16 a[64:79], v[68:71], v[48:51], a[64:79]
    v_mfma_f32_32x32x16_bf16 a[80:95], v[68:71], v[52:55], a[80:95]
    v_mfma_f32_32x32x16_bf16 a[96:111], v[68:71], v[56:59], a[96:111]
    v_mfma_f32_32x32x16_bf16 a[112:127], v[68:71], v[60:63], a[112:127]
    v_mfma_f32_32x32x16_bf16 a[128:143], v[48:51], v[72:75], a[128:143]
    v_mfma_f32_32x32x16_bf16 a[144:159], v[52:55], v[72:75], a[144:159]
    v_mfma_f32_32x32x16_bf16 a[160:175], v[56:59], v[72:75], a[160:175]
    v_mfma_f32_32x32x16_bf16 a[176:191], v[60:63], v[72:75], a[176:191]
    s_waitcnt vmcnt(0)
    s_barrier
    ds_read_b128 v[16:19], v8 offset:0
    ds_read_b128 v[20:23], v8 offset:4096
    ds_read_b128 v[24:27], v8 offset:8192
    ds_read_b128 v[28:31], v8 offset:12288
    ds_read_b64_tr_b16 v[32:33], v76 offset:0
    ds_read_b64_tr_b16 v[34:35], v76 offset:1024
    ds_read_b64_tr_b16 v[36:37], v76 offset:16384
    ds_read_b64_tr_b16 v[38:39], v76 offset:17408
    ds_read_b64_tr_b16 v[40:41], v76 offset:32768
    ds_read_b64_tr_b16 v[42:43], v76 offset:33792
    ds_read_b128 v[48:51], v9 offset:0
    ds_read_b128 v[52:55], v9 offset:4096
    ds_read_b128 v[56:59], v9 offset:8192
    ds_read_b128 v[60:63], v9 offset:12288
    ds_read_b64_tr_b16 v[64:65], v76 offset:4096
    ds_read_b64_tr_b16 v[66:67], v76 offset:5120
    ds_read_b64_tr_b16 v[68:69], v76 offset:20480
    ds_read_b64_tr_b16 v[70:71], v76 offset:21504
    ds_read_b64_tr_b16 v[72:73], v76 offset:36864
    ds_read_b64_tr_b16 v[74:75], v76 offset:37888
    s_waitcnt lgkmcnt(10)
    v_mfma_f32_32x32x16_bf16 a[0:15], v[32:35], v[16:19], a[0:15]
    v_mfma_f32_32x32x16_bf16 a[16:31], v[32:35], v[20:23], a[16:31]
    s_lshl_b32 s57, s56, 12
    s_add_u32 s60, s57, 16384
    s_add_u32 s61, s57, 81920
    v_mov_b32 v5, v3
    s_mov_b32 m0, s60
    s_add_u32 s60, s60, 1024
    global_load_lds_dwordx4 v5, s[40:41]
    v_add_u32 v5, 9216, v5
    v_mfma_f32_32x32x16_bf16 a[32:47], v[32:35], v[24:27], a[32:47]
    v_mfma_f32_32x32x16_bf16 a[48:63], v[32:35], v[28:31], a[48:63]
    s_mov_b32 m0, s60
    s_add_u32 s60, s60, 1024
    global_load_lds_dwordx4 v5, s[40:41]
    v_add_u32 v5, 9216, v5
    v_mfma_f32_32x32x16_bf16 a[64:79], v[36:39], v[16:19], a[64:79]
    v_mfma_f32_32x32x16_bf16 a[80:95], v[36:39], v[20:23], a[80:95]
    s_mov_b32 m0, s60
    s_add_u32 s60, s60, 1024
    global_load_lds_dwordx4 v5, s[40:41]
    v_add_u32 v5, 9216, v5
    v_mfma_f32_32x32x16_bf16 a[96:111], v[36:39], v[24:27], a[96:111]
    v_mfma_f32_32x32x16_bf16 a[112:127], v[36:39], v[28:31], a[112:127]
    s_mov_b32 m0, s60
    s_add_u32 s60, s60, 1024
    global_load_lds_dwordx4 v5, s[40:41]
    v_mov_b32 v5, v4
    v_mfma_f32_32x32x16_bf16 a[128:143], v[16:19], v[40:43], a[128:143]
    v_mfma_f32_32x32x16_bf16 a[144:159], v[20:23], v[40:43], a[144:159]
    s_mov_b32 m0, s61
    s_add_u32 s61, s61, 1024
    global_load_lds_dwordx4 v5, s[42:43]
    v_add_u32 v5, 32768, v5
    v_mfma_f32_32x32x16_bf16 a[160:175], v[24:27], v[40:43], a[160:175]
    v_mfma_f32_32x32x16_bf16 a[176:191], v[28:31], v[40:43], a[176:191]
    s_mov_b32 m0, s61
    s_add_u32 s61, s61, 1024
    global_load_lds_dwordx4 v5, s[42:43]
    v_add_u32 v5, 32768, v5
    ds_read_b128 v[16:19], v10 offset:0
    ds_read_b128 v[20:23], v10 offset:4096
    ds_read_b128 v[24:27], v10 offset:8192
    ds_read_b128 v[28:31], v10 offset:12288
    ds_read_b64_tr_b16 v[32:33], v76 offset:8192
    ds_read_b64_tr_b16 v[34:35], v76 offset:9216
    ds_read_b64_tr_b16 v[36:37], v76 offset:24576
    ds_read_b64_tr_b16 v[38:39], v76 offset:25600
    ds_read_b64_tr_b16 v[40:41], v76 offset:40960
    ds_read_b64_tr_b16 v[42:43], v76 offset:41984
    s_waitcnt lgkmcnt(10)
    v_mfma_f32_32x32x16_bf16 a[0:15], v[64:67], v[48:51], a[0:15]
    v_mfma_f32_32x32x16_bf16 a[16:31], v[64:67], v[52:55], a[16:31]
    s_mov_b32 m0, s61
    s_add_u32 s61, s61, 1024
    global_load_lds_dwordx4 v5, s[42:43]
    v_add_u32 v5, 32768, v5
    v_mfma_f32_32x32x16_bf16 a[32:47], v[64:67], v[56:59], a[32:47]
    v_mfma_f32_32x32x16_bf16 a[48:63], v[64:67], v[60:63], a[48:63]
    s_mov_b32 m0, s61
    s_add_u32 s61, s61, 13312
    global_load_lds_dwordx4 v5, s[42:43]
    v_mov_b32 v5, v4
    v_mfma_f32_32x32x16_bf16 a[64:79], v[68:71], v[48:51], a[64:79]
    v_mfma_f32_32x32x16_bf16 a[80:95], v[68:71], v[52:55], a[80:95]
    s_mov_b32 m0, s61
    s_add_u32 s61, s61, 1024
    global_load_lds_dwordx4 v5, s[44:45]
    v_add_u32 v5, 32768, v5
    v_mfma_f32_32x32x16_bf16 a[96:111], v[68:71], v[56:59], a[96:111]
    v_mfma_f32_32x32x16_bf16 a[112:127], v[68:71], v[60:63], a[112:127]
    s_mov_b32 m0, s61
    s_add_u32 s61, s61, 1024
    global_load_lds_dwordx4 v5, s[44:45]
    v_add_u32 v5, 32768, v5
    v_mfma_f32_32x32x16_bf16 a[128:143], v[48:51], v[72:75], a[128:143]
    v_mfma_f32_32x32x16_bf16 a[144:159], v[52:55], v[72:75], a[144:159]
    s_mov_b32 m0, s61
    s_add_u32 s61, s61, 1024
    global_load_lds_dwordx4 v5, s[44:45]
    v_add_u32 v5, 32768, v5
    v_mfma_f32_32x32x16_bf16 a[160:175], v[56:59], v[72:75], a[160:175]
    v_mfma_f32_32x32x16_bf16 a[176:191], v[60:63], v[72:75], a[176:191]
    s_mov_b32 m0, s61
    s_add_u32 s61, s61, 13312
    global_load_lds_dwordx4 v5, s[44:45]
    v_mov_b32 v5, v4
    ds_read_b128 v[48:51], v11 offset:0
    ds_read_b128 v[52:55], v11 offset:4096
    ds_read_b128 v[56:59], v11 offset:8192
    ds_read_b128 v[60:63], v11 offset:12288
    ds_read_b64_tr_b16 v[64:65], v76 offset:12288
    ds_read_b64_tr_b16 v[66:67], v76 offset:13312
    ds_read_b64_tr_b16 v[68:69], v76 offset:28672
    ds_read_b64_tr_b16 v[70:71], v76 offset:29696
    ds_read_b64_tr_b16 v[72:73], v76 offset:45056
    ds_read_b64_tr_b16 v[74:75], v76 offset:46080
    s_waitcnt lgkmcnt(10)
    v_mfma_f32_32x32x16_bf16 a[0:15], v[32:35], v[16:19], a[0:15]
    v_mfma_f32_32x32x16_bf16 a[16:31], v[32:35], v[20:23], a[16:31]
    s_mov_b32 m0, s61
    s_add_u32 s61, s61, 1024
    global_load_lds_dwordx4 v5, s[46:47]
    v_add_u32 v5, 32768, v5
    v_mfma_f32_32x32x16_bf16 a[32:47], v[32:35], v[24:27], a[32:47]
    v_mfma_f32_32x32x16_bf16 a[48:63], v[32:35], v[28:31], a[48:63]
    s_mov_b32 m0, s61
    s_add_u32 s61, s61, 1024
    global_load_lds_dwordx4 v5, s[46:47]
    v_add_u32 v5, 32768, v5
    v_mfma_f32_32x32x16_bf16 a[64:79], v[36:39], v[16:19], a[64:79]
    v_mfma_f32_32x32x16_bf16 a[80:95], v[36:39], v[20:23], a[80:95]
    s_mov_b32 m0, s61
    s_add_u32 s61, s61, 1024
    global_load_lds_dwordx4 v5, s[46:47]
    v_add_u32 v5, 32768, v5
    v_mfma_f32_32x32x16_bf16 a[96:111], v[36:39], v[24:27], a[96:111]
    v_mfma_f32_32x32x16_bf16 a[112:127], v[36:39], v[28:31], a[112:127]
    s_mov_b32 m0, s61
    s_add_u32 s61, s61, 13312
    global_load_lds_dwordx4 v5, s[46:47]
    v_mov_b32 v5, v4
    v_add_u32 v3, 128, v3
    v_add_u32 v4, 524288, v4
    v_mfma_f32_32x32x16_bf16 a[128:143], v[16:19], v[40:43], a[128:143]
    v_mfma_f32_32x32x16_bf16 a[144:159], v[20:23], v[40:43], a[144:159]
    v_mfma_f32_32x32x16_bf16 a[160:175], v[24:27], v[40:43], a[160:175]
    v_mfma_f32_32x32x16_bf16 a[176:191], v[28:31], v[40:43], a[176:191]
    s_waitcnt lgkmcnt(0)
    v_mfma_f32_32x32x16_bf16 a[0:15], v[64:67], v[48:51], a[0:15]
    v_mfma_f32_32x32x16_bf16 a[16:31], v[64:67], v[52:55], a[16:31]
    v_mfma_f32_32x32x16_bf16 a[32:47], v[64:67], v[56:59], a[32:47]
    v_mfma_f32_32x32x16_bf16 a[48:63], v[64:67], v[60:63], a[48:63]
    v_mfma_f32_32x32x16_bf16 a[64:79], v[68:71], v[48:51], a[64:79]
    v_mfma_f32_32x32x16_bf16 a[80:95], v[68:71], v[52:55], a[80:95]
    v_mfma_f32_32x32x16_bf16 a[96:111], v[68:71], v[56:59], a[96:111]
    v_mfma_f32_32x32x16_bf16 a[112:127], v[68:71], v[60:63], a[112:127]
    v_mfma_f32_32x32x16_bf16 a[128:143], v[48:51], v[72:75], a[128:143]
    v_mfma_f32_32x32x16_bf16 a[144:159], v[52:55], v[72:75], a[144:159]
    v_mfma_f32_32x32x16_bf16 a[160:175], v[56:59], v[72:75], a[160:175]
    v_mfma_f32_32x32x16_bf16 a[176:191], v[60:63], v[72:75], a[176:191]
    s_waitcnt vmcnt(0)
    s_barrier
    ds_read_b128 v[16:19], v8 offset:16384
    ds_read_b128 v[20:23], v8 offset:20480
    ds_read_b128 v[24:27], v8 offset:24576
    ds_read_b128 v[28:31], v8 offset:28672
    ds_read_b64_tr_b16 v[32:33], v77 offset:0
    ds_read_b64_tr_b16 v[34:35], v77 offset:1024
    ds_read_b64_tr_b16 v[36:37], v77 offset:16384
    ds_read_b64_tr_b16 v[38:39], v77 offset:17408
    ds_read_b64_tr_b16 v[40:41], v77 offset:32768
    ds_read_b64_tr_b16 v[42:43], v77 offset:33792
    ds_read_b128 v[48:51], v9 offset:16384
    ds_read_b128 v[52:55], v9 offset:20480
    ds_read_b128 v[56:59], v9 offset:24576
    ds_read_b128 v[60:63], v9 offset:28672
    ds_read_b64_tr_b16 v[64:65], v77 offset:4096
    ds_read_b64_tr_b16 v[66:67], v77 offset:5120
    ds_read_b64_tr_b16 v[68:69], v77 offset:20480
    ds_read_b64_tr_b16 v[70:71], v77 offset:21504
    ds_read_b64_tr_b16 v[72:73], v77 offset:36864
    ds_read_b64_tr_b16 v[74:75], v77 offset:37888
    s_waitcnt lgkmcnt(10)
    v_mfma_f32_32x32x16_bf16 a[0:15], v[32:35], v[16:19], a[0:15]
    v_mfma_f32_32x32x16_bf16 a[16:31], v[32:35], v[20:23], a[16:31]
    s_lshl_b32 s57, s56, 12
    s_add_u32 s60, s57, 0
    s_add_u32 s61, s57, 32768
    v_mov_b32 v5, v3
    s_mov_b32 m0, s60
    s_add_u32 s60, s60, 1024
    global_load_lds_dwordx4 v5, s[40:41]
    v_add_u32 v5, 9216, v5
    v_mfma_f32_32x32x16_bf16 a[32:47], v[32:35], v[24:27], a[32:47]
    v_mfma_f32_32x32x16_bf16 a[48:63], v[32:35], v[28:31], a[48:63]
    s_mov_b32 m0, s60
    s_add_u32 s60, s60, 1024
    global_load_lds_dwordx4 v5, s[40:41]
    v_add_u32 v5, 9216, v5
    v_mfma_f32_32x32x16_bf16 a[64:79], v[36:39], v[16:19], a[64:79]
    v_mfma_f32_32x32x16_bf16 a[80:95], v[36:39], v[20:23], a[80:95]
    s_mov_b32 m0, s60
    s_add_u32 s60, s60, 1024
    global_load_lds_dwordx4 v5, s[40:41]
    v_add_u32 v5, 9216, v5
    v_mfma_f32_32x32x16_bf16 a[96:111], v[36:39], v[24:27], a[96:111]
    v_mfma_f32_32x32x16_bf16 a[112:127], v[36:39], v[28:31], a[112:127]
    s_mov_b32 m0, s60
    s_add_u32 s60, s60, 1024
    global_load_lds_dwordx4 v5, s[40:41]
    v_mov_b32 v5, v4
    v_mfma_f32_32x32x16_bf16 a[128:143], v[16:19], v[40:43], a[128:143]
    v_mfma_f32_32x32x16_bf16 a[144:159], v[20:23], v[40:43], a[144:159]
    s_mov_b32 m0, s61
    s_add_u32 s61, s61, 1024
    global_load_lds_dwordx4 v5, s[42:43]
    v_add_u32 v5, 32768, v5
    v_mfma_f32_32x32x16_bf16 a[160:175], v[24:27], v[40:43], a[160:175]
    v_mfma_f32_32x32x16_bf16 a[176:191], v[28:31], v[40:43], a[176:191]
    s_mov_b32 m0, s61
    s_add_u32 s61, s61, 1024
    global_load_lds_dwordx4 v5, s[42:43]
    v_add_u32 v5, 32768, v5
    ds_read_b128 v[16:19], v10 offset:16384
    ds_read_b128 v[20:23], v10 offset:20480
    ds_read_b128 v[24:27], v10 offset:24576
    ds_read_b128 v[28:31], v10 offset:28672
    ds_read_b64_tr_b16 v[32:33], v77 offset:8192
    ds_read_b64_tr_b16 v[34:35], v77 offset:9216
    ds_read_b64_tr_b16 v[36:37], v77 offset:24576
    ds_read_b64_tr_b16 v[38:39], v77 offset:25600
    ds_read_b64_tr_b16 v[40:41], v77 offset:40960
    ds_read_b64_tr_b16 v[42:43], v77 offset:41984
    s_waitcnt lgkmcnt(10)
    v_mfma_f32_32x32x16_bf16 a[0:15], v[64:67], v[48:51], a[0:15]
    v_mfma_f32_32x32x16_bf16 a[16:31], v[64:67], v[52:55], a[16:31]
    s_mov_b32 m0, s61
    s_add_u32 s61, s61, 1024
    global_load_lds_dwordx4 v5, s[42:43]
    v_add_u32 v5, 32768, v5
    v_mfma_f32_32x32x16_bf16 a[32:47], v[64:67], v[56:59], a[32:47]
    v_mfma_f32_32x32x16_bf16 a[48:63], v[64:67], v[60:63], a[48:63]
    s_mov_b32 m0, s61
    s_add_u32 s61, s61, 13312
    global_load_lds_dwordx4 v5, s[42:43]
    v_mov_b32 v5, v4
    v_mfma_f32_32x32x16_bf16 a[64:79], v[68:71], v[48:51], a[64:79]
    v_mfma_f32_32x32x16_bf16 a[80:95], v[68:71], v[52:55], a[80:95]
    s_mov_b32 m0, s61
    s_add_u32 s61, s61, 1024
    global_load_lds_dwordx4 v5, s[44:45]
    v_add_u32 v5, 32768, v5
    v_mfma_f32_32x32x16_bf16 a[96:111], v[68:71], v[56:59], a[96:111]
    v_mfma_f32_32x32x16_bf16 a[112:127], v[68:71], v[60:63], a[112:127]
    s_mov_b32 m0, s61
    s_add_u32 s61, s61, 1024
    global_load_lds_dwordx4 v5, s[44:45]
    v_add_u32 v5, 32768, v5
    v_mfma_f32_32x32x16_bf16 a[128:143], v[48:51], v[72:75], a[128:143]
    v_mfma_f32_32x32x16_bf16 a[144:159], v[52:55], v[72:75], a[144:159]
    s_mov_b32 m0, s61
    s_add_u32 s61, s61, 1024
    global_load_lds_dwordx4 v5, s[44:45]
    v_add_u32 v5, 32768, v5
    v_mfma_f32_32x32x16_bf16 a[160:175], v[56:59], v[72:75], a[160:175]
    v_mfma_f32_32x32x16_bf16 a[176:191], v[60:63], v[72:75], a[176:191]
    s_mov_b32 m0, s61
    s_add_u32 s61, s61, 13312
    global_load_lds_dwordx4 v5, s[44:45]
    v_mov_b32 v5, v4
    ds_read_b128 v[48:51], v11 offset:16384
    ds_read_b128 v[52:55], v11 offset:20480
    ds_read_b128 v[56:59], v11 offset:24576
    ds_read_b128 v[60:63], v11 offset:28672
    ds_read_b64_tr_b16 v[64:65], v77 offset:12288
    ds_read_b64_tr_b16 v[66:67], v77 offset:13312
    ds_read_b64_tr_b16 v[68:69], v77 offset:28672
    ds_read_b64_tr_b16 v[70:71], v77 offset:29696
    ds_read_b64_tr_b16 v[72:73], v77 offset:45056
    ds_read_b64_tr_b16 v[74:75], v77 offset:46080
    s_waitcnt lgkmcnt(10)
    v_mfma_f32_32x32x16_bf16 a[0:15], v[32:35], v[16:19], a[0:15]
    v_mfma_f32_32x32x16_bf16 a[16:31], v[32:35], v[20:23], a[16:31]
    s_mov_b32 m0, s61
    s_add_u32 s61, s61, 1024
    global_load_lds_dwordx4 v5, s[46:47]
    v_add_u32 v5, 32768, v5
    v_mfma_f32_32x32x16_bf16 a[32:47], v[32:35], v[24:27], a[32:47]
    v_mfma_f32_32x32x16_bf16 a[48:63], v[32:35], v[28:31], a[48:63]
    s_mov_b32 m0, s61
    s_add_u32 s61, s61, 1024
    global_load_lds_dwordx4 v5, s[46:47]
    v_add_u32 v5, 32768, v5
    v_mfma_f32_32x32x16_bf16 a[64:79], v[36:39], v[16:19], a[64:79]
    v_mfma_f32_32x32x16_bf16 a[80:95], v[36:39], v[20:23], a[80:95]
    s_mov_b32 m0, s61
    s_add_u32 s61, s61, 1024
    global_load_lds_dwordx4 v5, s[46:47]
    v_add_u32 v5, 32768, v5
    v_mfma_f32_32x32x16_bf16 a[96:111], v[36:39], v[24:27], a[96:111]
    v_mfma_f32_32x32x16_bf16 a[112:127], v[36:39], v[28:31], a[112:127]
    s_mov_b32 m0, s61
    s_add_u32 s61, s61, 13312
    global_load_lds_dwordx4 v5, s[46:47]
    v_mov_b32 v5, v4
    v_add_u32 v3, 128, v3
    v_add_u32 v4, 524288, v4
    v_mfma_f32_32x32x16_bf16 a[128:143], v[16:19], v[40:43], a[128:143]
    v_mfma_f32_32x32x16_bf16 a[144:159], v[20:23], v[40:43], a[144:159]
    v_mfma_f32_32x32x16_bf16 a[160:175], v[24:27], v[40:43], a[160:175]
    v_mfma_f32_32x32x16_bf16 a[176:191], v[28:31], v[40:43], a[176:191]
    s_waitcnt lgkmcnt(0)
    v_mfma_f32_32x32x16_bf16 a[0:15], v[64:67], v[48:51], a[0:15]
    v_mfma_f32_32x32x16_bf16 a[16:31], v[64:67], v[52:55], a[16:31]
    v_mfma_f32_32x32x16_bf16 a[32:47], v[64:67], v[56:59], a[32:47]
    v_mfma_f32_32x32x16_bf16 a[48:63], v[64:67], v[60:63], a[48:63]
    v_mfma_f32_32x32x16_bf16 a[64:79], v[68:71], v[48:51], a[64:79]
    v_mfma_f32_32x32x16_bf16 a[80:95], v[68:71], v[52:55], a[80:95]
    v_mfma_f32_32x32x16_bf16 a[96:111], v[68:71], v[56:59], a[96:111]
    v_mfma_f32_32x32x16_bf16 a[112:127], v[68:71], v[60:63], a[112:127]
    v_mfma_f32_32x32x16_bf16 a[128:143], v[48:51], v[72:75], a[128:143]
    v_mfma_f32_32x32x16_bf16 a[144:159], v[52:55], v[72:75], a[144:159]
    v_mfma_f32_32x32x16_bf16 a[160:175], v[56:59], v[72:75], a[160:175]
    v_mfma_f32_32x32x16_bf16 a[176:191], v[60:63], v[72:75], a[176:191]
    s_waitcnt vmcnt(0)
    s_barrier
    ds_read_b128 v[16:19], v8 offset:0
    ds_read_b128 v[20:23], v8 offset:4096
    ds_read_b128 v[24:27], v8 offset:8192
    ds_read_b128 v[28:31], v8 offset:12288
    ds_read_b64_tr_b16 v[32:33], v76 offset:0
    ds_read_b64_tr_b16 v[34:35], v76 offset:1024
    ds_read_b64_tr_b16 v[36:37], v76 offset:16384
    ds_read_b64_tr_b16 v[38:39], v76 offset:17408
    ds_read_b64_tr_b16 v[40:41], v76 offset:32768
    ds_read_b64_tr_b16 v[42:43], v76 offset:33792
    ds_read_b128 v[48:51], v9 offset:0
    ds_read_b128 v[52:55], v9 offset:4096
    ds_read_b128 v[56:59], v9 offset:8192
    ds_read_b128 v[60:63], v9 offset:12288
    ds_read_b64_tr_b16 v[64:65], v76 offset:4096
    ds_read_b64_tr_b16 v[66:67], v76 offset:5120
    ds_read_b64_tr_b16 v[68:69], v76 offset:20480
    ds_read_b64_tr_b16 v[70:71], v76 offset:21504
    ds_read_b64_tr_b16 v[72:73], v76 offset:36864
    ds_read_b64_tr_b16 v[74:75], v76 offset:37888
    s_waitcnt lgkmcnt(10)
    v_mfma_f32_32x32x16_bf16 a[0:15], v[32:35], v[16:19], a[0:15]
    v_mfma_f32_32x32x16_bf16 a[16:31], v[32:35], v[20:23], a[16:31]
    s_lshl_b32 s57, s56, 12
    s_add_u32 s60, s57, 16384
    s_add_u32 s61, s57, 81920
    v_mov_b32 v5, v3
    s_mov_b32 m0, s60
    s_add_u32 s60, s60, 1024
    global_load_lds_dwordx4 v5, s[40:41]
    v_add_u32 v5, 9216, v5
    v_mfma_f32_32x32x16_bf16 a[32:47], v[32:35], v[24:27], a[32:47]
    v_mfma_f32_32x32x16_bf16 a[48:63], v[32:35], v[28:31], a[48:63]
    s_mov_b32 m0, s60
    s_add_u32 s60, s60, 1024
    global_load_lds_dwordx4 v5, s[40:41]
    v_add_u32 v5, 9216, v5
    v_mfma_f32_32x32x16_bf16 a[64:79], v[36:39], v[16:19], a[64:79]
    v_mfma_f32_32x32x16_bf16 a[80:95], v[36:39], v[20:23], a[80:95]
    s_mov_b32 m0, s60
    s_add_u32 s60, s60, 1024
    global_load_lds_dwordx4 v5, s[40:41]
    v_add_u32 v5, 9216, v5
    v_mfma_f32_32x32x16_bf16 a[96:111], v[36:39], v[24:27], a[96:111]
    v_mfma_f32_32x32x16_bf16 a[112:127], v[36:39], v[28:31], a[112:127]
    s_mov_b32 m0, s60
    s_add_u32 s60, s60, 1024
    global_load_lds_dwordx4 v5, s[40:41]
    v_mov_b32 v5, v4
    v_mfma_f32_32x32x16_bf16 a[128:143], v[16:19], v[40:43], a[128:143]
    v_mfma_f32_32x32x16_bf16 a[144:159], v[20:23], v[40:43], a[144:159]
    s_mov_b32 m0, s61
    s_add_u32 s61, s61, 1024
    global_load_lds_dwordx4 v5, s[42:43]
    v_add_u32 v5, 32768, v5
    v_mfma_f32_32x32x16_bf16 a[160:175], v[24:27], v[40:43], a[160:175]
    v_mfma_f32_32x32x16_bf16 a[176:191], v[28:31], v[40:43], a[176:191]
    s_mov_b32 m0, s61
    s_add_u32 s61, s61, 1024
    global_load_lds_dwordx4 v5, s[42:43]
    v_add_u32 v5, 32768, v5
    ds_read_b128 v[16:19], v10 offset:0
    ds_read_b128 v[20:23], v10 offset:4096
    ds_read_b128 v[24:27], v10 offset:8192
    ds_read_b128 v[28:31], v10 offset:12288
    ds_read_b64_tr_b16 v[32:33], v76 offset:8192
    ds_read_b64_tr_b16 v[34:35], v76 offset:9216
    ds_read_b64_tr_b16 v[36:37], v76 offset:24576
    ds_read_b64_tr_b16 v[38:39], v76 offset:25600
    ds_read_b64_tr_b16 v[40:41], v76 offset:40960
    ds_read_b64_tr_b16 v[42:43], v76 offset:41984
    s_waitcnt lgkmcnt(10)
    v_mfma_f32_32x32x16_bf16 a[0:15], v[64:67], v[48:51], a[0:15]
    v_mfma_f32_32x32x16_bf16 a[16:31], v[64:67], v[52:55], a[16:31]
    s_mov_b32 m0, s61
    s_add_u32 s61, s61, 1024
    global_load_lds_dwordx4 v5, s[42:43]
    v_add_u32 v5, 32768, v5
    v_mfma_f32_32x32x16_bf16 a[32:47], v[64:67], v[56:59], a[32:47]
    v_mfma_f32_32x32x16_bf16 a[48:63], v[64:67], v[60:63], a[48:63]
    s_mov_b32 m0, s61
    s_add_u32 s61, s61, 13312
    global_load_lds_dwordx4 v5, s[42:43]
    v_mov_b32 v5, v4
    v_mfma_f32_32x32x16_bf16 a[64:79], v[68:71], v[48:51], a[64:79]
    v_mfma_f32_32x32x16_bf16 a[80:95], v[68:71], v[52:55], a[80:95]
    s_mov_b32 m0, s61
    s_add_u32 s61, s61, 1024
    global_load_lds_dwordx4 v5, s[44:45]
    v_add_u32 v5, 32768, v5
    v_mfma_f32_32x32x16_bf16 a[96:111], v[68:71], v[56:59], a[96:111]
    v_mfma_f32_32x32x16_bf16 a[112:127], v[68:71], v[60:63], a[112:127]
    s_mov_b32 m0, s61
    s_add_u32 s61, s61, 1024
    global_load_lds_dwordx4 v5, s[44:45]
    v_add_u32 v5, 32768, v5
    v_mfma_f32_32x32x16_bf16 a[128:143], v[48:51], v[72:75], a[128:143]
    v_mfma_f32_32x32x16_bf16 a[144:159], v[52:55], v[72:75], a[144:159]
    s_mov_b32 m0, s61
    s_add_u32 s61, s61, 1024
    global_load_lds_dwordx4 v5, s[44:45]
    v_add_u32 v5, 32768, v5
    v_mfma_f32_32x32x16_bf16 a[160:175], v[56:59], v[72:75], a[160:175]
    v_mfma_f32_32x32x16_bf16 a[176:191], v[60:63], v[72:75], a[176:191]
    s_mov_b32 m0, s61
    s_add_u32 s61, s61, 13312
    global_load_lds_dwordx4 v5, s[44:45]
    v_mov_b32 v5, v4
    ds_read_b128 v[48:51], v11 offset:0
    ds_read_b128 v[52:55], v11 offset:4096
    ds_read_b128 v[56:59], v11 offset:8192
    ds_read_b128 v[60:63], v11 offset:12288
    ds_read_b64_tr_b16 v[64:65], v76 offset:12288
    ds_read_b64_tr_b16 v[66:67], v76 offset:13312
    ds_read_b64_tr_b16 v[68:69], v76 offset:28672
    ds_read_b64_tr_b16 v[70:71], v76 offset:29696
    ds_read_b64_tr_b16 v[72:73], v76 offset:45056
    ds_read_b64_tr_b16 v[74:75], v76 offset:46080
    s_waitcnt lgkmcnt(10)
    v_mfma_f32_32x32x16_bf16 a[0:15], v[32:35], v[16:19], a[0:15]
    v_mfma_f32_32x32x16_bf16 a[16:31], v[32:35], v[20:23], a[16:31]
    s_mov_b32 m0, s61
    s_add_u32 s61, s61, 1024
    global_load_lds_dwordx4 v5, s[46:47]
    v_add_u32 v5, 32768, v5
    v_mfma_f32_32x32x16_bf16 a[32:47], v[32:35], v[24:27], a[32:47]
    v_mfma_f32_32x32x16_bf16 a[48:63], v[32:35], v[28:31], a[48:63]
    s_mov_b32 m0, s61
    s_add_u32 s61, s61, 1024
    global_load_lds_dwordx4 v5, s[46:47]
    v_add_u32 v5, 32768, v5
    v_mfma_f32_32x32x16_bf16 a[64:79], v[36:39], v[16:19], a[64:79]
    v_mfma_f32_32x32x16_bf16 a[80:95], v[36:39], v[20:23], a[80:95]
    s_mov_b32 m0, s61
    s_add_u32 s61, s61, 1024
    global_load_lds_dwordx4 v5, s[46:47]
    v_add_u32 v5, 32768, v5
    v_mfma_f32_32x32x16_bf16 a[96:111], v[36:39], v[24:27], a[96:111]
    v_mfma_f32_32x32x16_bf16 a[112:127], v[36:39], v[28:31], a[112:127]
    s_mov_b32 m0, s61
    s_add_u32 s61, s61, 13312
    global_load_lds_dwordx4 v5, s[46:47]
    v_mov_b32 v5, v4
    v_add_u32 v3, 128, v3
    v_add_u32 v4, 524288, v4
    v_mfma_f32_32x32x16_bf16 a[128:143], v[16:19], v[40:43], a[128:143]
    v_mfma_f32_32x32x16_bf16 a[144:159], v[20:23], v[40:43], a[144:159]
    v_mfma_f32_32x32x16_bf16 a[160:175], v[24:27], v[40:43], a[160:175]
    v_mfma_f32_32x32x16_bf16 a[176:191], v[28:31], v[40:43], a[176:191]
    s_waitcnt lgkmcnt(0)
    v_mfma_f32_32x32x16_bf16 a[0:15], v[64:67], v[48:51], a[0:15]
    v_mfma_f32_32x32x16_bf16 a[16:31], v[64:67], v[52:55], a[16:31]
    v_mfma_f32_32x32x16_bf16 a[32:47], v[64:67], v[56:59], a[32:47]
    v_mfma_f32_32x32x16_bf16 a[48:63], v[64:67], v[60:63], a[48:63]
    v_mfma_f32_32x32x16_bf16 a[64:79], v[68:71], v[48:51], a[64:79]
    v_mfma_f32_32x32x16_bf16 a[80:95], v[68:71], v[52:55], a[80:95]
    v_mfma_f32_32x32x16_bf16 a[96:111], v[68:71], v[56:59], a[96:111]
    v_mfma_f32_32x32x16_bf16 a[112:127], v[68:71], v[60:63], a[112:127]
    v_mfma_f32_32x32x16_bf16 a[128:143], v[48:51], v[72:75], a[128:143]
    v_mfma_f32_32x32x16_bf16 a[144:159], v[52:55], v[72:75], a[144:159]
    v_mfma_f32_32x32x16_bf16 a[160:175], v[56:59], v[72:75], a[160:175]
    v_mfma_f32_32x32x16_bf16 a[176:191], v[60:63], v[72:75], a[176:191]
    s_waitcnt vmcnt(0)
    s_barrier
    ds_read_b128 v[16:19], v8 offset:16384
    ds_read_b128 v[20:23], v8 offset:20480
    ds_read_b128 v[24:27], v8 offset:24576
    ds_read_b128 v[28:31], v8 offset:28672
    ds_read_b64_tr_b16 v[32:33], v77 offset:0
    ds_read_b64_tr_b16 v[34:35], v77 offset:1024
    ds_read_b64_tr_b16 v[36:37], v77 offset:16384
    ds_read_b64_tr_b16 v[38:39], v77 offset:17408
    ds_read_b64_tr_b16 v[40:41], v77 offset:32768
    ds_read_b64_tr_b16 v[42:43], v77 offset:33792
    ds_read_b128 v[48:51], v9 offset:16384
    ds_read_b128 v[52:55], v9 offset:20480
    ds_read_b128 v[56:59], v9 offset:24576
    ds_read_b128 v[60:63], v9 offset:28672
    ds_read_b64_tr_b16 v[64:65], v77 offset:4096
    ds_read_b64_tr_b16 v[66:67], v77 offset:5120
    ds_read_b64_tr_b16 v[68:69], v77 offset:20480
    ds_read_b64_tr_b16 v[70:71], v77 offset:21504
    ds_read_b64_tr_b16 v[72:73], v77 offset:36864
    ds_read_b64_tr_b16 v[74:75], v77 offset:37888
    s_waitcnt lgkmcnt(10)
    v_mfma_f32_32x32x16_bf16 a[0:15], v[32:35], v[16:19], a[0:15]
    v_mfma_f32_32x32x16_bf16 a[16:31], v[32:35], v[20:23], a[16:31]
    s_lshl_b32 s57, s56, 12
    s_add_u32 s60, s57, 0
    s_add_u32 s61, s57, 32768
    v_mov_b32 v5, v3
    s_mov_b32 m0, s60
    s_add_u32 s60, s60, 1024
    global_load_lds_dwordx4 v5, s[40:41]
    v_add_u32 v5, 9216, v5
    v_mfma_f32_32x32x16_bf16 a[32:47], v[32:35], v[24:27], a[32:47]
    v_mfma_f32_32x32x16_bf16 a[48:63], v[32:35], v[28:31], a[48:63]
    s_mov_b32 m0, s60
    s_add_u32 s60, s60, 1024
    global_load_lds_dwordx4 v5, s[40:41]
    v_add_u32 v5, 9216, v5
    v_mfma_f32_32x32x16_bf16 a[64:79], v[36:39], v[16:19], a[64:79]
    v_mfma_f32_32x32x16_bf16 a[80:95], v[36:39], v[20:23], a[80:95]
    s_mov_b32 m0, s60
    s_add_u32 s60, s60, 1024
    global_load_lds_dwordx4 v5, s[40:41]
    v_add_u32 v5, 9216, v5
    v_mfma_f32_32x32x16_bf16 a[96:111], v[36:39], v[24:27], a[96:111]
    v_mfma_f32_32x32x16_bf16 a[112:127], v[36:39], v[28:31], a[112:127]
    s_mov_b32 m0, s60
    s_add_u32 s60, s60, 1024
    global_load_lds_dwordx4 v5, s[40:41]
    v_mov_b32 v5, v4
    v_mfma_f32_32x32x16_bf16 a[128:143], v[16:19], v[40:43], a[128:143]
    v_mfma_f32_32x32x16_bf16 a[144:159], v[20:23], v[40:43], a[144:159]
    s_mov_b32 m0, s61
    s_add_u32 s61, s61, 1024
    global_load_lds_dwordx4 v5, s[42:43]
    v_add_u32 v5, 32768, v5
    v_mfma_f32_32x32x16_bf16 a[160:175], v[24:27], v[40:43], a[160:175]
    v_mfma_f32_32x32x16_bf16 a[176:191], v[28:31], v[40:43], a[176:191]
    s_mov_b32 m0, s61
    s_add_u32 s61, s61, 1024
    global_load_lds_dwordx4 v5, s[42:43]
    v_add_u32 v5, 32768, v5
    ds_read_b128 v[16:19], v10 offset:16384
    ds_read_b128 v[20:23], v10 offset:20480
    ds_read_b128 v[24:27], v10 offset:24576
    ds_read_b128 v[28:31], v10 offset:28672
    ds_read_b64_tr_b16 v[32:33], v77 offset:8192
    ds_read_b64_tr_b16 v[34:35], v77 offset:9216
    ds_read_b64_tr_b16 v[36:37], v77 offset:24576
    ds_read_b64_tr_b16 v[38:39], v77 offset:25600
    ds_read_b64_tr_b16 v[40:41], v77 offset:40960
    ds_read_b64_tr_b16 v[42:43], v77 offset:41984
    s_waitcnt lgkmcnt(10)
    v_mfma_f32_32x32x16_bf16 a[0:15], v[64:67], v[48:51], a[0:15]
    v_mfma_f32_32x32x16_bf16 a[16:31], v[64:67], v[52:55], a[16:31]
    s_mov_b32 m0, s61
    s_add_u32 s61, s61, 1024
    global_load_lds_dwordx4 v5, s[42:43]
    v_add_u32 v5, 32768, v5
    v_mfma_f32_32x32x16_bf16 a[32:47], v[64:67], v[56:59], a[32:47]
    v_mfma_f32_32x32x16_bf16 a[48:63], v[64:67], v[60:63], a[48:63]
    s_mov_b32 m0, s61
    s_add_u32 s61, s61, 13312
    global_load_lds_dwordx4 v5, s[42:43]
    v_mov_b32 v5, v4
    v_mfma_f32_32x32x16_bf16 a[64:79], v[68:71], v[48:51], a[64:79]
    v_mfma_f32_32x32x16_bf16 a[80:95], v[68:71], v[52:55], a[80:95]
    s_mov_b32 m0, s61
    s_add_u32 s61, s61, 1024
    global_load_lds_dwordx4 v5, s[44:45]
    v_add_u32 v5, 32768, v5
    v_mfma_f32_32x32x16_bf16 a[96:111], v[68:71], v[56:59], a[96:111]
    v_mfma_f32_32x32x16_bf16 a[112:127], v[68:71], v[60:63], a[112:127]
    s_mov_b32 m0, s61
    s_add_u32 s61, s61, 1024
    global_load_lds_dwordx4 v5, s[44:45]
    v_add_u32 v5, 32768, v5
    v_mfma_f32_32x32x16_bf16 a[128:143], v[48:51], v[72:75], a[128:143]
    v_mfma_f32_32x32x16_bf16 a[144:159], v[52:55], v[72:75], a[144:159]
    s_mov_b32 m0, s61
    s_add_u32 s61, s61, 1024
    global_load_lds_dwordx4 v5, s[44:45]
    v_add_u32 v5, 32768, v5
    v_mfma_f32_32x32x16_bf16 a[160:175], v[56:59], v[72:75], a[160:175]
    v_mfma_f32_32x32x16_bf16 a[176:191], v[60:63], v[72:75], a[176:191]
    s_mov_b32 m0, s61
    s_add_u32 s61, s61, 13312
    global_load_lds_dwordx4 v5, s[44:45]
    v_mov_b32 v5, v4
    ds_read_b128 v[48:51], v11 offset:16384
    ds_read_b128 v[52:55], v11 offset:20480
    ds_read_b128 v[56:59], v11 offset:24576
    ds_read_b128 v[60:63], v11 offset:28672
    ds_read_b64_tr_b16 v[64:65], v77 offset:12288
    ds_read_b64_tr_b16 v[66:67], v77 offset:13312
    ds_read_b64_tr_b16 v[68:69], v77 offset:28672
    ds_read_b64_tr_b16 v[70:71], v77 offset:29696
    ds_read_b64_tr_b16 v[72:73], v77 offset:45056
    ds_read_b64_tr_b16 v[74:75], v77 offset:46080
    s_waitcnt lgkmcnt(10)
    v_mfma_f32_32x32x16_bf16 a[0:15], v[32:35], v[16:19], a[0:15]
    v_mfma_f32_32x32x16_bf16 a[16:31], v[32:35], v[20:23], a[16:31]
    s_mov_b32 m0, s61
    s_add_u32 s61, s61, 1024
    global_load_lds_dwordx4 v5, s[46:47]
    v_add_u32 v5, 32768, v5
    v_mfma_f32_32x32x16_bf16 a[32:47], v[32:35], v[24:27], a[32:47]
    v_mfma_f32_32x32x16_bf16 a[48:63], v[32:35], v[28:31], a[48:63]
    s_mov_b32 m0, s61
    s_add_u32 s61, s61, 1024
    global_load_lds_dwordx4 v5, s[46:47]
    v_add_u32 v5, 32768, v5
    v_mfma_f32_32x32x16_bf16 a[64:79], v[36:39], v[16:19], a[64:79]
    v_mfma_f32_32x32x16_bf16 a[80:95], v[36:39], v[20:23], a[80:95]
    s_mov_b32 m0, s61
    s_add_u32 s61, s61, 1024
    global_load_lds_dwordx4 v5, s[46:47]
    v_add_u32 v5, 32768, v5
    v_mfma_f32_32x32x16_bf16 a[96:111], v[36:39], v[24:27], a[96:111]
    v_mfma_f32_32x32x16_bf16 a[112:127], v[36:39], v[28:31], a[112:127]
    s_mov_b32 m0, s61
    s_add_u32 s61, s61, 13312
    global_load_lds_dwordx4 v5, s[46:47]
    v_mov_b32 v5, v4
    v_add_u32 v3, 128, v3
    v_add_u32 v4, 524288, v4
    v_mfma_f32_32x32x16_bf16 a[128:143], v[16:19], v[40:43], a[128:143]
    v_mfma_f32_32x32x16_bf16 a[144:159], v[20:23], v[40:43], a[144:159]
    v_mfma_f32_32x32x16_bf16 a[160:175], v[24:27], v[40:43], a[160:175]
    v_mfma_f32_32x32x16_bf16 a[176:191], v[28:31], v[40:43], a[176:191]
    s_waitcnt lgkmcnt(0)
    v_mfma_f32_32x32x16_bf16 a[0:15], v[64:67], v[48:51], a[0:15]
    v_mfma_f32_32x32x16_bf16 a[16:31], v[64:67], v[52:55], a[16:31]
    v_mfma_f32_32x32x16_bf16 a[32:47], v[64:67], v[56:59], a[32:47]
    v_mfma_f32_32x32x16_bf16 a[48:63], v[64:67], v[60:63], a[48:63]
    v_mfma_f32_32x32x16_bf16 a[64:79], v[68:71], v[48:51], a[64:79]
    v_mfma_f32_32x32x16_bf16 a[80:95], v[68:71], v[52:55], a[80:95]
    v_mfma_f32_32x32x16_bf16 a[96:111], v[68:71], v[56:59], a[96:111]
    v_mfma_f32_32x32x16_bf16 a[112:127], v[68:71], v[60:63], a[112:127]
    v_mfma_f32_32x32x16_bf16 a[128:143], v[48:51], v[72:75], a[128:143]
    v_mfma_f32_32x32x16_bf16 a[144:159], v[52:55], v[72:75], a[144:159]
    v_mfma_f32_32x32x16_bf16 a[160:175], v[56:59], v[72:75], a[160:175]
    v_mfma_f32_32x32x16_bf16 a[176:191], v[60:63], v[72:75], a[176:191]
    s_waitcnt vmcnt(0)
    s_barrier
    ds_read_b128 v[16:19], v8 offset:0
    ds_read_b128 v[20:23], v8 offset:4096
    ds_read_b128 v[24:27], v8 offset:8192
    ds_read_b128 v[28:31], v8 offset:12288
    ds_read_b64_tr_b16 v[32:33], v76 offset:0
    ds_read_b64_tr_b16 v[34:35], v76 offset:1024
    ds_read_b64_tr_b16 v[36:37], v76 offset:16384
    ds_read_b64_tr_b16 v[38:39], v76 offset:17408
    ds_read_b64_tr_b16 v[40:41], v76 offset:32768
    ds_read_b64_tr_b16 v[42:43], v76 offset:33792
    ds_read_b128 v[48:51], v9 offset:0
    ds_read_b128 v[52:55], v9 offset:4096
    ds_read_b128 v[56:59], v9 offset:8192
    ds_read_b128 v[60:63], v9 offset:12288
    ds_read_b64_tr_b16 v[64:65], v76 offset:4096
    ds_read_b64_tr_b16 v[66:67], v76 offset:5120
    ds_read_b64_tr_b16 v[68:69], v76 offset:20480
    ds_read_b64_tr_b16 v[70:71], v76 offset:21504
    ds_read_b64_tr_b16 v[72:73], v76 offset:36864
    ds_read_b64_tr_b16 v[74:75], v76 offset:37888
    s_waitcnt lgkmcnt(10)
    v_mfma_f32_32x32x16_bf16 a[0:15], v[32:35], v[16:19], a[0:15]
    v_mfma_f32_32x32x16_bf16 a[16:31], v[32:35], v[20:23], a[16:31]
    s_lshl_b32 s57, s56, 12
    s_add_u32 s60, s57, 16384
    s_add_u32 s61, s57, 81920
    v_mov_b32 v5, v3
    s_mov_b32 m0, s60
    s_add_u32 s60, s60, 1024
    global_load_lds_dwordx4 v5, s[40:41]
    v_add_u32 v5, 9216, v5
    v_mfma_f32_32x32x16_bf16 a[32:47], v[32:35], v[24:27], a[32:47]
    v_mfma_f32_32x32x16_bf16 a[48:63], v[32:35], v[28:31], a[48:63]
    s_mov_b32 m0, s60
    s_add_u32 s60, s60, 1024
    global_load_lds_dwordx4 v5, s[40:41]
    v_add_u32 v5, 9216, v5
    v_mfma_f32_32x32x16_bf16 a[64:79], v[36:39], v[16:19], a[64:79]
    v_mfma_f32_32x32x16_bf16 a[80:95], v[36:39], v[20:23], a[80:95]
    s_mov_b32 m0, s60
    s_add_u32 s60, s60, 1024
    global_load_lds_dwordx4 v5, s[40:41]
    v_add_u32 v5, 9216, v5
    v_mfma_f32_32x32x16_bf16 a[96:111], v[36:39], v[24:27], a[96:111]
    v_mfma_f32_32x32x16_bf16 a[112:127], v[36:39], v[28:31], a[112:127]
    s_mov_b32 m0, s60
    s_add_u32 s60, s60, 1024
    global_load_lds_dwordx4 v5, s[40:41]
    v_mov_b32 v5, v4
    v_mfma_f32_32x32x16_bf16 a[128:143], v[16:19], v[40:43], a[128:143]
    v_mfma_f32_32x32x16_bf16 a[144:159], v[20:23], v[40:43], a[144:159]
    s_mov_b32 m0, s61
    s_add_u32 s61, s61, 1024
    global_load_lds_dwordx4 v5, s[42:43]
    v_add_u32 v5, 32768, v5
    v_mfma_f32_32x32x16_bf16 a[160:175], v[24:27], v[40:43], a[160:175]
    v_mfma_f32_32x32x16_bf16 a[176:191], v[28:31], v[40:43], a[176:191]
    s_mov_b32 m0, s61
    s_add_u32 s61, s61, 1024
    global_load_lds_dwordx4 v5, s[42:43]
    v_add_u32 v5, 32768, v5
    ds_read_b128 v[16:19], v10 offset:0
    ds_read_b128 v[20:23], v10 offset:4096
    ds_read_b128 v[24:27], v10 offset:8192
    ds_read_b128 v[28:31], v10 offset:12288
    ds_read_b64_tr_b16 v[32:33], v76 offset:8192
    ds_read_b64_tr_b16 v[34:35], v76 offset:9216
    ds_read_b64_tr_b16 v[36:37], v76 offset:24576
    ds_read_b64_tr_b16 v[38:39], v76 offset:25600
    ds_read_b64_tr_b16 v[40:41], v76 offset:40960
    ds_read_b64_tr_b16 v[42:43], v76 offset:41984
    s_waitcnt lgkmcnt(10)
    v_mfma_f32_32x32x16_bf16 a[0:15], v[64:67], v[48:51], a[0:15]
    v_mfma_f32_32x32x16_bf16 a[16:31], v[64:67], v[52:55], a[16:31]
    s_mov_b32 m0, s61
    s_add_u32 s61, s61, 1024
    global_load_lds_dwordx4 v5, s[42:43]
    v_add_u32 v5, 32768, v5
    v_mfma_f32_32x32x16_bf16 a[32:47], v[64:67], v[56:59], a[32:47]
    v_mfma_f32_32x32x16_bf16 a[48:63], v[64:67], v[60:63], a[48:63]
    s_mov_b32 m0, s61
    s_add_u32 s61, s61, 13312
    global_load_lds_dwordx4 v5, s[42:43]
    v_mov_b32 v5, v4
    v_mfma_f32_32x32x16_bf16 a[64:79], v[68:71], v[48:51], a[64:79]
    v_mfma_f32_32x32x16_bf16 a[80:95], v[68:71], v[52:55], a[80:95]
    s_mov_b32 m0, s61
    s_add_u32 s61, s61, 1024
    global_load_lds_dwordx4 v5, s[44:45]
    v_add_u32 v5, 32768, v5
    v_mfma_f32_32x32x16_bf16 a[96:111], v[68:71], v[56:59], a[96:111]
    v_mfma_f32_32x32x16_bf16 a[112:127], v[68:71], v[60:63], a[112:127]
    s_mov_b32 m0, s61
    s_add_u32 s61, s61, 1024
    global_load_lds_dwordx4 v5, s[44:45]
    v_add_u32 v5, 32768, v5
    v_mfma_f32_32x32x16_bf16 a[128:143], v[48:51], v[72:75], a[128:143]
    v_mfma_f32_32x32x16_bf16 a[144:159], v[52:55], v[72:75], a[144:159]
    s_mov_b32 m0, s61
    s_add_u32 s61, s61, 1024
    global_load_lds_dwordx4 v5, s[44:45]
    v_add_u32 v5, 32768, v5
    v_mfma_f32_32x32x16_bf16 a[160:175], v[56:59], v[72:75], a[160:175]
    v_mfma_f32_32x32x16_bf16 a[176:191], v[60:63], v[72:75], a[176:191]
    s_mov_b32 m0, s61
    s_add_u32 s61, s61, 13312
    global_load_lds_dwordx4 v5, s[44:45]
    v_mov_b32 v5, v4
    ds_read_b128 v[48:51], v11 offset:0
    ds_read_b128 v[52:55], v11 offset:4096
    ds_read_b128 v[56:59], v11 offset:8192
    ds_read_b128 v[60:63], v11 offset:12288
    ds_read_b64_tr_b16 v[64:65], v76 offset:12288
    ds_read_b64_tr_b16 v[66:67], v76 offset:13312
    ds_read_b64_tr_b16 v[68:69], v76 offset:28672
    ds_read_b64_tr_b16 v[70:71], v76 offset:29696
    ds_read_b64_tr_b16 v[72:73], v76 offset:45056
    ds_read_b64_tr_b16 v[74:75], v76 offset:46080
    s_waitcnt lgkmcnt(10)
    v_mfma_f32_32x32x16_bf16 a[0:15], v[32:35], v[16:19], a[0:15]
    v_mfma_f32_32x32x16_bf16 a[16:31], v[32:35], v[20:23], a[16:31]
    s_mov_b32 m0, s61
    s_add_u32 s61, s61, 1024
    global_load_lds_dwordx4 v5, s[46:47]
    v_add_u32 v5, 32768, v5
    v_mfma_f32_32x32x16_bf16 a[32:47], v[32:35], v[24:27], a[32:47]
    v_mfma_f32_32x32x16_bf16 a[48:63], v[32:35], v[28:31], a[48:63]
    s_mov_b32 m0, s61
    s_add_u32 s61, s61, 1024
    global_load_lds_dwordx4 v5, s[46:47]
    v_add_u32 v5, 32768, v5
    v_mfma_f32_32x32x16_bf16 a[64:79], v[36:39], v[16:19], a[64:79]
    v_mfma_f32_32x32x16_bf16 a[80:95], v[36:39], v[20:23], a[80:95]
    s_mov_b32 m0, s61
    s_add_u32 s61, s61, 1024
    global_load_lds_dwordx4 v5, s[46:47]
    v_add_u32 v5, 32768, v5
    v_mfma_f32_32x32x16_bf16 a[96:111], v[36:39], v[24:27], a[96:111]
    v_mfma_f32_32x32x16_bf16 a[112:127], v[36:39], v[28:31], a[112:127]
    s_mov_b32 m0, s61
    s_add_u32 s61, s61, 13312
    global_load_lds_dwordx4 v5, s[46:47]
    v_mov_b32 v5, v4
    v_add_u32 v3, 128, v3
    v_add_u32 v4, 524288, v4
    v_mfma_f32_32x32x16_bf16 a[128:143], v[16:19], v[40:43], a[128:143]
    v_mfma_f32_32x32x16_bf16 a[144:159], v[20:23], v[40:43], a[144:159]
    v_mfma_f32_32x32x16_bf16 a[160:175], v[24:27], v[40:43], a[160:175]
    v_mfma_f32_32x32x16_bf16 a[176:191], v[28:31], v[40:43], a[176:191]
    s_waitcnt lgkmcnt(0)
    v_mfma_f32_32x32x16_bf16 a[0:15], v[64:67], v[48:51], a[0:15]
    v_mfma_f32_32x32x16_bf16 a[16:31], v[64:67], v[52:55], a[16:31]
    v_mfma_f32_32x32x16_bf16 a[32:47], v[64:67], v[56:59], a[32:47]
    v_mfma_f32_32x32x16_bf16 a[48:63], v[64:67], v[60:63], a[48:63]
    v_mfma_f32_32x32x16_bf16 a[64:79], v[68:71], v[48:51], a[64:79]
    v_mfma_f32_32x32x16_bf16 a[80:95], v[68:71], v[52:55], a[80:95]
    v_mfma_f32_32x32x16_bf16 a[96:111], v[68:71], v[56:59], a[96:111]
    v_mfma_f32_32x32x16_bf16 a[112:127], v[68:71], v[60:63], a[112:127]
    v_mfma_f32_32x32x16_bf16 a[128:143], v[48:51], v[72:75], a[128:143]
    v_mfma_f32_32x32x16_bf16 a[144:159], v[52:55], v[72:75], a[144:159]
    v_mfma_f32_32x32x16_bf16 a[160:175], v[56:59], v[72:75], a[160:175]
    v_mfma_f32_32x32x16_bf16 a[176:191], v[60:63], v[72:75], a[176:191]
    s_waitcnt vmcnt(0)
    s_barrier
    ds_read_b128 v[16:19], v8 offset:16384
    ds_read_b128 v[20:23], v8 offset:20480
    ds_read_b128 v[24:27], v8 offset:24576
    ds_read_b128 v[28:31], v8 offset:28672
    ds_read_b64_tr_b16 v[32:33], v77 offset:0
    ds_read_b64_tr_b16 v[34:35], v77 offset:1024
    ds_read_b64_tr_b16 v[36:37], v77 offset:16384
    ds_read_b64_tr_b16 v[38:39], v77 offset:17408
    ds_read_b64_tr_b16 v[40:41], v77 offset:32768
    ds_read_b64_tr_b16 v[42:43], v77 offset:33792
    ds_read_b128 v[48:51], v9 offset:16384
    ds_read_b128 v[52:55], v9 offset:20480
    ds_read_b128 v[56:59], v9 offset:24576
    ds_read_b128 v[60:63], v9 offset:28672
    ds_read_b64_tr_b16 v[64:65], v77 offset:4096
    ds_read_b64_tr_b16 v[66:67], v77 offset:5120
    ds_read_b64_tr_b16 v[68:69], v77 offset:20480
    ds_read_b64_tr_b16 v[70:71], v77 offset:21504
    ds_read_b64_tr_b16 v[72:73], v77 offset:36864
    ds_read_b64_tr_b16 v[74:75], v77 offset:37888
    s_waitcnt lgkmcnt(10)
    v_mfma_f32_32x32x16_bf16 a[0:15], v[32:35], v[16:19], a[0:15]
    v_mfma_f32_32x32x16_bf16 a[16:31], v[32:35], v[20:23], a[16:31]
    s_lshl_b32 s57, s56, 12
    s_add_u32 s60, s57, 0
    s_add_u32 s61, s57, 32768
    v_mov_b32 v5, v3
    s_mov_b32 m0, s60
    s_add_u32 s60, s60, 1024
    global_load_lds_dwordx4 v5, s[40:41]
    v_add_u32 v5, 9216, v5
    v_mfma_f32_32x32x16_bf16 a[32:47], v[32:35], v[24:27], a[32:47]
    v_mfma_f32_32x32x16_bf16 a[48:63], v[32:35], v[28:31], a[48:63]
    s_mov_b32 m0, s60
    s_add_u32 s60, s60, 1024
    global_load_lds_dwordx4 v5, s[40:41]
    v_add_u32 v5, 9216, v5
    v_mfma_f32_32x32x16_bf16 a[64:79], v[36:39], v[16:19], a[64:79]
    v_mfma_f32_32x32x16_bf16 a[80:95], v[36:39], v[20:23], a[80:95]
    s_mov_b32 m0, s60
    s_add_u32 s60, s60, 1024
    global_load_lds_dwordx4 v5, s[40:41]
    v_add_u32 v5, 9216, v5
    v_mfma_f32_32x32x16_bf16 a[96:111], v[36:39], v[24:27], a[96:111]
    v_mfma_f32_32x32x16_bf16 a[112:127], v[36:39], v[28:31], a[112:127]
    s_mov_b32 m0, s60
    s_add_u32 s60, s60, 1024
    global_load_lds_dwordx4 v5, s[40:41]
    v_mov_b32 v5, v4
    v_mfma_f32_32x32x16_bf16 a[128:143], v[16:19], v[40:43], a[128:143]
    v_mfma_f32_32x32x16_bf16 a[144:159], v[20:23], v[40:43], a[144:159]
    s_mov_b32 m0, s61
    s_add_u32 s61, s61, 1024
    global_load_lds_dwordx4 v5, s[42:43]
    v_add_u32 v5, 32768, v5
    v_mfma_f32_32x32x16_bf16 a[160:175], v[24:27], v[40:43], a[160:175]
    v_mfma_f32_32x32x16_bf16 a[176:191], v[28:31], v[40:43], a[176:191]
    s_mov_b32 m0, s61
    s_add_u32 s61, s61, 1024
    global_load_lds_dwordx4 v5, s[42:43]
    v_add_u32 v5, 32768, v5
    ds_read_b128 v[16:19], v10 offset:16384
    ds_read_b128 v[20:23], v10 offset:20480
    ds_read_b128 v[24:27], v10 offset:24576
    ds_read_b128 v[28:31], v10 offset:28672
    ds_read_b64_tr_b16 v[32:33], v77 offset:8192
    ds_read_b64_tr_b16 v[34:35], v77 offset:9216
    ds_read_b64_tr_b16 v[36:37], v77 offset:24576
    ds_read_b64_tr_b16 v[38:39], v77 offset:25600
    ds_read_b64_tr_b16 v[40:41], v77 offset:40960
    ds_read_b64_tr_b16 v[42:43], v77 offset:41984
    s_waitcnt lgkmcnt(10)
    v_mfma_f32_32x32x16_bf16 a[0:15], v[64:67], v[48:51], a[0:15]
    v_mfma_f32_32x32x16_bf16 a[16:31], v[64:67], v[52:55], a[16:31]
    s_mov_b32 m0, s61
    s_add_u32 s61, s61, 1024
    global_load_lds_dwordx4 v5, s[42:43]
    v_add_u32 v5, 32768, v5
    v_mfma_f32_32x32x16_bf16 a[32:47], v[64:67], v[56:59], a[32:47]
    v_mfma_f32_32x32x16_bf16 a[48:63], v[64:67], v[60:63], a[48:63]
    s_mov_b32 m0, s61
    s_add_u32 s61, s61, 13312
    global_load_lds_dwordx4 v5, s[42:43]
    v_mov_b32 v5, v4
    v_mfma_f32_32x32x16_bf16 a[64:79], v[68:71], v[48:51], a[64:79]
    v_mfma_f32_32x32x16_bf16 a[80:95], v[68:71], v[52:55], a[80:95]
    s_mov_b32 m0, s61
    s_add_u32 s61, s61, 1024
    global_load_lds_dwordx4 v5, s[44:45]
    v_add_u32 v5, 32768, v5
    v_mfma_f32_32x32x16_bf16 a[96:111], v[68:71], v[56:59], a[96:111]
    v_mfma_f32_32x32x16_bf16 a[112:127], v[68:71], v[60:63], a[112:127]
    s_mov_b32 m0, s61
    s_add_u32 s61, s61, 1024
    global_load_lds_dwordx4 v5, s[44:45]
    v_add_u32 v5, 32768, v5
    v_mfma_f32_32x32x16_bf16 a[128:143], v[48:51], v[72:75], a[128:143]
    v_mfma_f32_32x32x16_bf16 a[144:159], v[52:55], v[72:75], a[144:159]
    s_mov_b32 m0, s61
    s_add_u32 s61, s61, 1024
    global_load_lds_dwordx4 v5, s[44:45]
    v_add_u32 v5, 32768, v5
    v_mfma_f32_32x32x16_bf16 a[160:175], v[56:59], v[72:75], a[160:175]
    v_mfma_f32_32x32x16_bf16 a[176:191], v[60:63], v[72:75], a[176:191]
    s_mov_b32 m0, s61
    s_add_u32 s61, s61, 13312
    global_load_lds_dwordx4 v5, s[44:45]
    v_mov_b32 v5, v4
    ds_read_b128 v[48:51], v11 offset:16384
    ds_read_b128 v[52:55], v11 offset:20480
    ds_read_b128 v[56:59], v11 offset:24576
    ds_read_b128 v[60:63], v11 offset:28672
    ds_read_b64_tr_b16 v[64:65], v77 offset:12288
    ds_read_b64_tr_b16 v[66:67], v77 offset:13312
    ds_read_b64_tr_b16 v[68:69], v77 offset:28672
    ds_read_b64_tr_b16 v[70:71], v77 offset:29696
    ds_read_b64_tr_b16 v[72:73], v77 offset:45056
    ds_read_b64_tr_b16 v[74:75], v77 offset:46080
    s_waitcnt lgkmcnt(10)
    v_mfma_f32_32x32x16_bf16 a[0:15], v[32:35], v[16:19], a[0:15]
    v_mfma_f32_32x32x16_bf16 a[16:31], v[32:35], v[20:23], a[16:31]
    s_mov_b32 m0, s61
    s_add_u32 s61, s61, 1024
    global_load_lds_dwordx4 v5, s[46:47]
    v_add_u32 v5, 32768, v5
    v_mfma_f32_32x32x16_bf16 a[32:47], v[32:35], v[24:27], a[32:47]
    v_mfma_f32_32x32x16_bf16 a[48:63], v[32:35], v[28:31], a[48:63]
    s_mov_b32 m0, s61
    s_add_u32 s61, s61, 1024
    global_load_lds_dwordx4 v5, s[46:47]
    v_add_u32 v5, 32768, v5
    v_mfma_f32_32x32x16_bf16 a[64:79], v[36:39], v[16:19], a[64:79]
    v_mfma_f32_32x32x16_bf16 a[80:95], v[36:39], v[20:23], a[80:95]
    s_mov_b32 m0, s61
    s_add_u32 s61, s61, 1024
    global_load_lds_dwordx4 v5, s[46:47]
    v_add_u32 v5, 32768, v5
    v_mfma_f32_32x32x16_bf16 a[96:111], v[36:39], v[24:27], a[96:111]
    v_mfma_f32_32x32x16_bf16 a[112:127], v[36:39], v[28:31], a[112:127]
    s_mov_b32 m0, s61
    s_add_u32 s61, s61, 13312
    global_load_lds_dwordx4 v5, s[46:47]
    v_mov_b32 v5, v4
    v_add_u32 v3, 128, v3
    v_add_u32 v4, 524288, v4
    v_mfma_f32_32x32x16_bf16 a[128:143], v[16:19], v[40:43], a[128:143]
    v_mfma_f32_32x32x16_bf16 a[144:159], v[20:23], v[40:43], a[144:159]
    v_mfma_f32_32x32x16_bf16 a[160:175], v[24:27], v[40:43], a[160:175]
    v_mfma_f32_32x32x16_bf16 a[176:191], v[28:31], v[40:43], a[176:191]
    s_waitcnt lgkmcnt(0)
    v_mfma_f32_32x32x16_bf16 a[0:15], v[64:67], v[48:51], a[0:15]
    v_mfma_f32_32x32x16_bf16 a[16:31], v[64:67], v[52:55], a[16:31]
    v_mfma_f32_32x32x16_bf16 a[32:47], v[64:67], v[56:59], a[32:47]
    v_mfma_f32_32x32x16_bf16 a[48:63], v[64:67], v[60:63], a[48:63]
    v_mfma_f32_32x32x16_bf16 a[64:79], v[68:71], v[48:51], a[64:79]
    v_mfma_f32_32x32x16_bf16 a[80:95], v[68:71], v[52:55], a[80:95]
    v_mfma_f32_32x32x16_bf16 a[96:111], v[68:71], v[56:59], a[96:111]
    v_mfma_f32_32x32x16_bf16 a[112:127], v[68:71], v[60:63], a[112:127]
    v_mfma_f32_32x32x16_bf16 a[128:143], v[48:51], v[72:75], a[128:143]
    v_mfma_f32_32x32x16_bf16 a[144:159], v[52:55], v[72:75], a[144:159]
    v_mfma_f32_32x32x16_bf16 a[160:175], v[56:59], v[72:75], a[160:175]
    v_mfma_f32_32x32x16_bf16 a[176:191], v[60:63], v[72:75], a[176:191]
    s_waitcnt vmcnt(0)
    s_barrier
    ds_read_b128 v[16:19], v8 offset:0
    ds_read_b128 v[20:23], v8 offset:4096
    ds_read_b128 v[24:27], v8 offset:8192
    ds_read_b128 v[28:31], v8 offset:12288
    ds_read_b64_tr_b16 v[32:33], v76 offset:0
    ds_read_b64_tr_b16 v[34:35], v76 offset:1024
    ds_read_b64_tr_b16 v[36:37], v76 offset:16384
    ds_read_b64_tr_b16 v[38:39], v76 offset:17408
    ds_read_b64_tr_b16 v[40:41], v76 offset:32768
    ds_read_b64_tr_b16 v[42:43], v76 offset:33792
    ds_read_b128 v[48:51], v9 offset:0
    ds_read_b128 v[52:55], v9 offset:4096
    ds_read_b128 v[56:59], v9 offset:8192
    ds_read_b128 v[60:63], v9 offset:12288
    ds_read_b64_tr_b16 v[64:65], v76 offset:4096
    ds_read_b64_tr_b16 v[66:67], v76 offset:5120
    ds_read_b64_tr_b16 v[68:69], v76 offset:20480
    ds_read_b64_tr_b16 v[70:71], v76 offset:21504
    ds_read_b64_tr_b16 v[72:73], v76 offset:36864
    ds_read_b64_tr_b16 v[74:75], v76 offset:37888
    s_waitcnt lgkmcnt(10)
    v_mfma_f32_32x32x16_bf16 a[0:15], v[32:35], v[16:19], a[0:15]
    v_mfma_f32_32x32x16_bf16 a[16:31], v[32:35], v[20:23], a[16:31]
    v_mfma_f32_32x32x16_bf16 a[32:47], v[32:35], v[24:27], a[32:47]
    v_mfma_f32_32x32x16_bf16 a[48:63], v[32:35], v[28:31], a[48:63]
    v_mfma_f32_32x32x16_bf16 a[64:79], v[36:39], v[16:19], a[64:79]
    v_mfma_f32_32x32x16_bf16 a[80:95], v[36:39], v[20:23], a[80:95]
    v_mfma_f32_32x32x16_bf16 a[96:111], v[36:39], v[24:27], a[96:111]
    v_mfma_f32_32x32x16_bf16 a[112:127], v[36:39], v[28:31], a[112:127]
    v_mfma_f32_32x32x16_bf16 a[128:143], v[16:19], v[40:43], a[128:143]
    v_mfma_f32_32x32x16_bf16 a[144:159], v[20:23], v[40:43], a[144:159]
    v_mfma_f32_32x32x16_bf16 a[160:175], v[24:27], v[40:43], a[160:175]
    v_mfma_f32_32x32x16_bf16 a[176:191], v[28:31], v[40:43], a[176:191]
    ds_read_b128 v[16:19], v10 offset:0
    ds_read_b128 v[20:23], v10 offset:4096
    ds_read_b128 v[24:27], v10 offset:8192
    ds_read_b128 v[28:31], v10 offset:12288
    ds_read_b64_tr_b16 v[32:33], v76 offset:8192
    ds_read_b64_tr_b16 v[34:35], v76 offset:9216
    ds_read_b64_tr_b16 v[36:37], v76 offset:24576
    ds_read_b64_tr_b16 v[38:39], v76 offset:25600
    ds_read_b64_tr_b16 v[40:41], v76 offset:40960
    ds_read_b64_tr_b16 v[42:43], v76 offset:41984
    s_waitcnt lgkmcnt(10)
    v_mfma_f32_32x32x16_bf16 a[0:15], v[64:67], v[48:51], a[0:15]
    v_mfma_f32_32x32x16_bf16 a[16:31], v[64:67], v[52:55], a[16:31]
    v_mfma_f32_32x32x16_bf16 a[32:47], v[64:67], v[56:59], a[32:47]
    v_mfma_f32_32x32x16_bf16 a[48:63], v[64:67], v[60:63], a[48:63]
    v_mfma_f32_32x32x16_bf16 a[64:79], v[68:71], v[48:51], a[64:79]
    v_mfma_f32_32x32x16_bf16 a[80:95], v[68:71], v[52:55], a[80:95]
    v_mfma_f32_32x32x16_bf16 a[96:111], v[68:71], v[56:59], a[96:111]
    v_mfma_f32_32x32x16_bf16 a[112:127], v[68:71], v[60:63], a[112:127]
    v_mfma_f32_32x32x16_bf16 a[128:143], v[48:51], v[72:75], a[128:143]
    v_mfma_f32_32x32x16_bf16 a[144:159], v[52:55], v[72:75], a[144:159]
    v_mfma_f32_32x32x16_bf16 a[160:175], v[56:59], v[72:75], a[160:175]
    v_mfma_f32_32x32x16_bf16 a[176:191], v[60:63], v[72:75], a[176:191]
    ds_read_b128 v[48:51], v11 offset:0
    ds_read_b128 v[52:55], v11 offset:4096
    ds_read_b128 v[56:59], v11 offset:8192
    ds_read_b128 v[60:63], v11 offset:12288
    ds_read_b64_tr_b16 v[64:65], v76 offset:12288
    ds_read_b64_tr_b16 v[66:67], v76 offset:13312
    ds_read_b64_tr_b16 v[68:69], v76 offset:28672
    ds_read_b64_tr_b16 v[70:71], v76 offset:29696
    ds_read_b64_tr_b16 v[72:73], v76 offset:45056
    ds_read_b64_tr_b16 v[74:75], v76 offset:46080
    s_waitcnt lgkmcnt(10)
    v_mfma_f32_32x32x16_bf16 a[0:15], v[32:35], v[16:19], a[0:15]
    v_mfma_f32_32x32x16_bf16 a[16:31], v[32:35], v[20:23], a[16:31]
    v_mfma_f32_32x32x16_bf16 a[32:47], v[32:35], v[24:27], a[32:47]
    v_mfma_f32_32x32x16_bf16 a[48:63], v[32:35], v[28:31], a[48:63]
    v_mfma_f32_32x32x16_bf16 a[64:79], v[36:39], v[16:19], a[64:79]
    v_mfma_f32_32x32x16_bf16 a[80:95], v[36:39], v[20:23], a[80:95]
    v_mfma_f32_32x32x16_bf16 a[96:111], v[36:39], v[24:27], a[96:111]
    v_mfma_f32_32x32x16_bf16 a[112:127], v[36:39], v[28:31], a[112:127]
    v_mfma_f32_32x32x16_bf16 a[128:143], v[16:19], v[40:43], a[128:143]
    v_mfma_f32_32x32x16_bf16 a[144:159], v[20:23], v[40:43], a[144:159]
    v_mfma_f32_32x32x16_bf16 a[160:175], v[24:27], v[40:43], a[160:175]
    v_mfma_f32_32x32x16_bf16 a[176:191], v[28:31], v[40:43], a[176:191]
    s_waitcnt lgkmcnt(0)
    v_mfma_f32_32x32x16_bf16 a[0:15], v[64:67], v[48:51], a[0:15]
    v_mfma_f32_32x32x16_bf16 a[16:31], v[64:67], v[52:55], a[16:31]
    v_mfma_f32_32x32x16_bf16 a[32:47], v[64:67], v[56:59], a[32:47]
    v_mfma_f32_32x32x16_bf16 a[48:63], v[64:67], v[60:63], a[48:63]
    v_mfma_f32_32x32x16_bf16 a[64:79], v[68:71], v[48:51], a[64:79]
    v_mfma_f32_32x32x16_bf16 a[80:95], v[68:71], v[52:55], a[80:95]
    v_mfma_f32_32x32x16_bf16 a[96:111], v[68:71], v[56:59], a[96:111]
    v_mfma_f32_32x32x16_bf16 a[112:127], v[68:71], v[60:63], a[112:127]
    v_mfma_f32_32x32x16_bf16 a[128:143], v[48:51], v[72:75], a[128:143]
    v_mfma_f32_32x32x16_bf16 a[144:159], v[52:55], v[72:75], a[144:159]
    v_mfma_f32_32x32x16_bf16 a[160:175], v[56:59], v[72:75], a[160:175]
    v_mfma_f32_32x32x16_bf16 a[176:191], v[60:63], v[72:75], a[176:191]
    v_lshrrev_b32 v5, 4, v14
    v_lshlrev_b32 v5, 10, v5
    v_and_b32 v6, 15, v14
    v_lshl_add_u32 v5, v6, 4, v5
    v_lshl_add_u32 v5, v12, 8, v5
    s_lshl_b32 s57, s9, 20
    s_lshl_b32 s58, s10, 13
    s_add_u32 s57, s57, s58
    s_lshl_b32 s58, s56, 11
    s_add_u32 s57, s57, s58
    v_add_u32 v5, s57, v5
    s_nop 7
    s_nop 7
    s_mov_b32 s57, 0
    v_accvgpr_read_b32 v16, a64
    v_accvgpr_read_b32 v17, a65
    v_accvgpr_read_b32 v18, a66
    v_accvgpr_read_b32 v19, a67
    v_accvgpr_read_b32 v20, a68
    v_accvgpr_read_b32 v21, a69
    v_accvgpr_read_b32 v22, a70
    v_accvgpr_read_b32 v23, a71
    v_cvt_pk_bf16_f32 v24, v16, v20
    v_cvt_pk_bf16_f32 v25, v17, v21
    v_cvt_pk_bf16_f32 v26, v18, v22
    v_cvt_pk_bf16_f32 v27, v19, v23
    buffer_store_dwordx4 v[24:27], v5, s[52:55], s57 offen offset:0 sc1
    v_accvgpr_read_b32 v28, a72
    v_accvgpr_read_b32 v29, a73
    v_accvgpr_read_b32 v30, a74
    v_accvgpr_read_b32 v31, a75
    v_accvgpr_read_b32 v32, a76
    v_accvgpr_read_b32 v33, a77
    v_accvgpr_read_b32 v34, a78
    v_accvgpr_read_b32 v35, a79
    v_cvt_pk_bf16_f32 v36, v28, v32
    v_cvt_pk_bf16_f32 v37, v29, v33
    v_cvt_pk_bf16_f32 v38, v30, v34
    v_cvt_pk_bf16_f32 v39, v31, v35
    buffer_store_dwordx4 v[36:39], v5, s[52:55], s57 offen offset:512 sc1
    s_mov_b32 s57, 262144
    v_accvgpr_read_b32 v40, a80
    v_accvgpr_read_b32 v41, a81
    v_accvgpr_read_b32 v42, a82
    v_accvgpr_read_b32 v43, a83
    v_accvgpr_read_b32 v44, a84
    v_accvgpr_read_b32 v45, a85
    v_accvgpr_read_b32 v46, a86
    v_accvgpr_read_b32 v47, a87
    v_cvt_pk_bf16_f32 v48, v40, v44
    v_cvt_pk_bf16_f32 v49, v41, v45
    v_cvt_pk_bf16_f32 v50, v42, v46
    v_cvt_pk_bf16_f32 v51, v43, v47
    buffer_store_dwordx4 v[48:51], v5, s[52:55], s57 offen offset:0 sc1
    v_accvgpr_read_b32 v52, a88
    v_accvgpr_read_b32 v53, a89
    v_accvgpr_read_b32 v54, a90
    v_accvgpr_read_b32 v55, a91
    v_accvgpr_read_b32 v56, a92
    v_accvgpr_read_b32 v57, a93
    v_accvgpr_read_b32 v58, a94
    v_accvgpr_read_b32 v59, a95
    v_cvt_pk_bf16_f32 v60, v52, v56
    v_cvt_pk_bf16_f32 v61, v53, v57
    v_cvt_pk_bf16_f32 v62, v54, v58
    v_cvt_pk_bf16_f32 v63, v55, v59
    buffer_store_dwordx4 v[60:63], v5, s[52:55], s57 offen offset:512 sc1
    s_mov_b32 s57, 524288
    v_accvgpr_read_b32 v16, a96
    v_accvgpr_read_b32 v17, a97
    v_accvgpr_read_b32 v18, a98
    v_accvgpr_read_b32 v19, a99
    v_accvgpr_read_b32 v20, a100
    v_accvgpr_read_b32 v21, a101
    v_accvgpr_read_b32 v22, a102
    v_accvgpr_read_b32 v23, a103
    v_cvt_pk_bf16_f32 v24, v16, v20
    v_cvt_pk_bf16_f32 v25, v17, v21
    v_cvt_pk_bf16_f32 v26, v18, v22
    v_cvt_pk_bf16_f32 v27, v19, v23
    buffer_store_dwordx4 v[24:27], v5, s[52:55], s57 offen offset:0 sc1
    v_accvgpr_read_b32 v28, a104
    v_accvgpr_read_b32 v29, a105
    v_accvgpr_read_b32 v30, a106
    v_accvgpr_read_b32 v31, a107
    v_accvgpr_read_b32 v32, a108
    v_accvgpr_read_b32 v33, a109
    v_accvgpr_read_b32 v34, a110
    v_accvgpr_read_b32 v35, a111
    v_cvt_pk_bf16_f32 v36, v28, v32
    v_cvt_pk_bf16_f32 v37, v29, v33
    v_cvt_pk_bf16_f32 v38, v30, v34
    v_cvt_pk_bf16_f32 v39, v31, v35
    buffer_store_dwordx4 v[36:39], v5, s[52:55], s57 offen offset:512 sc1
    s_mov_b32 s57, 786432
    v_accvgpr_read_b32 v40, a112
    v_accvgpr_read_b32 v41, a113
    v_accvgpr_read_b32 v42, a114
    v_accvgpr_read_b32 v43, a115
    v_accvgpr_read_b32 v44, a116
    v_accvgpr_read_b32 v45, a117
    v_accvgpr_read_b32 v46, a118
    v_accvgpr_read_b32 v47, a119
    v_cvt_pk_bf16_f32 v48, v40, v44
    v_cvt_pk_bf16_f32 v49, v41, v45
    v_cvt_pk_bf16_f32 v50, v42, v46
    v_cvt_pk_bf16_f32 v51, v43, v47
    buffer_store_dwordx4 v[48:51], v5, s[52:55], s57 offen offset:0 sc1
    v_accvgpr_read_b32 v52, a120
    v_accvgpr_read_b32 v53, a121
    v_accvgpr_read_b32 v54, a122
    v_accvgpr_read_b32 v55, a123
    v_accvgpr_read_b32 v56, a124
    v_accvgpr_read_b32 v57, a125
    v_accvgpr_read_b32 v58, a126
    v_accvgpr_read_b32 v59, a127
    v_cvt_pk_bf16_f32 v60, v52, v56
    v_cvt_pk_bf16_f32 v61, v53, v57
    v_cvt_pk_bf16_f32 v62, v54, v58
    v_cvt_pk_bf16_f32 v63, v55, v59
    buffer_store_dwordx4 v[60:63], v5, s[52:55], s57 offen offset:512 sc1
    s_mov_b32 s57, 16777216
    v_accvgpr_read_b32 v16, a128
    v_accvgpr_read_b32 v17, a129
    v_accvgpr_read_b32 v18, a130
    v_accvgpr_read_b32 v19, a131
    v_accvgpr_read_b32 v20, a132
    v_accvgpr_read_b32 v21, a133
    v_accvgpr_read_b32 v22, a134
    v_accvgpr_read_b32 v23, a135
    v_cvt_pk_bf16_f32 v24, v16, v17
    v_cvt_pk_bf16_f32 v25, v20, v21
    v_cvt_pk_bf16_f32 v26, v18, v19
    v_cvt_pk_bf16_f32 v27, v22, v23
    buffer_store_dwordx4 v[24:27], v5, s[52:55], s57 offen offset:0 sc1
    v_accvgpr_read_b32 v28, a136
    v_accvgpr_read_b32 v29, a137
    v_accvgpr_read_b32 v30, a138
    v_accvgpr_read_b32 v31, a139
    v_accvgpr_read_b32 v32, a140
    v_accvgpr_read_b32 v33, a141
    v_accvgpr_read_b32 v34, a142
    v_accvgpr_read_b32 v35, a143
    v_cvt_pk_bf16_f32 v36, v28, v29
    v_cvt_pk_bf16_f32 v37, v32, v33
    v_cvt_pk_bf16_f32 v38, v30, v31
    v_cvt_pk_bf16_f32 v39, v34, v35
    buffer_store_dwordx4 v[36:39], v5, s[52:55], s57 offen offset:512 sc1
    s_mov_b32 s57, 17039360
    v_accvgpr_read_b32 v40, a144
    v_accvgpr_read_b32 v41, a145
    v_accvgpr_read_b32 v42, a146
    v_accvgpr_read_b32 v43, a147
    v_accvgpr_read_b32 v44, a148
    v_accvgpr_read_b32 v45, a149
    v_accvgpr_read_b32 v46, a150
    v_accvgpr_read_b32 v47, a151
    v_cvt_pk_bf16_f32 v48, v40, v41
    v_cvt_pk_bf16_f32 v49, v44, v45
    v_cvt_pk_bf16_f32 v50, v42, v43
    v_cvt_pk_bf16_f32 v51, v46, v47
    buffer_store_dwordx4 v[48:51], v5, s[52:55], s57 offen offset:0 sc1
    v_accvgpr_read_b32 v52, a152
    v_accvgpr_read_b32 v53, a153
    v_accvgpr_read_b32 v54, a154
    v_accvgpr_read_b32 v55, a155
    v_accvgpr_read_b32 v56, a156
    v_accvgpr_read_b32 v57, a157
    v_accvgpr_read_b32 v58, a158
    v_accvgpr_read_b32 v59, a159
    v_cvt_pk_bf16_f32 v60, v52, v53
    v_cvt_pk_bf16_f32 v61, v56, v57
    v_cvt_pk_bf16_f32 v62, v54, v55
    v_cvt_pk_bf16_f32 v63, v58, v59
    buffer_store_dwordx4 v[60:63], v5, s[52:55], s57 offen offset:512 sc1
    s_mov_b32 s57, 17301504
    v_accvgpr_read_b32 v16, a160
    v_accvgpr_read_b32 v17, a161
    v_accvgpr_read_b32 v18, a162
    v_accvgpr_read_b32 v19, a163
    v_accvgpr_read_b32 v20, a164
    v_accvgpr_read_b32 v21, a165
    v_accvgpr_read_b32 v22, a166
    v_accvgpr_read_b32 v23, a167
    v_cvt_pk_bf16_f32 v24, v16, v17
    v_cvt_pk_bf16_f32 v25, v20, v21
    v_cvt_pk_bf16_f32 v26, v18, v19
    v_cvt_pk_bf16_f32 v27, v22, v23
    buffer_store_dwordx4 v[24:27], v5, s[52:55], s57 offen offset:0 sc1
    v_accvgpr_read_b32 v28, a168
    v_accvgpr_read_b32 v29, a169
    v_accvgpr_read_b32 v30, a170
    v_accvgpr_read_b32 v31, a171
    v_accvgpr_read_b32 v32, a172
    v_accvgpr_read_b32 v33, a173
    v_accvgpr_read_b32 v34, a174
    v_accvgpr_read_b32 v35, a175
    v_cvt_pk_bf16_f32 v36, v28, v29
    v_cvt_pk_bf16_f32 v37, v32, v33
    v_cvt_pk_bf16_f32 v38, v30, v31
    v_cvt_pk_bf16_f32 v39, v34, v35
    buffer_store_dwordx4 v[36:39], v5, s[52:55], s57 offen offset:512 sc1
    s_mov_b32 s57, 17563648
    v_accvgpr_read_b32 v40, a176
    v_accvgpr_read_b32 v41, a177
    v_accvgpr_read_b32 v42, a178
    v_accvgpr_read_b32 v43, a179
    v_accvgpr_read_b32 v44, a180
    v_accvgpr_read_b32 v45, a181
    v_accvgpr_read_b32 v46, a182
    v_accvgpr_read_b32 v47, a183
    v_cvt_pk_bf16_f32 v48, v40, v41
    v_cvt_pk_bf16_f32 v49, v44, v45
    v_cvt_pk_bf16_f32 v50, v42, v43
    v_cvt_pk_bf16_f32 v51, v46, v47
    buffer_store_dwordx4 v[48:51], v5, s[52:55], s57 offen offset:0 sc1
    v_accvgpr_read_b32 v52, a184
    v_accvgpr_read_b32 v53, a185
    v_accvgpr_read_b32 v54, a186
    v_accvgpr_read_b32 v55, a187
    v_accvgpr_read_b32 v56, a188
    v_accvgpr_read_b32 v57, a189
    v_accvgpr_read_b32 v58, a190
    v_accvgpr_read_b32 v59, a191
    v_cvt_pk_bf16_f32 v60, v52, v53
    v_cvt_pk_bf16_f32 v61, v56, v57
    v_cvt_pk_bf16_f32 v62, v54, v55
    v_cvt_pk_bf16_f32 v63, v58, v59
    buffer_store_dwordx4 v[60:63], v5, s[52:55], s57 offen offset:512 sc1
    s_mov_b32 s57, 33554432
    v_accvgpr_read_b32 v16, a0
    v_accvgpr_read_b32 v17, a1
    v_accvgpr_read_b32 v18, a2
    v_accvgpr_read_b32 v19, a3
    v_accvgpr_read_b32 v20, a4
    v_accvgpr_read_b32 v21, a5
    v_accvgpr_read_b32 v22, a6
    v_accvgpr_read_b32 v23, a7
    v_cvt_pk_bf16_f32 v24, v16, v20
    v_cvt_pk_bf16_f32 v25, v17, v21
    v_cvt_pk_bf16_f32 v26, v18, v22
    v_cvt_pk_bf16_f32 v27, v19, v23
    buffer_store_dwordx4 v[24:27], v5, s[52:55], s57 offen offset:0 sc1
    v_accvgpr_read_b32 v28, a8
    v_accvgpr_read_b32 v29, a9
    v_accvgpr_read_b32 v30, a10
    v_accvgpr_read_b32 v31, a11
    v_accvgpr_read_b32 v32, a12
    v_accvgpr_read_b32 v33, a13
    v_accvgpr_read_b32 v34, a14
    v_accvgpr_read_b32 v35, a15
    v_cvt_pk_bf16_f32 v36, v28, v32
    v_cvt_pk_bf16_f32 v37, v29, v33
    v_cvt_pk_bf16_f32 v38, v30, v34
    v_cvt_pk_bf16_f32 v39, v31, v35
    buffer_store_dwordx4 v[36:39], v5, s[52:55], s57 offen offset:512 sc1
    s_mov_b32 s57, 33816576
    v_accvgpr_read_b32 v40, a16
    v_accvgpr_read_b32 v41, a17
    v_accvgpr_read_b32 v42, a18
    v_accvgpr_read_b32 v43, a19
    v_accvgpr_read_b32 v44, a20
    v_accvgpr_read_b32 v45, a21
    v_accvgpr_read_b32 v46, a22
    v_accvgpr_read_b32 v47, a23
    v_cvt_pk_bf16_f32 v48, v40, v44
    v_cvt_pk_bf16_f32 v49, v41, v45
    v_cvt_pk_bf16_f32 v50, v42, v46
    v_cvt_pk_bf16_f32 v51, v43, v47
    buffer_store_dwordx4 v[48:51], v5, s[52:55], s57 offen offset:0 sc1
    v_accvgpr_read_b32 v52, a24
    v_accvgpr_read_b32 v53, a25
    v_accvgpr_read_b32 v54, a26
    v_accvgpr_read_b32 v55, a27
    v_accvgpr_read_b32 v56, a28
    v_accvgpr_read_b32 v57, a29
    v_accvgpr_read_b32 v58, a30
    v_accvgpr_read_b32 v59, a31
    v_cvt_pk_bf16_f32 v60, v52, v56
    v_cvt_pk_bf16_f32 v61, v53, v57
    v_cvt_pk_bf16_f32 v62, v54, v58
    v_cvt_pk_bf16_f32 v63, v55, v59
    buffer_store_dwordx4 v[60:63], v5, s[52:55], s57 offen offset:512 sc1
    s_mov_b32 s57, 34078720
    v_accvgpr_read_b32 v16, a32
    v_accvgpr_read_b32 v17, a33
    v_accvgpr_read_b32 v18, a34
    v_accvgpr_read_b32 v19, a35
    v_accvgpr_read_b32 v20, a36
    v_accvgpr_read_b32 v21, a37
    v_accvgpr_read_b32 v22, a38
    v_accvgpr_read_b32 v23, a39
    v_cvt_pk_bf16_f32 v24, v16, v20
    v_cvt_pk_bf16_f32 v25, v17, v21
    v_cvt_pk_bf16_f32 v26, v18, v22
    v_cvt_pk_bf16_f32 v27, v19, v23
    buffer_store_dwordx4 v[24:27], v5, s[52:55], s57 offen offset:0 sc1
    v_accvgpr_read_b32 v28, a40
    v_accvgpr_read_b32 v29, a41
    v_accvgpr_read_b32 v30, a42
    v_accvgpr_read_b32 v31, a43
    v_accvgpr_read_b32 v32, a44
    v_accvgpr_read_b32 v33, a45
    v_accvgpr_read_b32 v34, a46
    v_accvgpr_read_b32 v35, a47
    v_cvt_pk_bf16_f32 v36, v28, v32
    v_cvt_pk_bf16_f32 v37, v29, v33
    v_cvt_pk_bf16_f32 v38, v30, v34
    v_cvt_pk_bf16_f32 v39, v31, v35
    buffer_store_dwordx4 v[36:39], v5, s[52:55], s57 offen offset:512 sc1
    s_mov_b32 s57, 34340864
    v_accvgpr_read_b32 v40, a48
    v_accvgpr_read_b32 v41, a49
    v_accvgpr_read_b32 v42, a50
    v_accvgpr_read_b32 v43, a51
    v_accvgpr_read_b32 v44, a52
    v_accvgpr_read_b32 v45, a53
    v_accvgpr_read_b32 v46, a54
    v_accvgpr_read_b32 v47, a55
    v_cvt_pk_bf16_f32 v48, v40, v44
    v_cvt_pk_bf16_f32 v49, v41, v45
    v_cvt_pk_bf16_f32 v50, v42, v46
    v_cvt_pk_bf16_f32 v51, v43, v47
    buffer_store_dwordx4 v[48:51], v5, s[52:55], s57 offen offset:0 sc1
    v_accvgpr_read_b32 v52, a56
    v_accvgpr_read_b32 v53, a57
    v_accvgpr_read_b32 v54, a58
    v_accvgpr_read_b32 v55, a59
    v_accvgpr_read_b32 v56, a60
    v_accvgpr_read_b32 v57, a61
    v_accvgpr_read_b32 v58, a62
    v_accvgpr_read_b32 v59, a63
    v_cvt_pk_bf16_f32 v60, v52, v56
    v_cvt_pk_bf16_f32 v61, v53, v57
    v_cvt_pk_bf16_f32 v62, v54, v58
    v_cvt_pk_bf16_f32 v63, v55, v59
    buffer_store_dwordx4 v[60:63], v5, s[52:55], s57 offen offset:512 sc1
    s_waitcnt vmcnt(0)
    s_barrier
    s_and_b32 s12, s9, 3
    s_lshl_b32 s12, s12, 3
    s_lshl_b32 s12, 1, s12
    s_and_b32 s13, s9, 0xfc
    v_mov_b32 v1, s13
    v_mov_b32 v2, s12
    v_cmp_eq_u32 vcc, 0, v0
    s_nop 0
    s_and_saveexec_b64 s[6:7], vcc
    s_cbranch_execz L_fetch_r
    global_atomic_add v1, v2, s[4:5] offset:32
    s_mov_b64 exec, -1
    s_branch L_fetch
L_gate:
    s_sub_u32 s9, s8, 288
    s_load_dwordx2 s[40:41], s[0:1], 0
    s_load_dwordx2 s[42:43], s[0:1], 128
    s_load_dwordx2 s[44:45], s[0:1], 152
    v_lshrrev_b32 v1, 3, v0
    v_and_b32 v2, 7, v0
    s_lshl_b32 s52, s9, 5
    v_add_u32 v1, s52, v1
    v_mul_u32_u24 v3, 1152, v1
    v_lshl_add_u32 v3, v2, 4, v3
    v_lshlrev_b32 v4, 4, v2
    s_waitcnt lgkmcnt(0)
    s_mov_b32 s48, s44
    s_mov_b32 s49, s45
    s_mov_b32 s50, 268435456
    s_mov_b32 s51, 0x00020000
    global_load_dwordx4 v[16:19], v3, s[40:41] offset:0
    global_load_dwordx4 v[56:59], v4, s[42:43] offset:0
    global_load_dwordx4 v[20:23], v3, s[40:41] offset:128
    global_load_dwordx4 v[60:63], v4, s[42:43] offset:128
    global_load_dwordx4 v[24:27], v3, s[40:41] offset:256
    global_load_dwordx4 v[64:67], v4, s[42:43] offset:256
    global_load_dwordx4 v[28:31], v3, s[40:41] offset:384
    global_load_dwordx4 v[68:71], v4, s[42:43] offset:384
    global_load_dwordx4 v[32:35], v3, s[40:41] offset:512
    global_load_dwordx4 v[72:75], v4, s[42:43] offset:512
    global_load_dwordx4 v[36:39], v3, s[40:41] offset:640
    global_load_dwordx4 v[76:79], v4, s[42:43] offset:640
    global_load_dwordx4 v[40:43], v3, s[40:41] offset:768
    global_load_dwordx4 v[80:83], v4, s[42:43] offset:768
    global_load_dwordx4 v[44:47], v3, s[40:41] offset:896
    global_load_dwordx4 v[84:87], v4, s[42:43] offset:896
    global_load_dwordx4 v[48:51], v3, s[40:41] offset:1024
    global_load_dwordx4 v[88:91], v4, s[42:43] offset:1024
    v_mov_b32 v5, 0
    s_waitcnt vmcnt(0)
    v_lshlrev_b32 v6, 16, v16
    v_and_b32 v7, 0xffff0000, v16
    v_lshlrev_b32 v8, 16, v56
    v_and_b32 v9, 0xffff0000, v56
    v_mul_f32 v6, v6, v8
    v_mul_f32 v7, v7, v9
    v_cvt_pk_bf16_f32 v6, v6, v7
    v_lshlrev_b32 v7, 16, v6
    v_and_b32 v6, 0xffff0000, v6
    v_add_f32 v5, v5, v7
    v_add_f32 v5, v5, v6
    v_lshlrev_b32 v6, 16, v17
    v_and_b32 v7, 0xffff0000, v17
    v_lshlrev_b32 v8, 16, v57
    v_and_b32 v9, 0xffff0000, v57
    v_mul_f32 v6, v6, v8
    v_mul_f32 v7, v7, v9
    v_cvt_pk_bf16_f32 v6, v6, v7
    v_lshlrev_b32 v7, 16, v6
    v_and_b32 v6, 0xffff0000, v6
    v_add_f32 v5, v5, v7
    v_add_f32 v5, v5, v6
    v_lshlrev_b32 v6, 16, v18
    v_and_b32 v7, 0xffff0000, v18
    v_lshlrev_b32 v8, 16, v58
    v_and_b32 v9, 0xffff0000, v58
    v_mul_f32 v6, v6, v8
    v_mul_f32 v7, v7, v9
    v_cvt_pk_bf16_f32 v6, v6, v7
    v_lshlrev_b32 v7, 16, v6
    v_and_b32 v6, 0xffff0000, v6
    v_add_f32 v5, v5, v7
    v_add_f32 v5, v5, v6
    v_lshlrev_b32 v6, 16, v19
    v_and_b32 v7, 0xffff0000, v19
    v_lshlrev_b32 v8, 16, v59
    v_and_b32 v9, 0xffff0000, v59
    v_mul_f32 v6, v6, v8
    v_mul_f32 v7, v7, v9
    v_cvt_pk_bf16_f32 v6, v6, v7
    v_lshlrev_b32 v7, 16, v6
    v_and_b32 v6, 0xffff0000, v6
    v_add_f32 v5, v5, v7
    v_add_f32 v5, v5, v6
    v_lshlrev_b32 v6, 16, v20
    v_and_b32 v7, 0xffff0000, v20
    v_lshlrev_b32 v8, 16, v60
    v_and_b32 v9, 0xffff0000, v60
    v_mul_f32 v6, v6, v8
    v_mul_f32 v7, v7, v9
    v_cvt_pk_bf16_f32 v6, v6, v7
    v_lshlrev_b32 v7, 16, v6
    v_and_b32 v6, 0xffff0000, v6
    v_add_f32 v5, v5, v7
    v_add_f32 v5, v5, v6
    v_lshlrev_b32 v6, 16, v21
    v_and_b32 v7, 0xffff0000, v21
    v_lshlrev_b32 v8, 16, v61
    v_and_b32 v9, 0xffff0000, v61
    v_mul_f32 v6, v6, v8
    v_mul_f32 v7, v7, v9
    v_cvt_pk_bf16_f32 v6, v6, v7
    v_lshlrev_b32 v7, 16, v6
    v_and_b32 v6, 0xffff0000, v6
    v_add_f32 v5, v5, v7
    v_add_f32 v5, v5, v6
    v_lshlrev_b32 v6, 16, v22
    v_and_b32 v7, 0xffff0000, v22
    v_lshlrev_b32 v8, 16, v62
    v_and_b32 v9, 0xffff0000, v62
    v_mul_f32 v6, v6, v8
    v_mul_f32 v7, v7, v9
    v_cvt_pk_bf16_f32 v6, v6, v7
    v_lshlrev_b32 v7, 16, v6
    v_and_b32 v6, 0xffff0000, v6
    v_add_f32 v5, v5, v7
    v_add_f32 v5, v5, v6
    v_lshlrev_b32 v6, 16, v23
    v_and_b32 v7, 0xffff0000, v23
    v_lshlrev_b32 v8, 16, v63
    v_and_b32 v9, 0xffff0000, v63
    v_mul_f32 v6, v6, v8
    v_mul_f32 v7, v7, v9
    v_cvt_pk_bf16_f32 v6, v6, v7
    v_lshlrev_b32 v7, 16, v6
    v_and_b32 v6, 0xffff0000, v6
    v_add_f32 v5, v5, v7
    v_add_f32 v5, v5, v6
    v_lshlrev_b32 v6, 16, v24
    v_and_b32 v7, 0xffff0000, v24
    v_lshlrev_b32 v8, 16, v64
    v_and_b32 v9, 0xffff0000, v64
    v_mul_f32 v6, v6, v8
    v_mul_f32 v7, v7, v9
    v_cvt_pk_bf16_f32 v6, v6, v7
    v_lshlrev_b32 v7, 16, v6
    v_and_b32 v6, 0xffff0000, v6
    v_add_f32 v5, v5, v7
    v_add_f32 v5, v5, v6
    v_lshlrev_b32 v6, 16, v25
    v_and_b32 v7, 0xffff0000, v25
    v_lshlrev_b32 v8, 16, v65
    v_and_b32 v9, 0xffff0000, v65
    v_mul_f32 v6, v6, v8
    v_mul_f32 v7, v7, v9
    v_cvt_pk_bf16_f32 v6, v6, v7
    v_lshlrev_b32 v7, 16, v6
    v_and_b32 v6, 0xffff0000, v6
    v_add_f32 v5, v5, v7
    v_add_f32 v5, v5, v6
    v_lshlrev_b32 v6, 16, v26
    v_and_b32 v7, 0xffff0000, v26
    v_lshlrev_b32 v8, 16, v66
    v_and_b32 v9, 0xffff0000, v66
    v_mul_f32 v6, v6, v8
    v_mul_f32 v7, v7, v9
    v_cvt_pk_bf16_f32 v6, v6, v7
    v_lshlrev_b32 v7, 16, v6
    v_and_b32 v6, 0xffff0000, v6
    v_add_f32 v5, v5, v7
    v_add_f32 v5, v5, v6
    v_lshlrev_b32 v6, 16, v27
    v_and_b32 v7, 0xffff0000, v27
    v_lshlrev_b32 v8, 16, v67
    v_and_b32 v9, 0xffff0000, v67
    v_mul_f32 v6, v6, v8
    v_mul_f32 v7, v7, v9
    v_cvt_pk_bf16_f32 v6, v6, v7
    v_lshlrev_b32 v7, 16, v6
    v_and_b32 v6, 0xffff0000, v6
    v_add_f32 v5, v5, v7
    v_add_f32 v5, v5, v6
    v_lshlrev_b32 v6, 16, v28
    v_and_b32 v7, 0xffff0000, v28
    v_lshlrev_b32 v8, 16, v68
    v_and_b32 v9, 0xffff0000, v68
    v_mul_f32 v6, v6, v8
    v_mul_f32 v7, v7, v9
    v_cvt_pk_bf16_f32 v6, v6, v7
    v_lshlrev_b32 v7, 16, v6
    v_and_b32 v6, 0xffff0000, v6
    v_add_f32 v5, v5, v7
    v_add_f32 v5, v5, v6
    v_lshlrev_b32 v6, 16, v29
    v_and_b32 v7, 0xffff0000, v29
    v_lshlrev_b32 v8, 16, v69
    v_and_b32 v9, 0xffff0000, v69
    v_mul_f32 v6, v6, v8
    v_mul_f32 v7, v7, v9
    v_cvt_pk_bf16_f32 v6, v6, v7
    v_lshlrev_b32 v7, 16, v6
    v_and_b32 v6, 0xffff0000, v6
    v_add_f32 v5, v5, v7
    v_add_f32 v5, v5, v6
    v_lshlrev_b32 v6, 16, v30
    v_and_b32 v7, 0xffff0000, v30
    v_lshlrev_b32 v8, 16, v70
    v_and_b32 v9, 0xffff0000, v70
    v_mul_f32 v6, v6, v8
    v_mul_f32 v7, v7, v9
    v_cvt_pk_bf16_f32 v6, v6, v7
    v_lshlrev_b32 v7, 16, v6
    v_and_b32 v6, 0xffff0000, v6
    v_add_f32 v5, v5, v7
    v_add_f32 v5, v5, v6
    v_lshlrev_b32 v6, 16, v31
    v_and_b32 v7, 0xffff0000, v31
    v_lshlrev_b32 v8, 16, v71
    v_and_b32 v9, 0xffff0000, v71
    v_mul_f32 v6, v6, v8
    v_mul_f32 v7, v7, v9
    v_cvt_pk_bf16_f32 v6, v6, v7
    v_lshlrev_b32 v7, 16, v6
    v_and_b32 v6, 0xffff0000, v6
    v_add_f32 v5, v5, v7
    v_add_f32 v5, v5, v6
    v_lshlrev_b32 v6, 16, v32
    v_and_b32 v7, 0xffff0000, v32
    v_lshlrev_b32 v8, 16, v72
    v_and_b32 v9, 0xffff0000, v72
    v_mul_f32 v6, v6, v8
    v_mul_f32 v7, v7, v9
    v_cvt_pk_bf16_f32 v6, v6, v7
    v_lshlrev_b32 v7, 16, v6
    v_and_b32 v6, 0xffff0000, v6
    v_add_f32 v5, v5, v7
    v_add_f32 v5, v5, v6
    v_lshlrev_b32 v6, 16, v33
    v_and_b32 v7, 0xffff0000, v33
    v_lshlrev_b32 v8, 16, v73
    v_and_b32 v9, 0xffff0000, v73
    v_mul_f32 v6, v6, v8
    v_mul_f32 v7, v7, v9
    v_cvt_pk_bf16_f32 v6, v6, v7
    v_lshlrev_b32 v7, 16, v6
    v_and_b32 v6, 0xffff0000, v6
    v_add_f32 v5, v5, v7
    v_add_f32 v5, v5, v6
    v_lshlrev_b32 v6, 16, v34
    v_and_b32 v7, 0xffff0000, v34
    v_lshlrev_b32 v8, 16, v74
    v_and_b32 v9, 0xffff0000, v74
    v_mul_f32 v6, v6, v8
    v_mul_f32 v7, v7, v9
    v_cvt_pk_bf16_f32 v6, v6, v7
    v_lshlrev_b32 v7, 16, v6
    v_and_b32 v6, 0xffff0000, v6
    v_add_f32 v5, v5, v7
    v_add_f32 v5, v5, v6
    v_lshlrev_b32 v6, 16, v35
    v_and_b32 v7, 0xffff0000, v35
    v_lshlrev_b32 v8, 16, v75
    v_and_b32 v9, 0xffff0000, v75
    v_mul_f32 v6, v6, v8
    v_mul_f32 v7, v7, v9
    v_cvt_pk_bf16_f32 v6, v6, v7
    v_lshlrev_b32 v7, 16, v6
    v_and_b32 v6, 0xffff0000, v6
    v_add_f32 v5, v5, v7
    v_add_f32 v5, v5, v6
    v_lshlrev_b32 v6, 16, v36
    v_and_b32 v7, 0xffff0000, v36
    v_lshlrev_b32 v8, 16, v76
    v_and_b32 v9, 0xffff0000, v76
    v_mul_f32 v6, v6, v8
    v_mul_f32 v7, v7, v9
    v_cvt_pk_bf16_f32 v6, v6, v7
    v_lshlrev_b32 v7, 16, v6
    v_and_b32 v6, 0xffff0000, v6
    v_add_f32 v5, v5, v7
    v_add_f32 v5, v5, v6
    v_lshlrev_b32 v6, 16, v37
    v_and_b32 v7, 0xffff0000, v37
    v_lshlrev_b32 v8, 16, v77
    v_and_b32 v9, 0xffff0000, v77
    v_mul_f32 v6, v6, v8
    v_mul_f32 v7, v7, v9
    v_cvt_pk_bf16_f32 v6, v6, v7
    v_lshlrev_b32 v7, 16, v6
    v_and_b32 v6, 0xffff0000, v6
    v_add_f32 v5, v5, v7
    v_add_f32 v5, v5, v6
    v_lshlrev_b32 v6, 16, v38
    v_and_b32 v7, 0xffff0000, v38
    v_lshlrev_b32 v8, 16, v78
    v_and_b32 v9, 0xffff0000, v78
    v_mul_f32 v6, v6, v8
    v_mul_f32 v7, v7, v9
    v_cvt_pk_bf16_f32 v6, v6, v7
    v_lshlrev_b32 v7, 16, v6
    v_and_b32 v6, 0xffff0000, v6
    v_add_f32 v5, v5, v7
    v_add_f32 v5, v5, v6
    v_lshlrev_b32 v6, 16, v39
    v_and_b32 v7, 0xffff0000, v39
    v_lshlrev_b32 v8, 16, v79
    v_and_b32 v9, 0xffff0000, v79
    v_mul_f32 v6, v6, v8
    v_mul_f32 v7, v7, v9
    v_cvt_pk_bf16_f32 v6, v6, v7
    v_lshlrev_b32 v7, 16, v6
    v_and_b32 v6, 0xffff0000, v6
    v_add_f32 v5, v5, v7
    v_add_f32 v5, v5, v6
    v_lshlrev_b32 v6, 16, v40
    v_and_b32 v7, 0xffff0000, v40
    v_lshlrev_b32 v8, 16, v80
    v_and_b32 v9, 0xffff0000, v80
    v_mul_f32 v6, v6, v8
    v_mul_f32 v7, v7, v9
    v_cvt_pk_bf16_f32 v6, v6, v7
    v_lshlrev_b32 v7, 16, v6
    v_and_b32 v6, 0xffff0000, v6
    v_add_f32 v5, v5, v7
    v_add_f32 v5, v5, v6
    v_lshlrev_b32 v6, 16, v41
    v_and_b32 v7, 0xffff0000, v41
    v_lshlrev_b32 v8, 16, v81
    v_and_b32 v9, 0xffff0000, v81
    v_mul_f32 v6, v6, v8
    v_mul_f32 v7, v7, v9
    v_cvt_pk_bf16_f32 v6, v6, v7
    v_lshlrev_b32 v7, 16, v6
    v_and_b32 v6, 0xffff0000, v6
    v_add_f32 v5, v5, v7
    v_add_f32 v5, v5, v6
    v_lshlrev_b32 v6, 16, v42
    v_and_b32 v7, 0xffff0000, v42
    v_lshlrev_b32 v8, 16, v82
    v_and_b32 v9, 0xffff0000, v82
    v_mul_f32 v6, v6, v8
    v_mul_f32 v7, v7, v9
    v_cvt_pk_bf16_f32 v6, v6, v7
    v_lshlrev_b32 v7, 16, v6
    v_and_b32 v6, 0xffff0000, v6
    v_add_f32 v5, v5, v7
    v_add_f32 v5, v5, v6
    v_lshlrev_b32 v6, 16, v43
    v_and_b32 v7, 0xffff0000, v43
    v_lshlrev_b32 v8, 16, v83
    v_and_b32 v9, 0xffff0000, v83
    v_mul_f32 v6, v6, v8
    v_mul_f32 v7, v7, v9
    v_cvt_pk_bf16_f32 v6, v6, v7
    v_lshlrev_b32 v7, 16, v6
    v_and_b32 v6, 0xffff0000, v6
    v_add_f32 v5, v5, v7
    v_add_f32 v5, v5, v6
    v_lshlrev_b32 v6, 16, v44
    v_and_b32 v7, 0xffff0000, v44
    v_lshlrev_b32 v8, 16, v84
    v_and_b32 v9, 0xffff0000, v84
    v_mul_f32 v6, v6, v8
    v_mul_f32 v7, v7, v9
    v_cvt_pk_bf16_f32 v6, v6, v7
    v_lshlrev_b32 v7, 16, v6
    v_and_b32 v6, 0xffff0000, v6
    v_add_f32 v5, v5, v7
    v_add_f32 v5, v5, v6
    v_lshlrev_b32 v6, 16, v45
    v_and_b32 v7, 0xffff0000, v45
    v_lshlrev_b32 v8, 16, v85
    v_and_b32 v9, 0xffff0000, v85
    v_mul_f32 v6, v6, v8
    v_mul_f32 v7, v7, v9
    v_cvt_pk_bf16_f32 v6, v6, v7
    v_lshlrev_b32 v7, 16, v6
    v_and_b32 v6, 0xffff0000, v6
    v_add_f32 v5, v5, v7
    v_add_f32 v5, v5, v6
    v_lshlrev_b32 v6, 16, v46
    v_and_b32 v7, 0xffff0000, v46
    v_lshlrev_b32 v8, 16, v86
    v_and_b32 v9, 0xffff0000, v86
    v_mul_f32 v6, v6, v8
    v_mul_f32 v7, v7, v9
    v_cvt_pk_bf16_f32 v6, v6, v7
    v_lshlrev_b32 v7, 16, v6
    v_and_b32 v6, 0xffff0000, v6
    v_add_f32 v5, v5, v7
    v_add_f32 v5, v5, v6
    v_lshlrev_b32 v6, 16, v47
    v_and_b32 v7, 0xffff0000, v47
    v_lshlrev_b32 v8, 16, v87
    v_and_b32 v9, 0xffff0000, v87
    v_mul_f32 v6, v6, v8
    v_mul_f32 v7, v7, v9
    v_cvt_pk_bf16_f32 v6, v6, v7
    v_lshlrev_b32 v7, 16, v6
    v_and_b32 v6, 0xffff0000, v6
    v_add_f32 v5, v5, v7
    v_add_f32 v5, v5, v6
    v_lshlrev_b32 v6, 16, v48
    v_and_b32 v7, 0xffff0000, v48
    v_lshlrev_b32 v8, 16, v88
    v_and_b32 v9, 0xffff0000, v88
    v_mul_f32 v6, v6, v8
    v_mul_f32 v7, v7, v9
    v_cvt_pk_bf16_f32 v6, v6, v7
    v_lshlrev_b32 v7, 16, v6
    v_and_b32 v6, 0xffff0000, v6
    v_add_f32 v5, v5, v7
    v_add_f32 v5, v5, v6
    v_lshlrev_b32 v6, 16, v49
    v_and_b32 v7, 0xffff0000, v49
    v_lshlrev_b32 v8, 16, v89
    v_and_b32 v9, 0xffff0000, v89
    v_mul_f32 v6, v6, v8
    v_mul_f32 v7, v7, v9
    v_cvt_pk_bf16_f32 v6, v6, v7
    v_lshlrev_b32 v7, 16, v6
    v_and_b32 v6, 0xffff0000, v6
    v_add_f32 v5, v5, v7
    v_add_f32 v5, v5, v6
    v_lshlrev_b32 v6, 16, v50
    v_and_b32 v7, 0xffff0000, v50
    v_lshlrev_b32 v8, 16, v90
    v_and_b32 v9, 0xffff0000, v90
    v_mul_f32 v6, v6, v8
    v_mul_f32 v7, v7, v9
    v_cvt_pk_bf16_f32 v6, v6, v7
    v_lshlrev_b32 v7, 16, v6
    v_and_b32 v6, 0xffff0000, v6
    v_add_f32 v5, v5, v7
    v_add_f32 v5, v5, v6
    v_lshlrev_b32 v6, 16, v51
    v_and_b32 v7, 0xffff0000, v51
    v_lshlrev_b32 v8, 16, v91
    v_and_b32 v9, 0xffff0000, v91
    v_mul_f32 v6, v6, v8
    v_mul_f32 v7, v7, v9
    v_cvt_pk_bf16_f32 v6, v6, v7
    v_lshlrev_b32 v7, 16, v6
    v_and_b32 v6, 0xffff0000, v6
    v_add_f32 v5, v5, v7
    v_add_f32 v5, v5, v6
    s_nop 1
    v_add_f32_dpp v5, v5, v5 quad_perm:[1,0,3,2] row_mask:0xf bank_mask:0xf
    s_nop 1
    v_add_f32_dpp v5, v5, v5 quad_perm:[2,3,0,1] row_mask:0xf bank_mask:0xf
    s_nop 1
    v_add_f32_dpp v5, v5, v5 row_half_mirror row_mask:0xf bank_mask:0xf
    v_cvt_pk_bf16_f32 v5, v5, v5
    v_lshlrev_b32 v5, 16, v5
    v_mul_f32 v5, 0xbfb8aa3b, v5
    v_exp_f32 v5, v5
    s_nop 0
    v_add_f32 v5, 1.0, v5
    v_rcp_f32 v5, v5
    s_nop 0
    v_cvt_pk_bf16_f32 v5, v5, v5
    v_lshlrev_b32 v5, 16, v5
    v_lshlrev_b32 v1, 2, v1
    s_mov_b32 s52, 88080384
    buffer_store_dword v5, v1, s[48:51], s52 offen sc1
    s_waitcnt vmcnt(0)
    s_barrier
    v_mov_b32 v1, 0
    v_mov_b32 v2, 1
    v_cmp_eq_u32 vcc, 0, v0
    s_nop 0
    s_and_saveexec_b64 s[6:7], vcc
    s_cbranch_execz L_fetch_r
    global_atomic_add v1, v2, s[4:5] offset:12
    s_mov_b64 exec, -1
    s_branch L_fetch
L_s4:
    s_sub_u32 s9, s8, 0
    s_load_dwordx2 s[40:41], s[0:1], 0
    s_load_dwordx2 s[42:43], s[0:1], 152
    s_load_dwordx2 s[56:57], s[0:1], 56
    s_load_dwordx2 s[58:59], s[0:1], 64
    s_load_dwordx2 s[44:45], s[0:1], 8
    s_load_dwordx2 s[46:47], s[0:1], 16
    s_load_dwordx2 s[48:49], s[0:1], 24
    s_load_dwordx2 s[50:51], s[0:1], 32
    s_load_dwordx2 s[52:53], s[0:1], 40
    s_load_dwordx2 s[54:55], s[0:1], 48
    v_lshrrev_b32 v1, 6, v0
    v_and_b32 v2, 63, v0
    v_readfirstlane_b32 s64, v1
    s_waitcnt lgkmcnt(0)
    s_mov_b32 s60, s42
    s_mov_b32 s61, s43
    s_mov_b32 s62, 268435456
    s_mov_b32 s63, 0x00020000
    s_lshr_b32 s65, s64, 1
    s_and_b32 s66, s64, 1
    s_mul_i32 s67, s65, 64832
    v_mul_u32_u24 v3, 1152, v0
    s_lshl_b32 s68, s9, 2
    v_add_u32 v3, s68, v3
    v_mov_b32 v4, v3
    global_load_dword v8, v4, s[40:41]
    v_add_u32 v4, 294912, v4
    global_load_dword v9, v4, s[40:41]
    v_add_u32 v4, 294912, v4
    global_load_dword v10, v4, s[40:41]
    v_add_u32 v4, 294912, v4
    global_load_dword v11, v4, s[40:41]
    v_add_u32 v4, 294912, v4
    global_load_dword v12, v4, s[40:41]
    v_add_u32 v4, 294912, v4
    global_load_dword v13, v4, s[40:41]
    v_add_u32 v4, 294912, v4
    global_load_dword v14, v4, s[40:41]
    v_add_u32 v4, 294912, v4
    global_load_dword v15, v4, s[40:41]
    v_add_u32 v4, 294912, v4
    s_lshl_b32 s68, s9, 1
    s_add_u32 s68, s68, s65
    s_lshl_b32 s69, s68, 8
    s_lshl_b32 s70, s66, 7
    s_add_u32 s69, s69, s70
    v_lshlrev_b32 v4, 1, v2
    v_add_u32 v4, s69, v4
    s_lshl_b32 s70, s68, 1
    v_mov_b32 v5, s70
    global_load_ushort v16, v4, s[44:45]
    global_load_ushort v17, v4, s[46:47]
    global_load_ushort v18, v4, s[48:49]
    global_load_ushort v19, v4, s[50:51]
    global_load_ushort v20, v4, s[52:53]
    global_load_ushort v21, v4, s[54:55]
    global_load_ushort v22, v5, s[56:57]
    s_lshl_b32 s70, s9, 2
    v_mov_b32 v5, s70
    global_load_dword v7, v5, s[58:59]
    v_mov_b32 v24, 0
    v_mov_b32 v25, 0
    v_mov_b32 v26, 0
    v_mov_b32 v27, 0
    v_lshlrev_b32 v4, 4, v0
    v_add_u32 v5, 65536, v4
    ds_write_b128 v4, v[24:27] offset:0
    ds_write_b128 v4, v[24:27] offset:4096
    ds_write_b128 v4, v[24:27] offset:8192
    ds_write_b128 v4, v[24:27] offset:12288
    ds_write_b128 v4, v[24:27] offset:16384
    ds_write_b128 v4, v[24:27] offset:20480
    ds_write_b128 v4, v[24:27] offset:24576
    ds_write_b128 v4, v[24:27] offset:28672
    ds_write_b128 v4, v[24:27] offset:32768
    ds_write_b128 v4, v[24:27] offset:36864
    ds_write_b128 v4, v[24:27] offset:40960
    ds_write_b128 v4, v[24:27] offset:45056
    ds_write_b128 v4, v[24:27] offset:49152
    ds_write_b128 v4, v[24:27] offset:53248
    ds_write_b128 v4, v[24:27] offset:57344
    ds_write_b128 v4, v[24:27] offset:61440
    ds_write_b128 v5, v[24:27] offset:0
    ds_write_b128 v5, v[24:27] offset:4096
    ds_write_b128 v5, v[24:27] offset:8192
    ds_write_b128 v5, v[24:27] offset:12288
    ds_write_b128 v5, v[24:27] offset:16384
    ds_write_b128 v5, v[24:27] offset:20480
    ds_write_b128 v5, v[24:27] offset:24576
    ds_write_b128 v5, v[24:27] offset:28672
    ds_write_b128 v5, v[24:27] offset:32768
    ds_write_b128 v5, v[24:27] offset:36864
    ds_write_b128 v5, v[24:27] offset:40960
    ds_write_b128 v5, v[24:27] offset:45056
    ds_write_b128 v5, v[24:27] offset:49152
    ds_write_b128 v5, v[24:27] offset:53248
    ds_write_b128 v5, v[24:27] offset:57344
    v_cmp_gt_u32 vcc, 168, v0
    s_nop 0
    s_and_saveexec_b64 s[72:73], vcc
    ds_write_b128 v5, v[24:27] offset:61440
    s_mov_b64 exec, -1
    s_waitcnt lgkmcnt(0)
    s_barrier
    s_waitcnt vmcnt(0)
    v_lshlrev_b32 v4, 1, v0
    v_add_u32 v4, 1568, v4
    v_add_u32 v5, 64832, v4
    ds_write_b16 v4, v8 offset:0
    ds_write_b16_d16_hi v5, v8 offset:0
    ds_write_b16 v4, v8 offset:5918
    ds_write_b16_d16_hi v5, v8 offset:5918
    ds_write_b16 v4, v8 offset:11836
    ds_write_b16_d16_hi v5, v8 offset:11836
    ds_write_b16 v4, v8 offset:17754
    ds_write_b16_d16_hi v5, v8 offset:17754
    ds_write_b16 v4, v8 offset:23672
    ds_write_b16_d16_hi v5, v8 offset:23672
    ds_write_b16 v4, v8 offset:29590
    ds_write_b16_d16_hi v5, v8 offset:29590
    ds_write_b16 v4, v8 offset:35508
    ds_write_b16_d16_hi v5, v8 offset:35508
    ds_write_b16 v4, v8 offset:41426
    ds_write_b16_d16_hi v5, v8 offset:41426
    ds_write_b16 v4, v9 offset:512
    ds_write_b16_d16_hi v5, v9 offset:512
    ds_write_b16 v4, v9 offset:6430
    ds_write_b16_d16_hi v5, v9 offset:6430
    ds_write_b16 v4, v9 offset:12348
    ds_write_b16_d16_hi v5, v9 offset:12348
    ds_write_b16 v4, v9 offset:18266
    ds_write_b16_d16_hi v5, v9 offset:18266
    ds_write_b16 v4, v9 offset:24184
    ds_write_b16_d16_hi v5, v9 offset:24184
    ds_write_b16 v4, v9 offset:30102
    ds_write_b16_d16_hi v5, v9 offset:30102
    ds_write_b16 v4, v9 offset:36020
    ds_write_b16_d16_hi v5, v9 offset:36020
    ds_write_b16 v4, v9 offset:41938
    ds_write_b16_d16_hi v5, v9 offset:41938
    ds_write_b16 v4, v10 offset:1024
    ds_write_b16_d16_hi v5, v10 offset:1024
    ds_write_b16 v4, v10 offset:6942
    ds_write_b16_d16_hi v5, v10 offset:6942
    ds_write_b16 v4, v10 offset:12860
    ds_write_b16_d16_hi v5, v10 offset:12860
    ds_write_b16 v4, v10 offset:18778
    ds_write_b16_d16_hi v5, v10 offset:18778
    ds_write_b16 v4, v10 offset:24696
    ds_write_b16_d16_hi v5, v10 offset:24696
    ds_write_b16 v4, v10 offset:30614
    ds_write_b16_d16_hi v5, v10 offset:30614
    ds_write_b16 v4, v10 offset:36532
    ds_write_b16_d16_hi v5, v10 offset:36532
    ds_write_b16 v4, v10 offset:42450
    ds_write_b16_d16_hi v5, v10 offset:42450
    ds_write_b16 v4, v11 offset:1536
    ds_write_b16_d16_hi v5, v11 offset:1536
    ds_write_b16 v4, v11 offset:7454
    ds_write_b16_d16_hi v5, v11 offset:7454
    ds_write_b16 v4, v11 offset:13372
    ds_write_b16_d16_hi v5, v11 offset:13372
    ds_write_b16 v4, v11 offset:19290
    ds_write_b16_d16_hi v5, v11 offset:19290
    ds_write_b16 v4, v11 offset:25208
    ds_write_b16_d16_hi v5, v11 offset:25208
    ds_write_b16 v4, v11 offset:31126
    ds_write_b16_d16_hi v5, v11 offset:31126
    ds_write_b16 v4, v11 offset:37044
    ds_write_b16_d16_hi v5, v11 offset:37044
    ds_write_b16 v4, v11 offset:42962
    ds_write_b16_d16_hi v5, v11 offset:42962
    ds_write_b16 v4, v12 offset:2048
    ds_write_b16_d16_hi v5, v12 offset:2048
    ds_write_b16 v4, v12 offset:7966
    ds_write_b16_d16_hi v5, v12 offset:7966
    ds_write_b16 v4, v12 offset:13884
    ds_write_b16_d16_hi v5, v12 offset:13884
    ds_write_b16 v4, v12 offset:19802
    ds_write_b16_d16_hi v5, v12 offset:19802
    ds_write_b16 v4, v12 offset:25720
    ds_write_b16_d16_hi v5, v12 offset:25720
    ds_write_b16 v4, v12 offset:31638
    ds_write_b16_d16_hi v5, v12 offset:31638
    ds_write_b16 v4, v12 offset:37556
    ds_write_b16_d16_hi v5, v12 offset:37556
    ds_write_b16 v4, v12 offset:43474
    ds_write_b16_d16_hi v5, v12 offset:43474
    ds_write_b16 v4, v13 offset:2560
    ds_write_b16_d16_hi v5, v13 offset:2560
    ds_write_b16 v4, v13 offset:8478
    ds_write_b16_d16_hi v5, v13 offset:8478
    ds_write_b16 v4, v13 offset:14396
    ds_write_b16_d16_hi v5, v13 offset:14396
    ds_write_b16 v4, v13 offset:20314
    ds_write_b16_d16_hi v5, v13 offset:20314
    ds_write_b16 v4, v13 offset:26232
    ds_write_b16_d16_hi v5, v13 offset:26232
    ds_write_b16 v4, v13 offset:32150
    ds_write_b16_d16_hi v5, v13 offset:32150
    ds_write_b16 v4, v13 offset:38068
    ds_write_b16_d16_hi v5, v13 offset:38068
    ds_write_b16 v4, v13 offset:43986
    ds_write_b16_d16_hi v5, v13 offset:43986
    ds_write_b16 v4, v14 offset:3072
    ds_write_b16_d16_hi v5, v14 offset:3072
    ds_write_b16 v4, v14 offset:8990
    ds_write_b16_d16_hi v5, v14 offset:8990
    ds_write_b16 v4, v14 offset:14908
    ds_write_b16_d16_hi v5, v14 offset:14908
    ds_write_b16 v4, v14 offset:20826
    ds_write_b16_d16_hi v5, v14 offset:20826
    ds_write_b16 v4, v14 offset:26744
    ds_write_b16_d16_hi v5, v14 offset:26744
    ds_write_b16 v4, v14 offset:32662
    ds_write_b16_d16_hi v5, v14 offset:32662
    ds_write_b16 v4, v14 offset:38580
    ds_write_b16_d16_hi v5, v14 offset:38580
    ds_write_b16 v4, v14 offset:44498
    ds_write_b16_d16_hi v5, v14 offset:44498
    ds_write_b16 v4, v15 offset:3584
    ds_write_b16_d16_hi v5, v15 offset:3584
    ds_write_b16 v4, v15 offset:9502
    ds_write_b16_d16_hi v5, v15 offset:9502
    ds_write_b16 v4, v15 offset:15420
    ds_write_b16_d16_hi v5, v15 offset:15420
    ds_write_b16 v4, v15 offset:21338
    ds_write_b16_d16_hi v5, v15 offset:21338
    ds_write_b16 v4, v15 offset:27256
    ds_write_b16_d16_hi v5, v15 offset:27256
    ds_write_b16 v4, v15 offset:33174
    ds_write_b16_d16_hi v5, v15 offset:33174
    ds_write_b16 v4, v15 offset:39092
    ds_write_b16_d16_hi v5, v15 offset:39092
    ds_write_b16 v4, v15 offset:45010
    ds_write_b16_d16_hi v5, v15 offset:45010
    v_lshlrev_b32 v22, 16, v22
    v_mul_f32 v22, 0x3fb8aa3b, v22
    v_exp_f32 v22, v22
    s_nop 0
    v_cvt_pk_bf16_f32 v22, v22, v22
    v_lshlrev_b32 v22, 16, v22
    v_lshlrev_b32 v16, 16, v16
    v_lshlrev_b32 v17, 16, v17
    v_lshlrev_b32 v18, 16, v18
    v_lshlrev_b32 v19, 16, v19
    v_lshlrev_b32 v20, 16, v20
    v_lshlrev_b32 v21, 16, v21
    v_mul_f32 v16, v22, v16
    v_mul_f32 v16, 0x3fb8aa3b, v16
    v_mul_f32 v17, v22, v17
    v_mul_f32 v17, 0.15915494, v17
    v_mul_f32 v18, v22, v18
    v_mul_f32 v19, v22, v19
    v_mul_f32 v23, v20, v18
    v_fma_f32 v23, -v21, v19, v23
    v_mul_f32 v24, v20, v19
    v_fma_f32 v24, v21, v18, v24
    v_and_b32 v25, 31, v2
    v_lshrrev_b32 v26, 5, v2
    v_cvt_f32_u32 v27, v26
    v_mul_f32 v27, 0x3e800000, v27
    v_lshlrev_b32 v28, 3, v25
    v_cvt_f32_u32 v28, v28
    v_mov_b32 v29, v25
    v_lshlrev_b32 v30, 1, v25
    v_add_u32 v30, 240, v30
    v_cmp_lt_u32 vcc, 7, v25
    s_nop 1
    v_cndmask_b32 v29, v29, v30, vcc
    v_lshlrev_b32 v30, 2, v25
    v_add_u32 v31, 464, v30
    v_cmp_lt_u32 vcc, 11, v25
    s_nop 1
    v_cndmask_b32 v29, v29, v31, vcc
    v_add_u32 v31, 712, v30
    v_cmp_lt_u32 vcc, 13, v25
    s_nop 1
    v_cndmask_b32 v29, v29, v31, vcc
    v_lshlrev_b32 v30, 8, v25
    v_subrev_u32 v30, 3072, v30
    v_cmp_lt_u32 vcc, 15, v25
    s_nop 1
    v_cndmask_b32 v29, v29, v30, vcc
    v_cmp_lt_u32 vcc, 20, v25
    s_nop 1
    v_cndmask_b32 v29, v29, 0, vcc
    v_cvt_f32_u32 v29, v29
    v_mov_b32 v48, 0
    v_mov_b32 v49, 0
    v_mov_b32 v50, 0
    v_mov_b32 v51, 0
    v_mov_b32 v52, 0
    v_mov_b32 v53, 0
    v_mov_b32 v54, 0
    v_mov_b32 v55, 0
    v_mov_b32 v56, 0
    v_mov_b32 v57, 0
    v_mov_b32 v58, 0
    v_mov_b32 v59, 0
    v_mov_b32 v60, 0
    v_mov_b32 v61, 0
    v_mov_b32 v62, 0
    v_mov_b32 v63, 0
    s_mov_b32 s80, 0
kg_1:
    v_readlane_b32 s76, v16, s80
    v_readlane_b32 s77, v17, s80
    v_readlane_b32 s78, v23, s80
    v_readlane_b32 s79, v24, s80
    s_add_u32 s80, s80, 1
    v_mul_f32 v32, s76, v29
    v_mul_f32 v33, s76, v28
    v_fma_f32 v34, s77, v29, v27
    v_fma_f32 v35, s77, v28, -v27
    v_exp_f32 v32, v32
    v_exp_f32 v33, v33
    v_cos_f32 v36, v34
    v_sin_f32 v37, v34
    v_cos_f32 v35, v35
    v_mul_f32 v36, s78, v36
    v_mul_f32 v37, s79, v37
    v_mul_f32 v33, v33, v35
    v_sub_f32 v36, v36, v37
    v_mul_f32 v32, v32, v36
    s_nop 1
    v_mfma_f32_32x32x2_f32 v[48:63], v32, v33, v[48:63]
    v_readlane_b32 s76, v16, s80
    v_readlane_b32 s77, v17, s80
    v_readlane_b32 s78, v23, s80
    v_readlane_b32 s79, v24, s80
    s_add_u32 s80, s80, 1
    v_mul_f32 v40, s76, v29
    v_mul_f32 v41, s76, v28
    v_fma_f32 v42, s77, v29, v27
    v_fma_f32 v43, s77, v28, -v27
    v_exp_f32 v40, v40
    v_exp_f32 v41, v41
    v_cos_f32 v44, v42
    v_sin_f32 v45, v42
    v_cos_f32 v43, v43
    v_mul_f32 v44, s78, v44
    v_mul_f32 v45, s79, v45
    v_mul_f32 v41, v41, v43
    v_sub_f32 v44, v44, v45
    v_mul_f32 v40, v40, v44
    s_nop 1
    v_mfma_f32_32x32x2_f32 v[48:63], v40, v41, v[48:63]
    s_cmp_lt_u32 s80, 64
    s_cbranch_scc1 kg_1
    s_nop 15
    s_nop 3
    s_mul_i32 s68, s66, 4096
    s_add_u32 s68, s68, s67
    s_add_u32 s68, s68, 56640
    v_lshlrev_b32 v4, 2, v25
    v_lshl_add_u32 v4, v26, 9, v4
    v_add_u32 v4, s68, v4
    ds_write_b32 v4, v48 offset:0
    ds_write_b32 v4, v49 offset:128
    ds_write_b32 v4, v50 offset:256
    ds_write_b32 v4, v51 offset:384
    ds_write_b32 v4, v52 offset:1024
    ds_write_b32 v4, v53 offset:1152
    ds_write_b32 v4, v54 offset:1280
    ds_write_b32 v4, v55 offset:1408
    ds_write_b32 v4, v56 offset:2048
    ds_write_b32 v4, v57 offset:2176
    ds_write_b32 v4, v58 offset:2304
    ds_write_b32 v4, v59 offset:2432
    s_waitcnt lgkmcnt(0)
    s_barrier
    s_lshl_b32 s68, s66, 6
    v_add_u32 v4, s68, v2
    s_add_u32 s69, s67, 56640
    s_add_u32 s70, s67, 51472
    s_mov_b32 s80, 0
ex_2:
    v_cvt_f32_u32 v32, v4
    v_cvt_pk_bf16_f32 v32, v32, v32
    v_lshlrev_b32 v32, 16, v32
    v_cvt_u32_f32 v32, v32
    v_lshrrev_b32 v33, 8, v32
    v_lshl_add_u32 v34, v33, 1, 1
    v_ffbh_u32 v34, v34
    v_sub_u32 v34, 31, v34
    v_min_u32 v34, 3, v34
    v_and_b32 v35, 7, v32
    v_lshrrev_b32 v35, v34, v35
    v_lshlrev_b32 v36, 3, v33
    v_lshl_add_u32 v37, v33, 1, 8
    v_add_u32 v38, 12, v33
    v_min3_u32 v36, v36, v37, v38
    v_add_u32 v35, v35, v36
    v_bfe_u32 v36, v32, 3, 5
    v_lshl_add_u32 v35, v35, 5, v36
    v_lshl_add_u32 v35, v35, 2, s69
    ds_read2st64_b32 v[36:37], v35 offset0:0 offset1:16
    v_lshlrev_b32 v38, 1, v4
    v_sub_u32 v38, s70, v38
    v_add_u32 v4, 128, v4
    s_add_u32 s80, s80, 1
    s_waitcnt lgkmcnt(0)
    v_add_f32 v36, v36, v37
    v_cvt_pk_bf16_f32 v37, v36, v36
    v_lshlrev_b32 v39, 16, v37
    v_sub_f32 v36, v36, v39
    v_cvt_pk_bf16_f32 v36, v36, v36
    ds_write_b16 v38, v37
    ds_write_b16 v38, v36 offset:4640
    s_cmp_lt_u32 s80, 16
    s_cbranch_scc1 ex_2
    s_waitcnt lgkmcnt(0)
    s_barrier
    s_mul_i32 s68, s66, 4640
    s_add_u32 s68, s68, s67
    s_add_u32 s68, s68, 47856
    v_sub_u32 v4, v26, v25
    v_lshl_add_u32 v4, v4, 4, s68
    v_and_b32 v5, 7, v25
    v_mul_u32_u24 v5, 5920, v5
    v_lshrrev_b32 v6, 3, v25
    v_lshl_add_u32 v5, v6, 9, v5
    v_lshl_add_u32 v5, v26, 4, v5
    v_add_u32 v5, s67, v5
    v_mov_b32 v64, 0
    v_mov_b32 v65, 0
    v_mov_b32 v66, 0
    v_mov_b32 v67, 0
    v_mov_b32 v68, 0
    v_mov_b32 v69, 0
    v_mov_b32 v70, 0
    v_mov_b32 v71, 0
    v_mov_b32 v72, 0
    v_mov_b32 v73, 0
    v_mov_b32 v74, 0
    v_mov_b32 v75, 0
    v_mov_b32 v76, 0
    v_mov_b32 v77, 0
    v_mov_b32 v78, 0
    v_mov_b32 v79, 0
    v_mov_b32 v80, 0
    v_mov_b32 v81, 0
    v_mov_b32 v82, 0
    v_mov_b32 v83, 0
    v_mov_b32 v84, 0
    v_mov_b32 v85, 0
    v_mov_b32 v86, 0
    v_mov_b32 v87, 0
    v_mov_b32 v88, 0
    v_mov_b32 v89, 0
    v_mov_b32 v90, 0
    v_mov_b32 v91, 0
    v_mov_b32 v92, 0
    v_mov_b32 v93, 0
    v_mov_b32 v94, 0
    v_mov_b32 v95, 0
    ds_read_b128 v[96:99], v4 offset:0
    ds_read_b128 v[100:103], v5 offset:0
    ds_read_b128 v[108:111], v4 offset:32
    ds_read_b128 v[112:115], v5 offset:32
    ds_read_b128 v[120:123], v4 offset:64
    ds_read_b128 v[124:127], v5 offset:64
    ds_read_b128 v[132:135], v4 offset:96
    ds_read_b128 v[136:139], v5 offset:96
    s_waitcnt lgkmcnt(6)
    v_mfma_f32_32x32x16_bf16 v[80:95], v[96:99], v[100:103], v[80:95]
    ds_read_b128 v[96:99], v4 offset:128
    ds_read_b128 v[100:103], v5 offset:128
    s_waitcnt lgkmcnt(6)
    v_mfma_f32_32x32x16_bf16 v[80:95], v[108:111], v[112:115], v[80:95]
    ds_read_b128 v[108:111], v4 offset:160
    ds_read_b128 v[112:115], v5 offset:160
    s_waitcnt lgkmcnt(6)
    v_mfma_f32_32x32x16_bf16 v[80:95], v[120:123], v[124:127], v[80:95]
    ds_read_b128 v[120:123], v4 offset:192
    ds_read_b128 v[124:127], v5 offset:192
    s_waitcnt lgkmcnt(6)
    v_mfma_f32_32x32x16_bf16 v[80:95], v[132:135], v[136:139], v[80:95]
    ds_read_b128 v[132:135], v4 offset:224
    ds_read_b128 v[136:139], v5 offset:224
    s_waitcnt lgkmcnt(6)
    v_mfma_f32_32x32x16_bf16 v[80:95], v[96:99], v[100:103], v[80:95]
    ds_read_b128 v[96:99], v4 offset:256
    ds_read_b128 v[100:103], v5 offset:256
    s_waitcnt lgkmcnt(6)
    v_mfma_f32_32x32x16_bf16 v[80:95], v[108:111], v[112:115], v[80:95]
    ds_read_b128 v[108:111], v4 offset:288
    ds_read_b128 v[112:115], v5 offset:288
    s_waitcnt lgkmcnt(6)
    v_mfma_f32_32x32x16_bf16 v[80:95], v[120:123], v[124:127], v[80:95]
    ds_read_b128 v[120:123], v4 offset:320
    ds_read_b128 v[124:127], v5 offset:320
    s_waitcnt lgkmcnt(6)
    v_mfma_f32_32x32x16_bf16 v[80:95], v[132:135], v[136:139], v[80:95]
    ds_read_b128 v[132:135], v4 offset:352
    ds_read_b128 v[136:139], v5 offset:352
    s_waitcnt lgkmcnt(6)
    v_mfma_f32_32x32x16_bf16 v[80:95], v[96:99], v[100:103], v[80:95]
    ds_read_b128 v[96:99], v4 offset:384
    ds_read_b128 v[100:103], v5 offset:384
    s_waitcnt lgkmcnt(6)
    v_mfma_f32_32x32x16_bf16 v[80:95], v[108:111], v[112:115], v[80:95]
    ds_read_b128 v[108:111], v4 offset:416
    ds_read_b128 v[112:115], v5 offset:416
    s_waitcnt lgkmcnt(6)
    v_mfma_f32_32x32x16_bf16 v[80:95], v[120:123], v[124:127], v[80:95]
    ds_read_b128 v[120:123], v4 offset:448
    ds_read_b128 v[124:127], v5 offset:448
    s_waitcnt lgkmcnt(6)
    v_mfma_f32_32x32x16_bf16 v[80:95], v[132:135], v[136:139], v[80:95]
    ds_read_b128 v[132:135], v4 offset:480
    ds_read_b128 v[136:139], v5 offset:480
    s_waitcnt lgkmcnt(6)
    v_mfma_f32_32x32x16_bf16 v[80:95], v[96:99], v[100:103], v[80:95]
    ds_read_b128 v[96:99], v4 offset:512
    ds_read_b128 v[100:103], v5 offset:512
    s_waitcnt lgkmcnt(6)
    v_mfma_f32_32x32x16_bf16 v[80:95], v[108:111], v[112:115], v[80:95]
    ds_read_b128 v[108:111], v4 offset:544
    ds_read_b128 v[112:115], v5 offset:544
    s_waitcnt lgkmcnt(6)
    v_mfma_f32_32x32x16_bf16 v[80:95], v[120:123], v[124:127], v[80:95]
    ds_read_b128 v[120:123], v4 offset:576
    ds_read_b128 v[124:127], v5 offset:576
    s_waitcnt lgkmcnt(6)
    v_mfma_f32_32x32x16_bf16 v[80:95], v[132:135], v[136:139], v[80:95]
    ds_read_b128 v[132:135], v4 offset:608
    ds_read_b128 v[136:139], v5 offset:608
    s_waitcnt lgkmcnt(6)
    v_mfma_f32_32x32x16_bf16 v[80:95], v[96:99], v[100:103], v[80:95]
    ds_read_b128 v[96:99], v4 offset:640
    ds_read_b128 v[100:103], v5 offset:640
    s_waitcnt lgkmcnt(6)
    v_mfma_f32_32x32x16_bf16 v[80:95], v[108:111], v[112:115], v[80:95]
    ds_read_b128 v[108:111], v4 offset:672
    ds_read_b128 v[112:115], v5 offset:672
    s_waitcnt lgkmcnt(6)
    v_mfma_f32_32x32x16_bf16 v[80:95], v[120:123], v[124:127], v[80:95]
    ds_read_b128 v[120:123], v4 offset:704
    ds_read_b128 v[124:127], v5 offset:704
    s_waitcnt lgkmcnt(6)
    v_mfma_f32_32x32x16_bf16 v[80:95], v[132:135], v[136:139], v[80:95]
    ds_read_b128 v[132:135], v4 offset:736
    ds_read_b128 v[136:139], v5 offset:736
    s_waitcnt lgkmcnt(6)
    v_mfma_f32_32x32x16_bf16 v[80:95], v[96:99], v[100:103], v[80:95]
    ds_read_b128 v[96:99], v4 offset:768
    ds_read_b128 v[100:103], v5 offset:768
    s_waitcnt lgkmcnt(6)
    v_mfma_f32_32x32x16_bf16 v[80:95], v[108:111], v[112:115], v[80:95]
    ds_read_b128 v[108:111], v4 offset:800
    ds_read_b128 v[112:115], v5 offset:800
    s_waitcnt lgkmcnt(6)
    v_mfma_f32_32x32x16_bf16 v[80:95], v[120:123], v[124:127], v[80:95]
    ds_read_b128 v[120:123], v4 offset:832
    ds_read_b128 v[124:127], v5 offset:832
    s_waitcnt lgkmcnt(6)
    v_mfma_f32_32x32x16_bf16 v[80:95], v[132:135], v[136:139], v[80:95]
    ds_read_b128 v[132:135], v4 offset:864
    ds_read_b128 v[136:139], v5 offset:864
    s_waitcnt lgkmcnt(6)
    v_mfma_f32_32x32x16_bf16 v[80:95], v[96:99], v[100:103], v[80:95]
    ds_read_b128 v[96:99], v4 offset:896
    ds_read_b128 v[100:103], v5 offset:896
    s_waitcnt lgkmcnt(6)
    v_mfma_f32_32x32x16_bf16 v[80:95], v[108:111], v[112:115], v[80:95]
    ds_read_b128 v[108:111], v4 offset:928
    ds_read_b128 v[112:115], v5 offset:928
    s_waitcnt lgkmcnt(6)
    v_mfma_f32_32x32x16_bf16 v[80:95], v[120:123], v[124:127], v[80:95]
    ds_read_b128 v[120:123], v4 offset:960
    ds_read_b128 v[124:127], v5 offset:960
    s_waitcnt lgkmcnt(6)
    v_mfma_f32_32x32x16_bf16 v[80:95], v[132:135], v[136:139], v[80:95]
    ds_read_b128 v[132:135], v4 offset:992
    ds_read_b128 v[136:139], v5 offset:992
    s_waitcnt lgkmcnt(6)
    v_mfma_f32_32x32x16_bf16 v[80:95], v[96:99], v[100:103], v[80:95]
    ds_read_b128 v[96:99], v4 offset:1024
    ds_read_b128 v[100:103], v5 offset:1024
    s_waitcnt lgkmcnt(6)
    v_mfma_f32_32x32x16_bf16 v[80:95], v[108:111], v[112:115], v[80:95]
    ds_read_b128 v[108:111], v4 offset:1056
    ds_read_b128 v[112:115], v5 offset:1056
    s_waitcnt lgkmcnt(6)
    v_mfma_f32_32x32x16_bf16 v[80:95], v[120:123], v[124:127], v[80:95]
    ds_read_b128 v[120:123], v4 offset:1088
    ds_read_b128 v[124:127], v5 offset:1088
    s_waitcnt lgkmcnt(6)
    v_mfma_f32_32x32x16_bf16 v[80:95], v[132:135], v[136:139], v[80:95]
    ds_read_b128 v[132:135], v4 offset:1120
    ds_read_b128 v[136:139], v5 offset:1120
    s_waitcnt lgkmcnt(6)
    v_mfma_f32_32x32x16_bf16 v[80:95], v[96:99], v[100:103], v[80:95]
    ds_read_b128 v[96:99], v4 offset:1152
    ds_read_b128 v[100:103], v5 offset:1152
    s_waitcnt lgkmcnt(6)
    v_mfma_f32_32x32x16_bf16 v[80:95], v[108:111], v[112:115], v[80:95]
    ds_read_b128 v[108:111], v4 offset:1184
    ds_read_b128 v[112:115], v5 offset:1184
    s_waitcnt lgkmcnt(6)
    v_mfma_f32_32x32x16_bf16 v[80:95], v[120:123], v[124:127], v[80:95]
    ds_read_b128 v[120:123], v4 offset:1216
    ds_read_b128 v[124:127], v5 offset:1216
    s_waitcnt lgkmcnt(6)
    v_mfma_f32_32x32x16_bf16 v[80:95], v[132:135], v[136:139], v[80:95]
    ds_read_b128 v[132:135], v4 offset:1248
    ds_read_b128 v[136:139], v5 offset:1248
    s_waitcnt lgkmcnt(6)
    v_mfma_f32_32x32x16_bf16 v[80:95], v[96:99], v[100:103], v[80:95]
    ds_read_b128 v[96:99], v4 offset:1280
    ds_read_b128 v[100:103], v5 offset:1280
    s_waitcnt lgkmcnt(6)
    v_mfma_f32_32x32x16_bf16 v[80:95], v[108:111], v[112:115], v[80:95]
    ds_read_b128 v[108:111], v4 offset:1312
    ds_read_b128 v[112:115], v5 offset:1312
    s_waitcnt lgkmcnt(6)
    v_mfma_f32_32x32x16_bf16 v[80:95], v[120:123], v[124:127], v[80:95]
    ds_read_b128 v[120:123], v4 offset:1344
    ds_read_b128 v[124:127], v5 offset:1344
    s_waitcnt lgkmcnt(6)
    v_mfma_f32_32x32x16_bf16 v[80:95], v[132:135], v[136:139], v[80:95]
    ds_read_b128 v[132:135], v4 offset:1376
    ds_read_b128 v[136:139], v5 offset:1376
    s_waitcnt lgkmcnt(6)
    v_mfma_f32_32x32x16_bf16 v[80:95], v[96:99], v[100:103], v[80:95]
    ds_read_b128 v[96:99], v4 offset:1408
    ds_read_b128 v[100:103], v5 offset:1408
    s_waitcnt lgkmcnt(6)
    v_mfma_f32_32x32x16_bf16 v[80:95], v[108:111], v[112:115], v[80:95]
    ds_read_b128 v[108:111], v4 offset:1440
    ds_read_b128 v[112:115], v5 offset:1440
    s_waitcnt lgkmcnt(6)
    v_mfma_f32_32x32x16_bf16 v[80:95], v[120:123], v[124:127], v[80:95]
    ds_read_b128 v[120:123], v4 offset:1472
    ds_read_b128 v[124:127], v5 offset:1472
    s_waitcnt lgkmcnt(6)
    v_mfma_f32_32x32x16_bf16 v[80:95], v[132:135], v[136:139], v[80:95]
    ds_read_b128 v[132:135], v4 offset:1504
    ds_read_b128 v[136:139], v5 offset:1504
    s_waitcnt lgkmcnt(6)
    v_mfma_f32_32x32x16_bf16 v[80:95], v[96:99], v[100:103], v[80:95]
    ds_read_b128 v[96:99], v4 offset:1536
    ds_read_b128 v[100:103], v5 offset:1536
    s_waitcnt lgkmcnt(6)
    v_mfma_f32_32x32x16_bf16 v[80:95], v[108:111], v[112:115], v[80:95]
    ds_read_b128 v[108:111], v4 offset:1568
    ds_read_b128 v[112:115], v5 offset:1568
    s_waitcnt lgkmcnt(6)
    v_mfma_f32_32x32x16_bf16 v[80:95], v[120:123], v[124:127], v[80:95]
    ds_read_b128 v[120:123], v4 offset:1600
    ds_read_b128 v[124:127], v5 offset:1600
    s_waitcnt lgkmcnt(6)
    v_mfma_f32_32x32x16_bf16 v[80:95], v[132:135], v[136:139], v[80:95]
    ds_read_b128 v[132:135], v4 offset:1632
    ds_read_b128 v[136:139], v5 offset:1632
    s_waitcnt lgkmcnt(6)
    v_mfma_f32_32x32x16_bf16 v[80:95], v[96:99], v[100:103], v[80:95]
    ds_read_b128 v[96:99], v4 offset:1664
    ds_read_b128 v[100:103], v5 offset:1664
    s_waitcnt lgkmcnt(6)
    v_mfma_f32_32x32x16_bf16 v[80:95], v[108:111], v[112:115], v[80:95]
    ds_read_b128 v[108:111], v4 offset:1696
    ds_read_b128 v[112:115], v5 offset:1696
    s_waitcnt lgkmcnt(6)
    v_mfma_f32_32x32x16_bf16 v[80:95], v[120:123], v[124:127], v[80:95]
    ds_read_b128 v[120:123], v4 offset:1728
    ds_read_b128 v[124:127], v5 offset:1728
    s_waitcnt lgkmcnt(6)
    v_mfma_f32_32x32x16_bf16 v[80:95], v[132:135], v[136:139], v[80:95]
    ds_read_b128 v[132:135], v4 offset:1760
    ds_read_b128 v[136:139], v5 offset:1760
    s_waitcnt lgkmcnt(6)
    v_mfma_f32_32x32x16_bf16 v[80:95], v[96:99], v[100:103], v[80:95]
    ds_read_b128 v[96:99], v4 offset:1792
    ds_read_b128 v[100:103], v5 offset:1792
    s_waitcnt lgkmcnt(6)
    v_mfma_f32_32x32x16_bf16 v[80:95], v[108:111], v[112:115], v[80:95]
    ds_read_b128 v[108:111], v4 offset:1824
    ds_read_b128 v[112:115], v5 offset:1824
    s_waitcnt lgkmcnt(6)
    v_mfma_f32_32x32x16_bf16 v[80:95], v[120:123], v[124:127], v[80:95]
    ds_read_b128 v[120:123], v4 offset:1856
    ds_read_b128 v[124:127], v5 offset:1856
    s_waitcnt lgkmcnt(6)
    v_mfma_f32_32x32x16_bf16 v[80:95], v[132:135], v[136:139], v[80:95]
    ds_read_b128 v[132:135], v4 offset:1888
    ds_read_b128 v[136:139], v5 offset:1888
    s_waitcnt lgkmcnt(6)
    v_mfma_f32_32x32x16_bf16 v[80:95], v[96:99], v[100:103], v[80:95]
    ds_read_b128 v[96:99], v4 offset:1920
    ds_read_b128 v[100:103], v5 offset:1920
    s_waitcnt lgkmcnt(6)
    v_mfma_f32_32x32x16_bf16 v[80:95], v[108:111], v[112:115], v[80:95]
    ds_read_b128 v[108:111], v4 offset:1952
    ds_read_b128 v[112:115], v5 offset:1952
    s_waitcnt lgkmcnt(6)
    v_mfma_f32_32x32x16_bf16 v[80:95], v[120:123], v[124:127], v[80:95]
    ds_read_b128 v[120:123], v4 offset:1984
    ds_read_b128 v[124:127], v5 offset:1984
    s_waitcnt lgkmcnt(6)
    v_mfma_f32_32x32x16_bf16 v[80:95], v[132:135], v[136:139], v[80:95]
    ds_read_b128 v[132:135], v4 offset:2016
    ds_read_b128 v[136:139], v5 offset:2016
    s_waitcnt lgkmcnt(6)
    v_mfma_f32_32x32x16_bf16 v[80:95], v[96:99], v[100:103], v[80:95]
    ds_read_b128 v[96:99], v4 offset:2048
    ds_read_b128 v[100:103], v5 offset:2048
    ds_read_b128 v[104:107], v5 offset:0
    s_waitcnt lgkmcnt(7)
    v_mfma_f32_32x32x16_bf16 v[80:95], v[108:111], v[112:115], v[80:95]
    ds_read_b128 v[108:111], v4 offset:2080
    ds_read_b128 v[112:115], v5 offset:2080
    ds_read_b128 v[116:119], v5 offset:32
    s_waitcnt lgkmcnt(8)
    v_mfma_f32_32x32x16_bf16 v[80:95], v[120:123], v[124:127], v[80:95]
    ds_read_b128 v[120:123], v4 offset:2112
    ds_read_b128 v[124:127], v5 offset:2112
    ds_read_b128 v[128:131], v5 offset:64
    s_waitcnt lgkmcnt(9)
    v_mfma_f32_32x32x16_bf16 v[80:95], v[132:135], v[136:139], v[80:95]
    ds_read_b128 v[132:135], v4 offset:2144
    ds_read_b128 v[136:139], v5 offset:2144
    ds_read_b128 v[140:143], v5 offset:96
    s_waitcnt lgkmcnt(9)
    v_mfma_f32_32x32x16_bf16 v[80:95], v[96:99], v[100:103], v[80:95]
    v_mfma_f32_32x32x16_bf16 v[64:79], v[96:99], v[104:107], v[64:79]
    ds_read_b128 v[96:99], v4 offset:2176
    ds_read_b128 v[100:103], v5 offset:2176
    ds_read_b128 v[104:107], v5 offset:128
    s_waitcnt lgkmcnt(9)
    v_mfma_f32_32x32x16_bf16 v[80:95], v[108:111], v[112:115], v[80:95]
    v_mfma_f32_32x32x16_bf16 v[64:79], v[108:111], v[116:119], v[64:79]
    ds_read_b128 v[108:111], v4 offset:2208
    ds_read_b128 v[112:115], v5 offset:2208
    ds_read_b128 v[116:119], v5 offset:160
    s_waitcnt lgkmcnt(9)
    v_mfma_f32_32x32x16_bf16 v[80:95], v[120:123], v[124:127], v[80:95]
    v_mfma_f32_32x32x16_bf16 v[64:79], v[120:123], v[128:131], v[64:79]
    ds_read_b128 v[120:123], v4 offset:2240
    ds_read_b128 v[124:127], v5 offset:2240
    ds_read_b128 v[128:131], v5 offset:192
    s_waitcnt lgkmcnt(9)
    v_mfma_f32_32x32x16_bf16 v[80:95], v[132:135], v[136:139], v[80:95]
    v_mfma_f32_32x32x16_bf16 v[64:79], v[132:135], v[140:143], v[64:79]
    ds_read_b128 v[132:135], v4 offset:2272
    ds_read_b128 v[136:139], v5 offset:2272
    ds_read_b128 v[140:143], v5 offset:224
    s_waitcnt lgkmcnt(9)
    v_mfma_f32_32x32x16_bf16 v[80:95], v[96:99], v[100:103], v[80:95]
    v_mfma_f32_32x32x16_bf16 v[64:79], v[96:99], v[104:107], v[64:79]
    ds_read_b128 v[96:99], v4 offset:2304
    ds_read_b128 v[100:103], v5 offset:2304
    ds_read_b128 v[104:107], v5 offset:256
    s_waitcnt lgkmcnt(9)
    v_mfma_f32_32x32x16_bf16 v[80:95], v[108:111], v[112:115], v[80:95]
    v_mfma_f32_32x32x16_bf16 v[64:79], v[108:111], v[116:119], v[64:79]
    ds_read_b128 v[108:111], v4 offset:2336
    ds_read_b128 v[112:115], v5 offset:2336
    ds_read_b128 v[116:119], v5 offset:288
    s_waitcnt lgkmcnt(9)
    v_mfma_f32_32x32x16_bf16 v[80:95], v[120:123], v[124:127], v[80:95]
    v_mfma_f32_32x32x16_bf16 v[64:79], v[120:123], v[128:131], v[64:79]
    ds_read_b128 v[120:123], v4 offset:2368
    ds_read_b128 v[124:127], v5 offset:2368
    ds_read_b128 v[128:131], v5 offset:320
    s_waitcnt lgkmcnt(9)
    v_mfma_f32_32x32x16_bf16 v[80:95], v[132:135], v[136:139], v[80:95]
    v_mfma_f32_32x32x16_bf16 v[64:79], v[132:135], v[140:143], v[64:79]
    ds_read_b128 v[132:135], v4 offset:2400
    ds_read_b128 v[136:139], v5 offset:2400
    ds_read_b128 v[140:143], v5 offset:352
    s_waitcnt lgkmcnt(9)
    v_mfma_f32_32x32x16_bf16 v[80:95], v[96:99], v[100:103], v[80:95]
    v_mfma_f32_32x32x16_bf16 v[64:79], v[96:99], v[104:107], v[64:79]
    ds_read_b128 v[96:99], v4 offset:2432
    ds_read_b128 v[100:103], v5 offset:2432
    ds_read_b128 v[104:107], v5 offset:384
    s_waitcnt lgkmcnt(9)
    v_mfma_f32_32x32x16_bf16 v[80:95], v[108:111], v[112:115], v[80:95]
    v_mfma_f32_32x32x16_bf16 v[64:79], v[108:111], v[116:119], v[64:79]
    ds_read_b128 v[108:111], v4 offset:2464
    ds_read_b128 v[112:115], v5 offset:2464
    ds_read_b128 v[116:119], v5 offset:416
    s_waitcnt lgkmcnt(9)
    v_mfma_f32_32x32x16_bf16 v[80:95], v[120:123], v[124:127], v[80:95]
    v_mfma_f32_32x32x16_bf16 v[64:79], v[120:123], v[128:131], v[64:79]
    ds_read_b128 v[120:123], v4 offset:2496
    ds_read_b128 v[124:127], v5 offset:2496
    ds_read_b128 v[128:131], v5 offset:448
    s_waitcnt lgkmcnt(9)
    v_mfma_f32_32x32x16_bf16 v[80:95], v[132:135], v[136:139], v[80:95]
    v_mfma_f32_32x32x16_bf16 v[64:79], v[132:135], v[140:143], v[64:79]
    ds_read_b128 v[132:135], v4 offset:2528
    ds_read_b128 v[136:139], v5 offset:2528
    ds_read_b128 v[140:143], v5 offset:480
    s_waitcnt lgkmcnt(9)
    v_mfma_f32_32x32x16_bf16 v[80:95], v[96:99], v[100:103], v[80:95]
    v_mfma_f32_32x32x16_bf16 v[64:79], v[96:99], v[104:107], v[64:79]
    ds_read_b128 v[96:99], v4 offset:2560
    ds_read_b128 v[100:103], v5 offset:2560
    ds_read_b128 v[104:107], v5 offset:512
    s_waitcnt lgkmcnt(9)
    v_mfma_f32_32x32x16_bf16 v[80:95], v[108:111], v[112:115], v[80:95]
    v_mfma_f32_32x32x16_bf16 v[64:79], v[108:111], v[116:119], v[64:79]
    ds_read_b128 v[108:111], v4 offset:2592
    ds_read_b128 v[112:115], v5 offset:2592
    ds_read_b128 v[116:119], v5 offset:544
    s_waitcnt lgkmcnt(9)
    v_mfma_f32_32x32x16_bf16 v[80:95], v[120:123], v[124:127], v[80:95]
    v_mfma_f32_32x32x16_bf16 v[64:79], v[120:123], v[128:131], v[64:79]
    ds_read_b128 v[120:123], v4 offset:2624
    ds_read_b128 v[124:127], v5 offset:2624
    ds_read_b128 v[128:131], v5 offset:576
    s_waitcnt lgkmcnt(9)
    v_mfma_f32_32x32x16_bf16 v[80:95], v[132:135], v[136:139], v[80:95]
    v_mfma_f32_32x32x16_bf16 v[64:79], v[132:135], v[140:143], v[64:79]
    ds_read_b128 v[132:135], v4 offset:2656
    ds_read_b128 v[136:139], v5 offset:2656
    ds_read_b128 v[140:143], v5 offset:608
    s_waitcnt lgkmcnt(9)
    v_mfma_f32_32x32x16_bf16 v[80:95], v[96:99], v[100:103], v[80:95]
    v_mfma_f32_32x32x16_bf16 v[64:79], v[96:99], v[104:107], v[64:79]
    ds_read_b128 v[96:99], v4 offset:2688
    ds_read_b128 v[100:103], v5 offset:2688
    ds_read_b128 v[104:107], v5 offset:640
    s_waitcnt lgkmcnt(9)
    v_mfma_f32_32x32x16_bf16 v[80:95], v[108:111], v[112:115], v[80:95]
    v_mfma_f32_32x32x16_bf16 v[64:79], v[108:111], v[116:119], v[64:79]
    ds_read_b128 v[108:111], v4 offset:2720
    ds_read_b128 v[112:115], v5 offset:2720
    ds_read_b128 v[116:119], v5 offset:672
    s_waitcnt lgkmcnt(9)
    v_mfma_f32_32x32x16_bf16 v[80:95], v[120:123], v[124:127], v[80:95]
    v_mfma_f32_32x32x16_bf16 v[64:79], v[120:123], v[128:131], v[64:79]
    ds_read_b128 v[120:123], v4 offset:2752
    ds_read_b128 v[124:127], v5 offset:2752
    ds_read_b128 v[128:131], v5 offset:704
    s_waitcnt lgkmcnt(9)
    v_mfma_f32_32x32x16_bf16 v[80:95], v[132:135], v[136:139], v[80:95]
    v_mfma_f32_32x32x16_bf16 v[64:79], v[132:135], v[140:143], v[64:79]
    ds_read_b128 v[132:135], v4 offset:2784
    ds_read_b128 v[136:139], v5 offset:2784
    ds_read_b128 v[140:143], v5 offset:736
    s_waitcnt lgkmcnt(9)
    v_mfma_f32_32x32x16_bf16 v[80:95], v[96:99], v[100:103], v[80:95]
    v_mfma_f32_32x32x16_bf16 v[64:79], v[96:99], v[104:107], v[64:79]
    ds_read_b128 v[96:99], v4 offset:2816
    ds_read_b128 v[100:103], v5 offset:2816
    ds_read_b128 v[104:107], v5 offset:768
    s_waitcnt lgkmcnt(9)
    v_mfma_f32_32x32x16_bf16 v[80:95], v[108:111], v[112:115], v[80:95]
    v_mfma_f32_32x32x16_bf16 v[64:79], v[108:111], v[116:119], v[64:79]
    ds_read_b128 v[108:111], v4 offset:2848
    ds_read_b128 v[112:115], v5 offset:2848
    ds_read_b128 v[116:119], v5 offset:800
    s_waitcnt lgkmcnt(9)
    v_mfma_f32_32x32x16_bf16 v[80:95], v[120:123], v[124:127], v[80:95]
    v_mfma_f32_32x32x16_bf16 v[64:79], v[120:123], v[128:131], v[64:79]
    ds_read_b128 v[120:123], v4 offset:2880
    ds_read_b128 v[124:127], v5 offset:2880
    ds_read_b128 v[128:131], v5 offset:832
    s_waitcnt lgkmcnt(9)
    v_mfma_f32_32x32x16_bf16 v[80:95], v[132:135], v[136:139], v[80:95]
    v_mfma_f32_32x32x16_bf16 v[64:79], v[132:135], v[140:143], v[64:79]
    ds_read_b128 v[132:135], v4 offset:2912
    ds_read_b128 v[136:139], v5 offset:2912
    ds_read_b128 v[140:143], v5 offset:864
    s_waitcnt lgkmcnt(9)
    v_mfma_f32_32x32x16_bf16 v[80:95], v[96:99], v[100:103], v[80:95]
    v_mfma_f32_32x32x16_bf16 v[64:79], v[96:99], v[104:107], v[64:79]
    ds_read_b128 v[96:99], v4 offset:2944
    ds_read_b128 v[100:103], v5 offset:2944
    ds_read_b128 v[104:107], v5 offset:896
    s_waitcnt lgkmcnt(9)
    v_mfma_f32_32x32x16_bf16 v[80:95], v[108:111], v[112:115], v[80:95]
    v_mfma_f32_32x32x16_bf16 v[64:79], v[108:111], v[116:119], v[64:79]
    ds_read_b128 v[108:111], v4 offset:2976
    ds_read_b128 v[112:115], v5 offset:2976
    ds_read_b128 v[116:119], v5 offset:928
    s_waitcnt lgkmcnt(9)
    v_mfma_f32_32x32x16_bf16 v[80:95], v[120:123], v[124:127], v[80:95]
    v_mfma_f32_32x32x16_bf16 v[64:79], v[120:123], v[128:131], v[64:79]
    ds_read_b128 v[120:123], v4 offset:3008
    ds_read_b128 v[124:127], v5 offset:3008
    ds_read_b128 v[128:131], v5 offset:960
    s_waitcnt lgkmcnt(9)
    v_mfma_f32_32x32x16_bf16 v[80:95], v[132:135], v[136:139], v[80:95]
    v_mfma_f32_32x32x16_bf16 v[64:79], v[132:135], v[140:143], v[64:79]
    ds_read_b128 v[132:135], v4 offset:3040
    ds_read_b128 v[136:139], v5 offset:3040
    ds_read_b128 v[140:143], v5 offset:992
    s_waitcnt lgkmcnt(9)
    v_mfma_f32_32x32x16_bf16 v[80:95], v[96:99], v[100:103], v[80:95]
    v_mfma_f32_32x32x16_bf16 v[64:79], v[96:99], v[104:107], v[64:79]
    ds_read_b128 v[96:99], v4 offset:3072
    ds_read_b128 v[100:103], v5 offset:3072
    ds_read_b128 v[104:107], v5 offset:1024
    s_waitcnt lgkmcnt(9)
    v_mfma_f32_32x32x16_bf16 v[80:95], v[108:111], v[112:115], v[80:95]
    v_mfma_f32_32x32x16_bf16 v[64:79], v[108:111], v[116:119], v[64:79]
    ds_read_b128 v[108:111], v4 offset:3104
    ds_read_b128 v[112:115], v5 offset:3104
    ds_read_b128 v[116:119], v5 offset:1056
    s_waitcnt lgkmcnt(9)
    v_mfma_f32_32x32x16_bf16 v[80:95], v[120:123], v[124:127], v[80:95]
    v_mfma_f32_32x32x16_bf16 v[64:79], v[120:123], v[128:131], v[64:79]
    ds_read_b128 v[120:123], v4 offset:3136
    ds_read_b128 v[124:127], v5 offset:3136
    ds_read_b128 v[128:131], v5 offset:1088
    s_waitcnt lgkmcnt(9)
    v_mfma_f32_32x32x16_bf16 v[80:95], v[132:135], v[136:139], v[80:95]
    v_mfma_f32_32x32x16_bf16 v[64:79], v[132:135], v[140:143], v[64:79]
    ds_read_b128 v[132:135], v4 offset:3168
    ds_read_b128 v[136:139], v5 offset:3168
    ds_read_b128 v[140:143], v5 offset:1120
    s_waitcnt lgkmcnt(9)
    v_mfma_f32_32x32x16_bf16 v[80:95], v[96:99], v[100:103], v[80:95]
    v_mfma_f32_32x32x16_bf16 v[64:79], v[96:99], v[104:107], v[64:79]
    ds_read_b128 v[96:99], v4 offset:3200
    ds_read_b128 v[100:103], v5 offset:3200
    ds_read_b128 v[104:107], v5 offset:1152
    s_waitcnt lgkmcnt(9)
    v_mfma_f32_32x32x16_bf16 v[80:95], v[108:111], v[112:115], v[80:95]
    v_mfma_f32_32x32x16_bf16 v[64:79], v[108:111], v[116:119], v[64:79]
    ds_read_b128 v[108:111], v4 offset:3232
    ds_read_b128 v[112:115], v5 offset:3232
    ds_read_b128 v[116:119], v5 offset:1184
    s_waitcnt lgkmcnt(9)
    v_mfma_f32_32x32x16_bf16 v[80:95], v[120:123], v[124:127], v[80:95]
    v_mfma_f32_32x32x16_bf16 v[64:79], v[120:123], v[128:131], v[64:79]
    ds_read_b128 v[120:123], v4 offset:3264
    ds_read_b128 v[124:127], v5 offset:3264
    ds_read_b128 v[128:131], v5 offset:1216
    s_waitcnt lgkmcnt(9)
    v_mfma_f32_32x32x16_bf16 v[80:95], v[132:135], v[136:139], v[80:95]
    v_mfma_f32_32x32x16_bf16 v[64:79], v[132:135], v[140:143], v[64:79]
    ds_read_b128 v[132:135], v4 offset:3296
    ds_read_b128 v[136:139], v5 offset:3296
    ds_read_b128 v[140:143], v5 offset:1248
    s_waitcnt lgkmcnt(9)
    v_mfma_f32_32x32x16_bf16 v[80:95], v[96:99], v[100:103], v[80:95]
    v_mfma_f32_32x32x16_bf16 v[64:79], v[96:99], v[104:107], v[64:79]
    ds_read_b128 v[96:99], v4 offset:3328
    ds_read_b128 v[100:103], v5 offset:3328
    ds_read_b128 v[104:107], v5 offset:1280
    s_waitcnt lgkmcnt(9)
    v_mfma_f32_32x32x16_bf16 v[80:95], v[108:111], v[112:115], v[80:95]
    v_mfma_f32_32x32x16_bf16 v[64:79], v[108:111], v[116:119], v[64:79]
    ds_read_b128 v[108:111], v4 offset:3360
    ds_read_b128 v[112:115], v5 offset:3360
    ds_read_b128 v[116:119], v5 offset:1312
    s_waitcnt lgkmcnt(9)
    v_mfma_f32_32x32x16_bf16 v[80:95], v[120:123], v[124:127], v[80:95]
    v_mfma_f32_32x32x16_bf16 v[64:79], v[120:123], v[128:131], v[64:79]
    ds_read_b128 v[120:123], v4 offset:3392
    ds_read_b128 v[124:127], v5 offset:3392
    ds_read_b128 v[128:131], v5 offset:1344
    s_waitcnt lgkmcnt(9)
    v_mfma_f32_32x32x16_bf16 v[80:95], v[132:135], v[136:139], v[80:95]
    v_mfma_f32_32x32x16_bf16 v[64:79], v[132:135], v[140:143], v[64:79]
    ds_read_b128 v[132:135], v4 offset:3424
    ds_read_b128 v[136:139], v5 offset:3424
    ds_read_b128 v[140:143], v5 offset:1376
    s_waitcnt lgkmcnt(9)
    v_mfma_f32_32x32x16_bf16 v[80:95], v[96:99], v[100:103], v[80:95]
    v_mfma_f32_32x32x16_bf16 v[64:79], v[96:99], v[104:107], v[64:79]
    ds_read_b128 v[96:99], v4 offset:3456
    ds_read_b128 v[100:103], v5 offset:3456
    ds_read_b128 v[104:107], v5 offset:1408
    s_waitcnt lgkmcnt(9)
    v_mfma_f32_32x32x16_bf16 v[80:95], v[108:111], v[112:115], v[80:95]
    v_mfma_f32_32x32x16_bf16 v[64:79], v[108:111], v[116:119], v[64:79]
    ds_read_b128 v[108:111], v4 offset:3488
    ds_read_b128 v[112:115], v5 offset:3488
    ds_read_b128 v[116:119], v5 offset:1440
    s_waitcnt lgkmcnt(9)
    v_mfma_f32_32x32x16_bf16 v[80:95], v[120:123], v[124:127], v[80:95]
    v_mfma_f32_32x32x16_bf16 v[64:79], v[120:123], v[128:131], v[64:79]
    ds_read_b128 v[120:123], v4 offset:3520
    ds_read_b128 v[124:127], v5 offset:3520
    ds_read_b128 v[128:131], v5 offset:1472
    s_waitcnt lgkmcnt(9)
    v_mfma_f32_32x32x16_bf16 v[80:95], v[132:135], v[136:139], v[80:95]
    v_mfma_f32_32x32x16_bf16 v[64:79], v[132:135], v[140:143], v[64:79]
    ds_read_b128 v[132:135], v4 offset:3552
    ds_read_b128 v[136:139], v5 offset:3552
    ds_read_b128 v[140:143], v5 offset:1504
    s_waitcnt lgkmcnt(9)
    v_mfma_f32_32x32x16_bf16 v[80:95], v[96:99], v[100:103], v[80:95]
    v_mfma_f32_32x32x16_bf16 v[64:79], v[96:99], v[104:107], v[64:79]
    ds_read_b128 v[96:99], v4 offset:3584
    ds_read_b128 v[100:103], v5 offset:3584
    ds_read_b128 v[104:107], v5 offset:1536
    s_waitcnt lgkmcnt(9)
    v_mfma_f32_32x32x16_bf16 v[80:95], v[108:111], v[112:115], v[80:95]
    v_mfma_f32_32x32x16_bf16 v[64:79], v[108:111], v[116:119], v[64:79]
    ds_read_b128 v[108:111], v4 offset:3616
    ds_read_b128 v[112:115], v5 offset:3616
    ds_read_b128 v[116:119], v5 offset:1568
    s_waitcnt lgkmcnt(9)
    v_mfma_f32_32x32x16_bf16 v[80:95], v[120:123], v[124:127], v[80:95]
    v_mfma_f32_32x32x16_bf16 v[64:79], v[120:123], v[128:131], v[64:79]
    ds_read_b128 v[120:123], v4 offset:3648
    ds_read_b128 v[124:127], v5 offset:3648
    ds_read_b128 v[128:131], v5 offset:1600
    s_waitcnt lgkmcnt(9)
    v_mfma_f32_32x32x16_bf16 v[80:95], v[132:135], v[136:139], v[80:95]
    v_mfma_f32_32x32x16_bf16 v[64:79], v[132:135], v[140:143], v[64:79]
    ds_read_b128 v[132:135], v4 offset:3680
    ds_read_b128 v[136:139], v5 offset:3680
    ds_read_b128 v[140:143], v5 offset:1632
    s_waitcnt lgkmcnt(9)
    v_mfma_f32_32x32x16_bf16 v[80:95], v[96:99], v[100:103], v[80:95]
    v_mfma_f32_32x32x16_bf16 v[64:79], v[96:99], v[104:107], v[64:79]
    ds_read_b128 v[96:99], v4 offset:3712
    ds_read_b128 v[100:103], v5 offset:3712
    ds_read_b128 v[104:107], v5 offset:1664
    s_waitcnt lgkmcnt(9)
    v_mfma_f32_32x32x16_bf16 v[80:95], v[108:111], v[112:115], v[80:95]
    v_mfma_f32_32x32x16_bf16 v[64:79], v[108:111], v[116:119], v[64:79]
    ds_read_b128 v[108:111], v4 offset:3744
    ds_read_b128 v[112:115], v5 offset:3744
    ds_read_b128 v[116:119], v5 offset:1696
    s_waitcnt lgkmcnt(9)
    v_mfma_f32_32x32x16_bf16 v[80:95], v[120:123], v[124:127], v[80:95]
    v_mfma_f32_32x32x16_bf16 v[64:79], v[120:123], v[128:131], v[64:79]
    ds_read_b128 v[120:123], v4 offset:3776
    ds_read_b128 v[124:127], v5 offset:3776
    ds_read_b128 v[128:131], v5 offset:1728
    s_waitcnt lgkmcnt(9)
    v_mfma_f32_32x32x16_bf16 v[80:95], v[132:135], v[136:139], v[80:95]
    v_mfma_f32_32x32x16_bf16 v[64:79], v[132:135], v[140:143], v[64:79]
    ds_read_b128 v[132:135], v4 offset:3808
    ds_read_b128 v[136:139], v5 offset:3808
    ds_read_b128 v[140:143], v5 offset:1760
    s_waitcnt lgkmcnt(9)
    v_mfma_f32_32x32x16_bf16 v[80:95], v[96:99], v[100:103], v[80:95]
    v_mfma_f32_32x32x16_bf16 v[64:79], v[96:99], v[104:107], v[64:79]
    ds_read_b128 v[96:99], v4 offset:3840
    ds_read_b128 v[100:103], v5 offset:3840
    ds_read_b128 v[104:107], v5 offset:1792
    s_waitcnt lgkmcnt(9)
    v_mfma_f32_32x32x16_bf16 v[80:95], v[108:111], v[112:115], v[80:95]
    v_mfma_f32_32x32x16_bf16 v[64:79], v[108:111], v[116:119], v[64:79]
    ds_read_b128 v[108:111], v4 offset:3872
    ds_read_b128 v[112:115], v5 offset:3872
    ds_read_b128 v[116:119], v5 offset:1824
    s_waitcnt lgkmcnt(9)
    v_mfma_f32_32x32x16_bf16 v[80:95], v[120:123], v[124:127], v[80:95]
    v_mfma_f32_32x32x16_bf16 v[64:79], v[120:123], v[128:131], v[64:79]
    ds_read_b128 v[120:123], v4 offset:3904
    ds_read_b128 v[124:127], v5 offset:3904
    ds_read_b128 v[128:131], v5 offset:1856
    s_waitcnt lgkmcnt(9)
    v_mfma_f32_32x32x16_bf16 v[80:95], v[132:135], v[136:139], v[80:95]
    v_mfma_f32_32x32x16_bf16 v[64:79], v[132:135], v[140:143], v[64:79]
    ds_read_b128 v[132:135], v4 offset:3936
    ds_read_b128 v[136:139], v5 offset:3936
    ds_read_b128 v[140:143], v5 offset:1888
    s_waitcnt lgkmcnt(9)
    v_mfma_f32_32x32x16_bf16 v[80:95], v[96:99], v[100:103], v[80:95]
    v_mfma_f32_32x32x16_bf16 v[64:79], v[96:99], v[104:107], v[64:79]
    ds_read_b128 v[96:99], v4 offset:3968
    ds_read_b128 v[100:103], v5 offset:3968
    ds_read_b128 v[104:107], v5 offset:1920
    s_waitcnt lgkmcnt(9)
    v_mfma_f32_32x32x16_bf16 v[80:95], v[108:111], v[112:115], v[80:95]
    v_mfma_f32_32x32x16_bf16 v[64:79], v[108:111], v[116:119], v[64:79]
    ds_read_b128 v[108:111], v4 offset:4000
    ds_read_b128 v[112:115], v5 offset:4000
    ds_read_b128 v[116:119], v5 offset:1952
    s_waitcnt lgkmcnt(9)
    v_mfma_f32_32x32x16_bf16 v[80:95], v[120:123], v[124:127], v[80:95]
    v_mfma_f32_32x32x16_bf16 v[64:79], v[120:123], v[128:131], v[64:79]
    ds_read_b128 v[120:123], v4 offset:4032
    ds_read_b128 v[124:127], v5 offset:4032
    ds_read_b128 v[128:131], v5 offset:1984
    s_waitcnt lgkmcnt(9)
    v_mfma_f32_32x32x16_bf16 v[80:95], v[132:135], v[136:139], v[80:95]
    v_mfma_f32_32x32x16_bf16 v[64:79], v[132:135], v[140:143], v[64:79]
    ds_read_b128 v[132:135], v4 offset:4064
    ds_read_b128 v[136:139], v5 offset:4064
    ds_read_b128 v[140:143], v5 offset:2016
    s_waitcnt lgkmcnt(9)
    v_mfma_f32_32x32x16_bf16 v[80:95], v[96:99], v[100:103], v[80:95]
    v_mfma_f32_32x32x16_bf16 v[64:79], v[96:99], v[104:107], v[64:79]
    ds_read_b128 v[96:99], v4 offset:4096
    ds_read_b128 v[100:103], v5 offset:4096
    ds_read_b128 v[104:107], v5 offset:2048
    s_waitcnt lgkmcnt(9)
    v_mfma_f32_32x32x16_bf16 v[80:95], v[108:111], v[112:115], v[80:95]
    v_mfma_f32_32x32x16_bf16 v[64:79], v[108:111], v[116:119], v[64:79]
    s_waitcnt lgkmcnt(6)
    v_mfma_f32_32x32x16_bf16 v[80:95], v[120:123], v[124:127], v[80:95]
    v_mfma_f32_32x32x16_bf16 v[64:79], v[120:123], v[128:131], v[64:79]
    s_waitcnt lgkmcnt(3)
    v_mfma_f32_32x32x16_bf16 v[80:95], v[132:135], v[136:139], v[80:95]
    v_mfma_f32_32x32x16_bf16 v[64:79], v[132:135], v[140:143], v[64:79]
    s_waitcnt lgkmcnt(0)
    v_mfma_f32_32x32x16_bf16 v[80:95], v[96:99], v[100:103], v[80:95]
    v_mfma_f32_32x32x16_bf16 v[64:79], v[96:99], v[104:107], v[64:79]
    s_nop 7
    s_nop 7
    s_barrier
    s_lshl_b32 s68, s64, 13
    v_and_b32 v4, 7, v25
    v_lshl_add_u32 v4, v6, 8, v4
    v_lshl_add_u32 v4, v26, 5, v4
    v_lshl_add_u32 v4, v4, 2, s68
    ds_write_b32 v4, v64 offset:0
    ds_write_b32 v4, v65 offset:32
    ds_write_b32 v4, v66 offset:64
    ds_write_b32 v4, v67 offset:96
    ds_write_b32 v4, v68 offset:256
    ds_write_b32 v4, v69 offset:288
    ds_write_b32 v4, v70 offset:320
    ds_write_b32 v4, v71 offset:352
    ds_write_b32 v4, v72 offset:512
    ds_write_b32 v4, v73 offset:544
    ds_write_b32 v4, v74 offset:576
    ds_write_b32 v4, v75 offset:608
    ds_write_b32 v4, v76 offset:768
    ds_write_b32 v4, v77 offset:800
    ds_write_b32 v4, v78 offset:832
    ds_write_b32 v4, v79 offset:864
    ds_write_b32 v4, v80 offset:4096
    ds_write_b32 v4, v81 offset:4128
    ds_write_b32 v4, v82 offset:4160
    ds_write_b32 v4, v83 offset:4192
    ds_write_b32 v4, v84 offset:4352
    ds_write_b32 v4, v85 offset:4384
    ds_write_b32 v4, v86 offset:4416
    ds_write_b32 v4, v87 offset:4448
    ds_write_b32 v4, v88 offset:4608
    ds_write_b32 v4, v89 offset:4640
    ds_write_b32 v4, v90 offset:4672
    ds_write_b32 v4, v91 offset:4704
    ds_write_b32 v4, v92 offset:4864
    ds_write_b32 v4, v93 offset:4896
    ds_write_b32 v4, v94 offset:4928
    ds_write_b32 v4, v95 offset:4960
    v_lshlrev_b32 v4, 2, v0
    v_lshlrev_b32 v5, 16, v7
    v_and_b32 v6, 0xffff0000, v7
    s_mov_b32 s68, 83886080
    s_waitcnt lgkmcnt(0)
    s_barrier
    ds_read2st64_b32 v[32:33], v4 offset0:0 offset1:32
    ds_read2st64_b32 v[34:35], v4 offset0:64 offset1:96
    ds_read2st64_b32 v[36:37], v4 offset0:4 offset1:36
    ds_read2st64_b32 v[38:39], v4 offset0:68 offset1:100
    ds_read2st64_b32 v[40:41], v4 offset0:8 offset1:40
    ds_read2st64_b32 v[42:43], v4 offset0:72 offset1:104
    ds_read2st64_b32 v[44:45], v4 offset0:12 offset1:44
    ds_read2st64_b32 v[46:47], v4 offset0:76 offset1:108
    ds_read2st64_b32 v[48:49], v4 offset0:16 offset1:48
    ds_read2st64_b32 v[50:51], v4 offset0:80 offset1:112
    ds_read2st64_b32 v[52:53], v4 offset0:20 offset1:52
    ds_read2st64_b32 v[54:55], v4 offset0:84 offset1:116
    ds_read2st64_b32 v[56:57], v4 offset0:24 offset1:56
    ds_read2st64_b32 v[58:59], v4 offset0:88 offset1:120
    ds_read2st64_b32 v[60:61], v4 offset0:28 offset1:60
    ds_read2st64_b32 v[62:63], v4 offset0:92 offset1:124
    s_waitcnt lgkmcnt(0)
    v_add_f32 v32, v32, v33
    v_add_f32 v34, v34, v35
    v_cvt_pk_bf16_f32 v32, v32, v34
    v_lshlrev_b32 v33, 16, v8
    v_and_b32 v34, 0xffff0000, v8
    v_mul_f32 v33, v33, v5
    v_mul_f32 v34, v34, v6
    v_cvt_pk_bf16_f32 v33, v33, v34
    v_lshlrev_b32 v34, 16, v32
    v_lshlrev_b32 v35, 16, v33
    v_add_f32 v34, v34, v35
    v_and_b32 v32, 0xffff0000, v32
    v_and_b32 v33, 0xffff0000, v33
    v_add_f32 v32, v32, v33
    v_cvt_pk_bf16_f32 v32, v34, v32
    buffer_store_dword v32, v3, s[60:63], s68 offen sc1
    v_add_u32 v3, 294912, v3
    v_add_f32 v36, v36, v37
    v_add_f32 v38, v38, v39
    v_cvt_pk_bf16_f32 v36, v36, v38
    v_lshlrev_b32 v37, 16, v9
    v_and_b32 v38, 0xffff0000, v9
    v_mul_f32 v37, v37, v5
    v_mul_f32 v38, v38, v6
    v_cvt_pk_bf16_f32 v37, v37, v38
    v_lshlrev_b32 v38, 16, v36
    v_lshlrev_b32 v39, 16, v37
    v_add_f32 v38, v38, v39
    v_and_b32 v36, 0xffff0000, v36
    v_and_b32 v37, 0xffff0000, v37
    v_add_f32 v36, v36, v37
    v_cvt_pk_bf16_f32 v36, v38, v36
    buffer_store_dword v36, v3, s[60:63], s68 offen sc1
    v_add_u32 v3, 294912, v3
    v_add_f32 v40, v40, v41
    v_add_f32 v42, v42, v43
    v_cvt_pk_bf16_f32 v40, v40, v42
    v_lshlrev_b32 v41, 16, v10
    v_and_b32 v42, 0xffff0000, v10
    v_mul_f32 v41, v41, v5
    v_mul_f32 v42, v42, v6
    v_cvt_pk_bf16_f32 v41, v41, v42
    v_lshlrev_b32 v42, 16, v40
    v_lshlrev_b32 v43, 16, v41
    v_add_f32 v42, v42, v43
    v_and_b32 v40, 0xffff0000, v40
    v_and_b32 v41, 0xffff0000, v41
    v_add_f32 v40, v40, v41
    v_cvt_pk_bf16_f32 v40, v42, v40
    buffer_store_dword v40, v3, s[60:63], s68 offen sc1
    v_add_u32 v3, 294912, v3
    v_add_f32 v44, v44, v45
    v_add_f32 v46, v46, v47
    v_cvt_pk_bf16_f32 v44, v44, v46
    v_lshlrev_b32 v45, 16, v11
    v_and_b32 v46, 0xffff0000, v11
    v_mul_f32 v45, v45, v5
    v_mul_f32 v46, v46, v6
    v_cvt_pk_bf16_f32 v45, v45, v46
    v_lshlrev_b32 v46, 16, v44
    v_lshlrev_b32 v47, 16, v45
    v_add_f32 v46, v46, v47
    v_and_b32 v44, 0xffff0000, v44
    v_and_b32 v45, 0xffff0000, v45
    v_add_f32 v44, v44, v45
    v_cvt_pk_bf16_f32 v44, v46, v44
    buffer_store_dword v44, v3, s[60:63], s68 offen sc1
    v_add_u32 v3, 294912, v3
    v_add_f32 v48, v48, v49
    v_add_f32 v50, v50, v51
    v_cvt_pk_bf16_f32 v48, v48, v50
    v_lshlrev_b32 v49, 16, v12
    v_and_b32 v50, 0xffff0000, v12
    v_mul_f32 v49, v49, v5
    v_mul_f32 v50, v50, v6
    v_cvt_pk_bf16_f32 v49, v49, v50
    v_lshlrev_b32 v50, 16, v48
    v_lshlrev_b32 v51, 16, v49
    v_add_f32 v50, v50, v51
    v_and_b32 v48, 0xffff0000, v48
    v_and_b32 v49, 0xffff0000, v49
    v_add_f32 v48, v48, v49
    v_cvt_pk_bf16_f32 v48, v50, v48
    buffer_store_dword v48, v3, s[60:63], s68 offen sc1
    v_add_u32 v3, 294912, v3
    v_add_f32 v52, v52, v53
    v_add_f32 v54, v54, v55
    v_cvt_pk_bf16_f32 v52, v52, v54
    v_lshlrev_b32 v53, 16, v13
    v_and_b32 v54, 0xffff0000, v13
    v_mul_f32 v53, v53, v5
    v_mul_f32 v54, v54, v6
    v_cvt_pk_bf16_f32 v53, v53, v54
    v_lshlrev_b32 v54, 16, v52
    v_lshlrev_b32 v55, 16, v53
    v_add_f32 v54, v54, v55
    v_and_b32 v52, 0xffff0000, v52
    v_and_b32 v53, 0xffff0000, v53
    v_add_f32 v52, v52, v53
    v_cvt_pk_bf16_f32 v52, v54, v52
    buffer_store_dword v52, v3, s[60:63], s68 offen sc1
    v_add_u32 v3, 294912, v3
    v_add_f32 v56, v56, v57
    v_add_f32 v58, v58, v59
    v_cvt_pk_bf16_f32 v56, v56, v58
    v_lshlrev_b32 v57, 16, v14
    v_and_b32 v58, 0xffff0000, v14
    v_mul_f32 v57, v57, v5
    v_mul_f32 v58, v58, v6
    v_cvt_pk_bf16_f32 v57, v57, v58
    v_lshlrev_b32 v58, 16, v56
    v_lshlrev_b32 v59, 16, v57
    v_add_f32 v58, v58, v59
    v_and_b32 v56, 0xffff0000, v56
    v_and_b32 v57, 0xffff0000, v57
    v_add_f32 v56, v56, v57
    v_cvt_pk_bf16_f32 v56, v58, v56
    buffer_store_dword v56, v3, s[60:63], s68 offen sc1
    v_add_u32 v3, 294912, v3
    v_add_f32 v60, v60, v61
    v_add_f32 v62, v62, v63
    v_cvt_pk_bf16_f32 v60, v60, v62
    v_lshlrev_b32 v61, 16, v15
    v_and_b32 v62, 0xffff0000, v15
    v_mul_f32 v61, v61, v5
    v_mul_f32 v62, v62, v6
    v_cvt_pk_bf16_f32 v61, v61, v62
    v_lshlrev_b32 v62, 16, v60
    v_lshlrev_b32 v63, 16, v61
    v_add_f32 v62, v62, v63
    v_and_b32 v60, 0xffff0000, v60
    v_and_b32 v61, 0xffff0000, v61
    v_add_f32 v60, v60, v61
    v_cvt_pk_bf16_f32 v60, v62, v60
    buffer_store_dword v60, v3, s[60:63], s68 offen sc1
    v_add_u32 v3, 294912, v3
    s_waitcnt vmcnt(0)
    s_barrier
    v_mov_b32 v1, 0
    v_mov_b32 v2, 1
    v_cmp_eq_u32 vcc, 0, v0
    s_nop 0
    s_and_saveexec_b64 s[6:7], vcc
    s_cbranch_execz L_fetch_r
    global_atomic_add v1, v2, s[4:5] offset:12
    s_mov_b64 exec, -1
    s_branch L_fetch
L_ao:
    s_sub_u32 s9, s8, 352
    s_mul_i32 s10, s9, 2979
    s_lshr_b32 s10, s10, 16
    s_mul_i32 s12, s10, 22
    s_sub_u32 s9, s9, s12
    s_cmp_ge_u32 s9, 16
    s_cbranch_scc1 L_op
    s_cmp_ge_u32 s10, 27
    s_cbranch_scc1 L_fetch
L_attn:
    s_lshr_b32 s12, s9, 3
    s_lshl_b32 s15, s10, 1
    s_add_u32 s15, s15, s12
    s_lshr_b32 s16, s15, 2
    v_readfirstlane_b32 s14, v0
    s_nop 0
    s_cmp_lg_u32 s14, 0
    s_cbranch_scc1 wb_3_ok
    s_and_b32 s12, s16, 3
    s_lshl_b32 s12, s12, 3
    s_and_b32 s13, s16, 0xfc
    v_mov_b32 v1, s13
    s_mov_b64 exec, 1
wb_3:
    global_load_dword v2, v1, s[4:5] offset:32 sc1
    s_waitcnt vmcnt(0)
    v_readfirstlane_b32 s14, v2
    s_nop 0
    s_lshr_b32 s14, s14, s12
    s_and_b32 s14, s14, 0xff
    s_cmp_ge_u32 s14, 32
    s_cbranch_scc1 wb_3_ok
    s_sleep 12
    s_branch wb_3
wb_3_ok:
    s_mov_b64 exec, -1
    s_barrier
    v_lshrrev_b32 v1, 6, v0
    s_nop 0
    v_readfirstlane_b32 s12, v1
    s_and_b32 s17, s9, 7
    s_lshl_b32 s16, s17, 2
    s_add_u32 s16, s16, s12
    s_load_dwordx2 s[40:41], s[0:1], 152
    v_and_b32 v2, 63, v0
    v_and_b32 v3, 31, v2
    v_lshrrev_b32 v4, 5, v2
    v_bfe_u32 v5, v3, 3, 1
    v_lshlrev_b32 v5, 4, v5
    v_lshrrev_b32 v6, 4, v3
    v_lshl_add_u32 v5, v6, 3, v5
    v_and_b32 v6, 7, v3
    v_add_u32 v5, v5, v6
    s_waitcnt lgkmcnt(0)
    s_mov_b32 s44, s40
    s_mov_b32 s45, s41
    s_mov_b32 s46, 268435456
    s_mov_b32 s47, 0x00020000
    s_lshl_b32 s48, s15, 5
    s_add_u32 s48, s48, s16
    s_lshl_b32 s49, s48, 13
    s_add_u32 s52, s49, 33554432
    s_add_u32 s53, s49, 0
    s_add_u32 s54, s49, 16777216
    s_lshl_b32 s49, s48, 12
    s_add_u32 s55, s49, 50331648
    s_lshl_b32 s49, s15, 18
    s_lshl_b32 s50, s16, 8
    s_add_u32 s56, s49, s50
    s_add_u32 s56, s56, 67108864
    s_mov_b32 s57, 0x3e0293ee
    v_lshrrev_b32 v6, 4, v3
    v_lshlrev_b32 v6, 10, v6
    v_and_b32 v7, 15, v3
    v_lshl_add_u32 v6, v7, 4, v6
    v_lshl_add_u32 v8, v4, 8, v6
    v_lshrrev_b32 v6, 4, v5
    v_lshlrev_b32 v6, 10, v6
    v_and_b32 v7, 15, v5
    v_lshl_add_u32 v6, v7, 4, v6
    v_lshl_add_u32 v9, v4, 8, v6
    v_and_b32 v6, 7, v3
    v_lshlrev_b32 v6, 6, v6
    v_lshl_add_u32 v10, v4, 4, v6
    v_lshrrev_b32 v6, 4, v3
    v_lshlrev_b32 v6, 4, v6
    v_bfe_u32 v7, v3, 2, 1
    v_lshl_add_u32 v6, v7, 3, v6
    v_bfe_u32 v7, v3, 3, 1
    v_lshl_add_u32 v6, v7, 2, v6
    v_and_b32 v7, 3, v3
    v_add_u32 v6, v6, v7
    v_lshrrev_b32 v7, 4, v6
    v_and_b32 v11, 15, v6
    v_lshlrev_b32 v12, 10, v7
    v_lshl_add_u32 v12, v11, 4, v12
    v_lshl_add_u32 v12, v4, 8, v12
    v_lshlrev_b32 v13, 6, v7
    v_lshl_add_u32 v13, v11, 2, v13
    v_lshl_add_u32 v13, v4, 8, v13
    v_lshlrev_b32 v14, 13, v3
    v_lshl_add_u32 v14, v4, 4, v14
    buffer_load_dwordx4 v[16:19], v8, s[44:47], s52 offen offset:0 sc1
    buffer_load_dwordx4 v[48:51], v9, s[44:47], s53 offen offset:0 sc1
    buffer_load_dwordx4 v[20:23], v8, s[44:47], s52 offen offset:512 sc1
    buffer_load_dwordx4 v[52:55], v9, s[44:47], s53 offen offset:512 sc1
    buffer_load_dwordx4 v[24:27], v8, s[44:47], s52 offen offset:2048 sc1
    buffer_load_dwordx4 v[56:59], v9, s[44:47], s53 offen offset:2048 sc1
    buffer_load_dwordx4 v[28:31], v8, s[44:47], s52 offen offset:2560 sc1
    buffer_load_dwordx4 v[60:63], v9, s[44:47], s53 offen offset:2560 sc1
    s_add_u32 s48, s52, 4096
    s_add_u32 s49, s53, 4096
    s_add_u32 s50, s54, 4096
    buffer_load_dwordx4 v[32:35], v8, s[44:47], s48 offen offset:0 sc1
    buffer_load_dwordx4 v[64:67], v9, s[44:47], s49 offen offset:0 sc1
    buffer_load_dwordx4 v[36:39], v8, s[44:47], s48 offen offset:512 sc1
    buffer_load_dwordx4 v[68:71], v9, s[44:47], s49 offen offset:512 sc1
    buffer_load_dwordx4 v[40:43], v8, s[44:47], s48 offen offset:2048 sc1
    buffer_load_dwordx4 v[72:75], v9, s[44:47], s49 offen offset:2048 sc1
    buffer_load_dwordx4 v[44:47], v8, s[44:47], s48 offen offset:2560 sc1
    buffer_load_dwordx4 v[76:79], v9, s[44:47], s49 offen offset:2560 sc1
    buffer_load_dwordx4 v[112:115], v12, s[44:47], s54 offen offset:0 sc1
    buffer_load_dwordx4 v[116:119], v12, s[44:47], s54 offen offset:512 sc1
    buffer_load_dwordx4 v[124:127], v12, s[44:47], s54 offen offset:2048 sc1
    buffer_load_dwordx4 v[128:131], v12, s[44:47], s54 offen offset:2560 sc1
    buffer_load_dwordx4 v[136:139], v12, s[44:47], s50 offen offset:0 sc1
    buffer_load_dwordx4 v[140:143], v12, s[44:47], s50 offen offset:512 sc1
    buffer_load_dwordx4 v[148:151], v12, s[44:47], s50 offen offset:2048 sc1
    buffer_load_dwordx4 v[152:155], v12, s[44:47], s50 offen offset:2560 sc1
    s_waitcnt vmcnt(8)
    v_mfma_f32_32x32x16_bf16 v[160:175], v[48:51], v[16:19], 0
    v_mfma_f32_32x32x16_bf16 v[160:175], v[52:55], v[20:23], v[160:175]
    v_mfma_f32_32x32x16_bf16 v[160:175], v[56:59], v[24:27], v[160:175]
    v_mfma_f32_32x32x16_bf16 v[160:175], v[60:63], v[28:31], v[160:175]
    v_mfma_f32_32x32x16_bf16 v[160:175], v[64:67], v[32:35], v[160:175]
    v_mfma_f32_32x32x16_bf16 v[160:175], v[68:71], v[36:39], v[160:175]
    v_mfma_f32_32x32x16_bf16 v[160:175], v[72:75], v[40:43], v[160:175]
    v_mfma_f32_32x32x16_bf16 v[160:175], v[76:79], v[44:47], v[160:175]
    s_or_b32 s30, s15, 3
    s_cmp_ge_u32 s15, 56
    s_cselect_b32 s30, s15, s30
    v_readfirstlane_b32 s14, v0
    s_nop 0
    s_cmp_lg_u32 s14, 0
    s_cbranch_scc1 wf_4_ok
    s_lshl_b32 s13, s30, 7
    s_add_u32 s13, s13, 8192
    v_mov_b32 v200, s13
    s_mov_b64 exec, 1
wf_4:
    global_load_dword v201, v200, s[26:27] sc1
    s_waitcnt vmcnt(0)
    v_readfirstlane_b32 s14, v201
    s_nop 0
    s_cmp_ge_u32 s14, 32
    s_cbranch_scc1 wf_4_ok
    s_sleep 4
    s_branch wf_4
wf_4_ok:
    s_mov_b64 exec, -1
    s_barrier
    buffer_load_dwordx4 v[80:83], v10, s[44:47], s55 offen offset:0 sc1
    buffer_load_dwordx4 v[84:87], v10, s[44:47], s55 offen offset:32 sc1
    buffer_load_dwordx4 v[88:91], v10, s[44:47], s55 offen offset:1024 sc1
    buffer_load_dwordx4 v[92:95], v10, s[44:47], s55 offen offset:1056 sc1
    buffer_load_dwordx4 v[96:99], v10, s[44:47], s55 offen offset:2048 sc1
    buffer_load_dwordx4 v[100:103], v10, s[44:47], s55 offen offset:2080 sc1
    buffer_load_dwordx4 v[104:107], v10, s[44:47], s55 offen offset:3072 sc1
    buffer_load_dwordx4 v[108:111], v10, s[44:47], s55 offen offset:3104 sc1
    buffer_load_dword v120, v13, s[44:47], s55 offen offset:512 sc1
    buffer_load_dword v121, v13, s[44:47], s55 offen offset:640 sc1
    v_mov_b32 v122, 0
    v_mov_b32 v123, 0
    buffer_load_dword v132, v13, s[44:47], s55 offen offset:1536 sc1
    buffer_load_dword v133, v13, s[44:47], s55 offen offset:1664 sc1
    v_mov_b32 v134, 0
    v_mov_b32 v135, 0
    buffer_load_dword v144, v13, s[44:47], s55 offen offset:2560 sc1
    buffer_load_dword v145, v13, s[44:47], s55 offen offset:2688 sc1
    v_mov_b32 v146, 0
    v_mov_b32 v147, 0
    buffer_load_dword v156, v13, s[44:47], s55 offen offset:3584 sc1
    buffer_load_dword v157, v13, s[44:47], s55 offen offset:3712 sc1
    v_mov_b32 v158, 0
    v_mov_b32 v159, 0
    s_waitcnt vmcnt(8)
    v_mfma_f32_32x32x16_bf16 v[176:191], v[80:83], v[16:19], 0
    v_mfma_f32_32x32x16_bf16 v[176:191], v[84:87], v[20:23], v[176:191]
    v_mfma_f32_32x32x16_bf16 v[176:191], v[88:91], v[24:27], v[176:191]
    v_mfma_f32_32x32x16_bf16 v[176:191], v[92:95], v[28:31], v[176:191]
    v_mfma_f32_32x32x16_bf16 v[176:191], v[96:99], v[32:35], v[176:191]
    v_mfma_f32_32x32x16_bf16 v[176:191], v[100:103], v[36:39], v[176:191]
    v_mfma_f32_32x32x16_bf16 v[176:191], v[104:107], v[40:43], v[176:191]
    v_mfma_f32_32x32x16_bf16 v[176:191], v[108:111], v[44:47], v[176:191]
    v_lshlrev_b32 v6, 2, v4
    v_sub_u32 v6, v3, v6
    v_mov_b32 v7, 0xff800000
    v_cmp_gt_i32 vcc, 0, v6
    s_nop 1
    v_cndmask_b32 v160, v160, v7, vcc
    v_cmp_gt_i32 vcc, 1, v6
    s_nop 1
    v_cndmask_b32 v161, v161, v7, vcc
    v_cmp_gt_i32 vcc, 2, v6
    s_nop 1
    v_cndmask_b32 v162, v162, v7, vcc
    v_cmp_gt_i32 vcc, 3, v6
    s_nop 1
    v_cndmask_b32 v163, v163, v7, vcc
    v_cmp_gt_i32 vcc, 16, v6
    s_nop 1
    v_cndmask_b32 v164, v164, v7, vcc
    v_cmp_gt_i32 vcc, 17, v6
    s_nop 1
    v_cndmask_b32 v165, v165, v7, vcc
    v_cmp_gt_i32 vcc, 18, v6
    s_nop 1
    v_cndmask_b32 v166, v166, v7, vcc
    v_cmp_gt_i32 vcc, 19, v6
    s_nop 1
    v_cndmask_b32 v167, v167, v7, vcc
    v_cmp_gt_i32 vcc, 8, v6
    s_nop 1
    v_cndmask_b32 v168, v168, v7, vcc
    v_cmp_gt_i32 vcc, 9, v6
    s_nop 1
    v_cndmask_b32 v169, v169, v7, vcc
    v_cmp_gt_i32 vcc, 10, v6
    s_nop 1
    v_cndmask_b32 v170, v170, v7, vcc
    v_cmp_gt_i32 vcc, 11, v6
    s_nop 1
    v_cndmask_b32 v171, v171, v7, vcc
    v_cmp_gt_i32 vcc, 24, v6
    s_nop 1
    v_cndmask_b32 v172, v172, v7, vcc
    v_cmp_gt_i32 vcc, 25, v6
    s_nop 1
    v_cndmask_b32 v173, v173, v7, vcc
    v_cmp_gt_i32 vcc, 26, v6
    s_nop 1
    v_cndmask_b32 v174, v174, v7, vcc
    v_cmp_gt_i32 vcc, 27, v6
    s_nop 1
    v_cndmask_b32 v175, v175, v7, vcc
    v_max3_f32 v15, v160, v161, v162
    v_max3_f32 v15, v15, v163, v164
    v_max3_f32 v15, v15, v165, v166
    v_max3_f32 v15, v15, v167, v168
    v_max3_f32 v15, v15, v169, v170
    v_max3_f32 v15, v15, v171, v172
    v_max3_f32 v15, v15, v173, v174
    v_max3_f32 v15, v15, v175, v176
    v_max3_f32 v15, v15, v177, v178
    v_max_f32 v15, v15, v179
    v_mov_b32 v6, v15
    s_nop 1
    v_permlane32_swap_b32 v6, v15
    v_max_f32 v15, v15, v6
    v_mul_f32 v15, s57, v15
    v_fma_f32 v160, v160, s57, -v15
    v_fma_f32 v161, v161, s57, -v15
    v_fma_f32 v162, v162, s57, -v15
    v_fma_f32 v163, v163, s57, -v15
    v_fma_f32 v164, v164, s57, -v15
    v_fma_f32 v165, v165, s57, -v15
    v_fma_f32 v166, v166, s57, -v15
    v_fma_f32 v167, v167, s57, -v15
    v_fma_f32 v168, v168, s57, -v15
    v_fma_f32 v169, v169, s57, -v15
    v_fma_f32 v170, v170, s57, -v15
    v_fma_f32 v171, v171, s57, -v15
    v_fma_f32 v172, v172, s57, -v15
    v_fma_f32 v173, v173, s57, -v15
    v_fma_f32 v174, v174, s57, -v15
    v_fma_f32 v175, v175, s57, -v15
    v_fma_f32 v176, v176, s57, -v15
    v_fma_f32 v177, v177, s57, -v15
    v_fma_f32 v178, v178, s57, -v15
    v_fma_f32 v179, v179, s57, -v15
    v_exp_f32 v160, v160
    v_exp_f32 v161, v161
    v_exp_f32 v162, v162
    v_exp_f32 v163, v163
    v_exp_f32 v164, v164
    v_exp_f32 v165, v165
    v_exp_f32 v166, v166
    v_exp_f32 v167, v167
    v_exp_f32 v168, v168
    v_exp_f32 v169, v169
    v_exp_f32 v170, v170
    v_exp_f32 v171, v171
    v_exp_f32 v172, v172
    v_exp_f32 v173, v173
    v_exp_f32 v174, v174
    v_exp_f32 v175, v175
    v_exp_f32 v176, v176
    v_exp_f32 v177, v177
    v_exp_f32 v178, v178
    v_exp_f32 v179, v179
    v_add_f32 v15, v160, v161
    v_add_f32 v15, v15, v162
    v_add_f32 v15, v15, v163
    v_add_f32 v15, v15, v164
    v_add_f32 v15, v15, v165
    v_add_f32 v15, v15, v166
    v_add_f32 v15, v15, v167
    v_add_f32 v15, v15, v168
    v_add_f32 v15, v15, v169
    v_add_f32 v15, v15, v170
    v_add_f32 v15, v15, v171
    v_add_f32 v15, v15, v172
    v_add_f32 v15, v15, v173
    v_add_f32 v15, v15, v174
    v_add_f32 v15, v15, v175
    v_add_f32 v15, v15, v176
    v_add_f32 v15, v15, v177
    v_add_f32 v15, v15, v178
    v_add_f32 v15, v15, v179
    v_mov_b32 v6, v15
    s_nop 1
    v_permlane32_swap_b32 v6, v15
    v_add_f32 v15, v15, v6
    v_rcp_f32 v15, v15
    s_nop 0
    v_mul_f32 v160, v160, v15
    v_mul_f32 v161, v161, v15
    v_mul_f32 v162, v162, v15
    v_mul_f32 v163, v163, v15
    v_mul_f32 v164, v164, v15
    v_mul_f32 v165, v165, v15
    v_mul_f32 v166, v166, v15
    v_mul_f32 v167, v167, v15
    v_mul_f32 v168, v168, v15
    v_mul_f32 v169, v169, v15
    v_mul_f32 v170, v170, v15
    v_mul_f32 v171, v171, v15
    v_mul_f32 v172, v172, v15
    v_mul_f32 v173, v173, v15
    v_mul_f32 v174, v174, v15
    v_mul_f32 v175, v175, v15
    v_mul_f32 v176, v176, v15
    v_mul_f32 v177, v177, v15
    v_mul_f32 v178, v178, v15
    v_mul_f32 v179, v179, v15
    v_cvt_pk_bf16_f32 v16, v160, v161
    v_cvt_pk_bf16_f32 v17, v164, v165
    v_cvt_pk_bf16_f32 v18, v162, v163
    v_cvt_pk_bf16_f32 v19, v166, v167
    v_cvt_pk_bf16_f32 v20, v168, v169
    v_cvt_pk_bf16_f32 v21, v172, v173
    v_cvt_pk_bf16_f32 v22, v170, v171
    v_cvt_pk_bf16_f32 v23, v174, v175
    v_cvt_pk_bf16_f32 v24, v176, v177
    v_cvt_pk_bf16_f32 v25, v178, v179
    v_mov_b32 v26, 0
    v_mov_b32 v27, 0
    s_waitcnt vmcnt(0)
    v_mfma_f32_32x32x16_bf16 v[48:63], v[112:115], v[16:19], 0
    v_mfma_f32_32x32x16_bf16 v[48:63], v[116:119], v[20:23], v[48:63]
    v_mfma_f32_32x32x16_bf16 v[48:63], v[120:123], v[24:27], v[48:63]
    v_mfma_f32_32x32x16_bf16 v[64:79], v[124:127], v[16:19], 0
    v_mfma_f32_32x32x16_bf16 v[64:79], v[128:131], v[20:23], v[64:79]
    v_mfma_f32_32x32x16_bf16 v[64:79], v[132:135], v[24:27], v[64:79]
    v_mfma_f32_32x32x16_bf16 v[80:95], v[136:139], v[16:19], 0
    v_mfma_f32_32x32x16_bf16 v[80:95], v[140:143], v[20:23], v[80:95]
    v_mfma_f32_32x32x16_bf16 v[80:95], v[144:147], v[24:27], v[80:95]
    v_mfma_f32_32x32x16_bf16 v[96:111], v[148:151], v[16:19], 0
    v_mfma_f32_32x32x16_bf16 v[96:111], v[152:155], v[20:23], v[96:111]
    v_mfma_f32_32x32x16_bf16 v[96:111], v[156:159], v[24:27], v[96:111]
    s_nop 2
    v_cvt_pk_bf16_f32 v160, v48, v49
    v_cvt_pk_bf16_f32 v161, v50, v51
    v_cvt_pk_bf16_f32 v162, v52, v53
    v_cvt_pk_bf16_f32 v163, v54, v55
    buffer_store_dwordx4 v[160:163], v14, s[44:47], s56 offen offset:0 sc1
    v_cvt_pk_bf16_f32 v164, v56, v57
    v_cvt_pk_bf16_f32 v165, v58, v59
    v_cvt_pk_bf16_f32 v166, v60, v61
    v_cvt_pk_bf16_f32 v167, v62, v63
    buffer_store_dwordx4 v[164:167], v14, s[44:47], s56 offen offset:32 sc1
    v_cvt_pk_bf16_f32 v168, v64, v65
    v_cvt_pk_bf16_f32 v169, v66, v67
    v_cvt_pk_bf16_f32 v170, v68, v69
    v_cvt_pk_bf16_f32 v171, v70, v71
    buffer_store_dwordx4 v[168:171], v14, s[44:47], s56 offen offset:64 sc1
    v_cvt_pk_bf16_f32 v172, v72, v73
    v_cvt_pk_bf16_f32 v173, v74, v75
    v_cvt_pk_bf16_f32 v174, v76, v77
    v_cvt_pk_bf16_f32 v175, v78, v79
    buffer_store_dwordx4 v[172:175], v14, s[44:47], s56 offen offset:96 sc1
    v_cvt_pk_bf16_f32 v176, v80, v81
    v_cvt_pk_bf16_f32 v177, v82, v83
    v_cvt_pk_bf16_f32 v178, v84, v85
    v_cvt_pk_bf16_f32 v179, v86, v87
    buffer_store_dwordx4 v[176:179], v14, s[44:47], s56 offen offset:128 sc1
    v_cvt_pk_bf16_f32 v180, v88, v89
    v_cvt_pk_bf16_f32 v181, v90, v91
    v_cvt_pk_bf16_f32 v182, v92, v93
    v_cvt_pk_bf16_f32 v183, v94, v95
    buffer_store_dwordx4 v[180:183], v14, s[44:47], s56 offen offset:160 sc1
    v_cvt_pk_bf16_f32 v184, v96, v97
    v_cvt_pk_bf16_f32 v185, v98, v99
    v_cvt_pk_bf16_f32 v186, v100, v101
    v_cvt_pk_bf16_f32 v187, v102, v103
    buffer_store_dwordx4 v[184:187], v14, s[44:47], s56 offen offset:192 sc1
    v_cvt_pk_bf16_f32 v188, v104, v105
    v_cvt_pk_bf16_f32 v189, v106, v107
    v_cvt_pk_bf16_f32 v190, v108, v109
    v_cvt_pk_bf16_f32 v191, v110, v111
    buffer_store_dwordx4 v[188:191], v14, s[44:47], s56 offen offset:224 sc1
    s_waitcnt vmcnt(0)
    s_barrier
    s_lshl_b32 s13, s10, 7
    s_add_u32 s13, s13, 0
    v_mov_b32 v1, s13
    v_mov_b32 v2, 1
    v_cmp_eq_u32 vcc, 0, v0
    s_nop 0
    s_and_saveexec_b64 s[6:7], vcc
    s_cbranch_execz L_fetch_r
    global_atomic_add v1, v2, s[26:27]
    s_mov_b64 exec, -1
    s_branch L_fetch
L_op:
    s_cmp_lt_u32 s10, 1
    s_cbranch_scc1 L_fetch
    s_sub_u32 s15, s10, 1
    s_cmp_ge_u32 s15, 27
    s_cbranch_scc1 L_fetch
    s_sub_u32 s16, s9, 16
    v_readfirstlane_b32 s14, v0
    s_nop 0
    s_cmp_lg_u32 s14, 0
    s_cbranch_scc1 wd_5_ok
    v_mov_b32 v1, 0
    s_mov_b64 exec, 1
wd_5:
    global_load_dword v2, v1, s[4:5] offset:12 sc1
    s_waitcnt vmcnt(0)
    v_readfirstlane_b32 s14, v2
    s_nop 0
    s_cmp_ge_u32 s14, 352
    s_cbranch_scc1 wd_5_ok
    s_sleep 12
    s_branch wd_5
wd_5_ok:
    s_mov_b64 exec, -1
    s_barrier
    v_readfirstlane_b32 s14, v0
    s_nop 0
    s_cmp_lg_u32 s14, 0
    s_cbranch_scc1 wf_6_ok
    s_lshl_b32 s13, s15, 7
    s_add_u32 s13, s13, 0
    v_mov_b32 v1, s13
    s_mov_b64 exec, 1
wf_6:
    global_load_dword v2, v1, s[26:27] sc1
    s_waitcnt vmcnt(0)
    v_readfirstlane_b32 s14, v2
    s_nop 0
    s_cmp_ge_u32 s14, 16
    s_cbranch_scc1 wf_6_ok
    s_sleep 4
    s_branch wf_6
wf_6_ok:
    s_mov_b64 exec, -1
    s_barrier
    s_load_dwordx2 s[40:41], s[0:1], 112
    s_load_dwordx2 s[42:43], s[0:1], 152
    s_load_dwordx2 s[44:45], s[0:1], 136
    v_lshrrev_b32 v1, 6, v0
    v_and_b32 v2, 63, v0
    v_readfirstlane_b32 s56, v1
    s_waitcnt lgkmcnt(0)
    s_mov_b32 s48, s42
    s_mov_b32 s49, s43
    s_mov_b32 s50, 268435456
    s_mov_b32 s51, 0x00020000
    s_mov_b32 s52, s44
    s_mov_b32 s53, s45
    s_mov_b32 s54, 2359296
    s_mov_b32 s55, 0x00020000
    s_add_u32 s62, s42, 67108864
    s_addc_u32 s63, s43, 0
    s_mul_i32 s65, s56, 40960
    v_lshrrev_b32 v7, 3, v2
    v_and_b32 v8, 7, v2
    v_xor_b32 v8, v8, v7
    s_lshl_b32 s57, s15, 6
    v_add_u32 v7, s57, v7
    v_lshlrev_b32 v7, 13, v7
    v_lshl_add_u32 v7, v8, 4, v7
    s_mul_i32 s59, s56, 1024
    s_lshl_b32 s57, s59, 1
    v_add_u32 v3, s57, v7
    s_mul_i32 s57, s59, 1152
    s_mul_i32 s58, s16, 192
    s_add_u32 s57, s57, s58
    s_mov_b32 s58, 0xaaab
    v_add_u32 v7, 0, v2
    v_mul_u32_u24 v8, s58, v7
    v_lshrrev_b32 v8, 19, v8
    v_mul_u32_u24 v9, 12, v8
    v_sub_u32 v9, v7, v9
    v_mul_u32_u24 v8, 1152, v8
    v_lshl_add_u32 v8, v9, 4, v8
    v_add_u32 v4, s57, v8
    v_add_u32 v7, 64, v2
    v_mul_u32_u24 v8, s58, v7
    v_lshrrev_b32 v8, 19, v8
    v_mul_u32_u24 v9, 12, v8
    v_sub_u32 v9, v7, v9
    v_mul_u32_u24 v8, 1152, v8
    v_lshl_add_u32 v8, v9, 4, v8
    v_add_u32 v5, s57, v8
    v_add_u32 v7, 128, v2
    v_mul_u32_u24 v8, s58, v7
    v_lshrrev_b32 v8, 19, v8
    v_mul_u32_u24 v9, 12, v8
    v_sub_u32 v9, v7, v9
    v_mul_u32_u24 v8, 1152, v8
    v_lshl_add_u32 v8, v9, 4, v8
    v_add_u32 v6, s57, v8
    v_and_b32 v14, 31, v2
    v_and_b32 v7, 7, v14
    v_lshrrev_b32 v12, 5, v2
    v_add_u32 v13, 0, v12
    v_xor_b32 v13, v13, v7
    v_lshlrev_b32 v13, 4, v13
    v_lshl_add_u32 v13, v14, 7, v13
    v_add_u32 v8, s65, v13
    v_add_u32 v13, 2, v12
    v_xor_b32 v13, v13, v7
    v_lshlrev_b32 v13, 4, v13
    v_lshl_add_u32 v13, v14, 7, v13
    v_add_u32 v9, s65, v13
    v_add_u32 v13, 4, v12
    v_xor_b32 v13, v13, v7
    v_lshlrev_b32 v13, 4, v13
    v_lshl_add_u32 v13, v14, 7, v13
    v_add_u32 v10, s65, v13
    v_add_u32 v13, 6, v12
    v_xor_b32 v13, v13, v7
    v_lshlrev_b32 v13, 4, v13
    v_lshl_add_u32 v13, v14, 7, v13
    v_add_u32 v11, s65, v13
    v_bfe_u32 v7, v2, 2, 2
    v_lshl_add_u32 v7, v12, 3, v7
    v_mul_u32_u24 v7, 192, v7
    v_bfe_u32 v13, v2, 4, 1
    v_lshl_add_u32 v7, v13, 5, v7
    v_and_b32 v13, 1, v2
    v_lshl_add_u32 v7, v13, 4, v7
    v_bfe_u32 v13, v2, 1, 1
    v_lshl_add_u32 v7, v13, 3, v7
    s_add_u32 s57, s65, 8192
    v_add_u32 v15, s57, v7
    v_mov_b32 v64, 0
    v_mov_b32 v65, 0
    v_mov_b32 v66, 0
    v_mov_b32 v67, 0
    v_mov_b32 v68, 0
    v_mov_b32 v69, 0
    v_mov_b32 v70, 0
    v_mov_b32 v71, 0
    v_mov_b32 v72, 0
    v_mov_b32 v73, 0
    v_mov_b32 v74, 0
    v_mov_b32 v75, 0
    v_mov_b32 v76, 0
    v_mov_b32 v77, 0
    v_mov_b32 v78, 0
    v_mov_b32 v79, 0
    v_mov_b32 v80, 0
    v_mov_b32 v81, 0
    v_mov_b32 v82, 0
    v_mov_b32 v83, 0
    v_mov_b32 v84, 0
    v_mov_b32 v85, 0
    v_mov_b32 v86, 0
    v_mov_b32 v87, 0
    v_mov_b32 v88, 0
    v_mov_b32 v89, 0
    v_mov_b32 v90, 0
    v_mov_b32 v91, 0
    v_mov_b32 v92, 0
    v_mov_b32 v93, 0
    v_mov_b32 v94, 0
    v_mov_b32 v95, 0
    v_mov_b32 v96, 0
    v_mov_b32 v97, 0
    v_mov_b32 v98, 0
    v_mov_b32 v99, 0
    v_mov_b32 v100, 0
    v_mov_b32 v101, 0
    v_mov_b32 v102, 0
    v_mov_b32 v103, 0
    v_mov_b32 v104, 0
    v_mov_b32 v105, 0
    v_mov_b32 v106, 0
    v_mov_b32 v107, 0
    v_mov_b32 v108, 0
    v_mov_b32 v109, 0
    v_mov_b32 v110, 0
    v_mov_b32 v111, 0
    v_mov_b32 v112, 0
    v_mov_b32 v113, 0
    v_mov_b32 v114, 0
    v_mov_b32 v115, 0
    v_mov_b32 v116, 0
    v_mov_b32 v117, 0
    v_mov_b32 v118, 0
    v_mov_b32 v119, 0
    v_mov_b32 v120, 0
    v_mov_b32 v121, 0
    v_mov_b32 v122, 0
    v_mov_b32 v123, 0
    v_mov_b32 v124, 0
    v_mov_b32 v125, 0
    v_mov_b32 v126, 0
    v_mov_b32 v127, 0
    v_mov_b32 v128, 0
    v_mov_b32 v129, 0
    v_mov_b32 v130, 0
    v_mov_b32 v131, 0
    v_mov_b32 v132, 0
    v_mov_b32 v133, 0
    v_mov_b32 v134, 0
    v_mov_b32 v135, 0
    v_mov_b32 v136, 0
    v_mov_b32 v137, 0
    v_mov_b32 v138, 0
    v_mov_b32 v139, 0
    v_mov_b32 v140, 0
    v_mov_b32 v141, 0
    v_mov_b32 v142, 0
    v_mov_b32 v143, 0
    v_mov_b32 v144, 0
    v_mov_b32 v145, 0
    v_mov_b32 v146, 0
    v_mov_b32 v147, 0
    v_mov_b32 v148, 0
    v_mov_b32 v149, 0
    v_mov_b32 v150, 0
    v_mov_b32 v151, 0
    v_mov_b32 v152, 0
    v_mov_b32 v153, 0
    v_mov_b32 v154, 0
    v_mov_b32 v155, 0
    v_mov_b32 v156, 0
    v_mov_b32 v157, 0
    v_mov_b32 v158, 0
    v_mov_b32 v159, 0
    s_add_u32 s64, s65, 0
    v_mov_b32 v7, v3
    s_mov_b32 m0, s64
    s_add_u32 s64, s64, 1024
    global_load_lds_dwordx4 v7, s[62:63] sc1
    v_add_u32 v7, 65536, v7
    s_mov_b32 m0, s64
    s_add_u32 s64, s64, 1024
    global_load_lds_dwordx4 v7, s[62:63] sc1
    v_add_u32 v7, 65536, v7
    s_mov_b32 m0, s64
    s_add_u32 s64, s64, 1024
    global_load_lds_dwordx4 v7, s[62:63] sc1
    v_add_u32 v7, 65536, v7
    s_mov_b32 m0, s64
    s_add_u32 s64, s64, 1024
    global_load_lds_dwordx4 v7, s[62:63] sc1
    v_add_u32 v7, 65536, v7
    s_mov_b32 m0, s64
    s_add_u32 s64, s64, 1024
    global_load_lds_dwordx4 v7, s[62:63] sc1
    v_add_u32 v7, 65536, v7
    s_mov_b32 m0, s64
    s_add_u32 s64, s64, 1024
    global_load_lds_dwordx4 v7, s[62:63] sc1
    v_add_u32 v7, 65536, v7
    s_mov_b32 m0, s64
    s_add_u32 s64, s64, 1024
    global_load_lds_dwordx4 v7, s[62:63] sc1
    v_add_u32 v7, 65536, v7
    s_mov_b32 m0, s64
    s_add_u32 s64, s64, 1024
    global_load_lds_dwordx4 v7, s[62:63] sc1
    v_add_u32 v7, 65536, v7
    s_mov_b32 m0, s64
    s_add_u32 s64, s64, 1024
    global_load_lds_dwordx4 v4, s[40:41]
    v_add_u32 v4, 18432, v4
    s_mov_b32 m0, s64
    s_add_u32 s64, s64, 1024
    global_load_lds_dwordx4 v5, s[40:41]
    v_add_u32 v5, 18432, v5
    s_mov_b32 m0, s64
    s_add_u32 s64, s64, 1024
    global_load_lds_dwordx4 v6, s[40:41]
    v_add_u32 v6, 18432, v6
    s_mov_b32 m0, s64
    s_add_u32 s64, s64, 1024
    global_load_lds_dwordx4 v4, s[40:41]
    v_add_u32 v4, 18432, v4
    s_mov_b32 m0, s64
    s_add_u32 s64, s64, 1024
    global_load_lds_dwordx4 v5, s[40:41]
    v_add_u32 v5, 18432, v5
    s_mov_b32 m0, s64
    s_add_u32 s64, s64, 1024
    global_load_lds_dwordx4 v6, s[40:41]
    v_add_u32 v6, 18432, v6
    s_mov_b32 m0, s64
    s_add_u32 s64, s64, 1024
    global_load_lds_dwordx4 v4, s[40:41]
    v_add_u32 v4, 18432, v4
    s_mov_b32 m0, s64
    s_add_u32 s64, s64, 1024
    global_load_lds_dwordx4 v5, s[40:41]
    v_add_u32 v5, 18432, v5
    s_mov_b32 m0, s64
    s_add_u32 s64, s64, 1024
    global_load_lds_dwordx4 v6, s[40:41]
    v_add_u32 v6, 18432, v6
    s_mov_b32 m0, s64
    s_add_u32 s64, s64, 1024
    global_load_lds_dwordx4 v4, s[40:41]
    v_add_u32 v4, 18432, v4
    s_mov_b32 m0, s64
    s_add_u32 s64, s64, 1024
    global_load_lds_dwordx4 v5, s[40:41]
    v_add_u32 v5, 18432, v5
    s_mov_b32 m0, s64
    s_add_u32 s64, s64, 1024
    global_load_lds_dwordx4 v6, s[40:41]
    v_add_u32 v6, 18432, v6
    v_add_u32 v3, 128, v3
    s_mov_b32 s66, 0
opl_7:
    s_add_u32 s64, s65, 20480
    v_mov_b32 v7, v3
    s_mov_b32 m0, s64
    s_add_u32 s64, s64, 1024
    global_load_lds_dwordx4 v7, s[62:63] sc1
    v_add_u32 v7, 65536, v7
    s_mov_b32 m0, s64
    s_add_u32 s64, s64, 1024
    global_load_lds_dwordx4 v7, s[62:63] sc1
    v_add_u32 v7, 65536, v7
    s_mov_b32 m0, s64
    s_add_u32 s64, s64, 1024
    global_load_lds_dwordx4 v7, s[62:63] sc1
    v_add_u32 v7, 65536, v7
    s_mov_b32 m0, s64
    s_add_u32 s64, s64, 1024
    global_load_lds_dwordx4 v7, s[62:63] sc1
    v_add_u32 v7, 65536, v7
    s_mov_b32 m0, s64
    s_add_u32 s64, s64, 1024
    global_load_lds_dwordx4 v7, s[62:63] sc1
    v_add_u32 v7, 65536, v7
    s_mov_b32 m0, s64
    s_add_u32 s64, s64, 1024
    global_load_lds_dwordx4 v7, s[62:63] sc1
    v_add_u32 v7, 65536, v7
    s_mov_b32 m0, s64
    s_add_u32 s64, s64, 1024
    global_load_lds_dwordx4 v7, s[62:63] sc1
    v_add_u32 v7, 65536, v7
    s_mov_b32 m0, s64
    s_add_u32 s64, s64, 1024
    global_load_lds_dwordx4 v7, s[62:63] sc1
    v_add_u32 v7, 65536, v7
    s_mov_b32 m0, s64
    s_add_u32 s64, s64, 1024
    global_load_lds_dwordx4 v4, s[40:41]
    v_add_u32 v4, 18432, v4
    s_mov_b32 m0, s64
    s_add_u32 s64, s64, 1024
    global_load_lds_dwordx4 v5, s[40:41]
    v_add_u32 v5, 18432, v5
    s_mov_b32 m0, s64
    s_add_u32 s64, s64, 1024
    global_load_lds_dwordx4 v6, s[40:41]
    v_add_u32 v6, 18432, v6
    s_mov_b32 m0, s64
    s_add_u32 s64, s64, 1024
    global_load_lds_dwordx4 v4, s[40:41]
    v_add_u32 v4, 18432, v4
    s_mov_b32 m0, s64
    s_add_u32 s64, s64, 1024
    global_load_lds_dwordx4 v5, s[40:41]
    v_add_u32 v5, 18432, v5
    s_mov_b32 m0, s64
    s_add_u32 s64, s64, 1024
    global_load_lds_dwordx4 v6, s[40:41]
    v_add_u32 v6, 18432, v6
    s_mov_b32 m0, s64
    s_add_u32 s64, s64, 1024
    global_load_lds_dwordx4 v4, s[40:41]
    v_add_u32 v4, 18432, v4
    s_mov_b32 m0, s64
    s_add_u32 s64, s64, 1024
    global_load_lds_dwordx4 v5, s[40:41]
    v_add_u32 v5, 18432, v5
    s_mov_b32 m0, s64
    s_add_u32 s64, s64, 1024
    global_load_lds_dwordx4 v6, s[40:41]
    v_add_u32 v6, 18432, v6
    s_mov_b32 m0, s64
    s_add_u32 s64, s64, 1024
    global_load_lds_dwordx4 v4, s[40:41]
    v_add_u32 v4, 18432, v4
    s_mov_b32 m0, s64
    s_add_u32 s64, s64, 1024
    global_load_lds_dwordx4 v5, s[40:41]
    v_add_u32 v5, 18432, v5
    s_mov_b32 m0, s64
    s_add_u32 s64, s64, 1024
    global_load_lds_dwordx4 v6, s[40:41]
    v_add_u32 v6, 18432, v6
    v_add_u32 v3, 128, v3
    s_waitcnt vmcnt(20)
    ds_read_b128 v[16:19], v8 offset:0
    ds_read_b128 v[20:23], v8 offset:4096
    ds_read_b64_tr_b16 v[24:25], v15 offset:0
    ds_read_b64_tr_b16 v[26:27], v15 offset:768
    ds_read_b64_tr_b16 v[28:29], v15 offset:64
    ds_read_b64_tr_b16 v[30:31], v15 offset:832
    ds_read_b64_tr_b16 v[32:33], v15 offset:128
    ds_read_b64_tr_b16 v[34:35], v15 offset:896
    ds_read_b128 v[40:43], v9 offset:0
    ds_read_b128 v[44:47], v9 offset:4096
    ds_read_b64_tr_b16 v[48:49], v15 offset:3072
    ds_read_b64_tr_b16 v[50:51], v15 offset:3840
    ds_read_b64_tr_b16 v[52:53], v15 offset:3136
    ds_read_b64_tr_b16 v[54:55], v15 offset:3904
    ds_read_b64_tr_b16 v[56:57], v15 offset:3200
    ds_read_b64_tr_b16 v[58:59], v15 offset:3968
    s_waitcnt lgkmcnt(8)
    v_mfma_f32_32x32x16_bf16 v[64:79], v[24:27], v[16:19], v[64:79]
    v_mfma_f32_32x32x16_bf16 v[80:95], v[24:27], v[20:23], v[80:95]
    v_mfma_f32_32x32x16_bf16 v[96:111], v[28:31], v[16:19], v[96:111]
    v_mfma_f32_32x32x16_bf16 v[112:127], v[28:31], v[20:23], v[112:127]
    v_mfma_f32_32x32x16_bf16 v[128:143], v[32:35], v[16:19], v[128:143]
    v_mfma_f32_32x32x16_bf16 v[144:159], v[32:35], v[20:23], v[144:159]
    ds_read_b128 v[16:19], v10 offset:0
    ds_read_b128 v[20:23], v10 offset:4096
    ds_read_b64_tr_b16 v[24:25], v15 offset:6144
    ds_read_b64_tr_b16 v[26:27], v15 offset:6912
    ds_read_b64_tr_b16 v[28:29], v15 offset:6208
    ds_read_b64_tr_b16 v[30:31], v15 offset:6976
    ds_read_b64_tr_b16 v[32:33], v15 offset:6272
    ds_read_b64_tr_b16 v[34:35], v15 offset:7040
    s_waitcnt lgkmcnt(8)
    v_mfma_f32_32x32x16_bf16 v[64:79], v[48:51], v[40:43], v[64:79]
    v_mfma_f32_32x32x16_bf16 v[80:95], v[48:51], v[44:47], v[80:95]
    v_mfma_f32_32x32x16_bf16 v[96:111], v[52:55], v[40:43], v[96:111]
    v_mfma_f32_32x32x16_bf16 v[112:127], v[52:55], v[44:47], v[112:127]
    v_mfma_f32_32x32x16_bf16 v[128:143], v[56:59], v[40:43], v[128:143]
    v_mfma_f32_32x32x16_bf16 v[144:159], v[56:59], v[44:47], v[144:159]
    ds_read_b128 v[40:43], v11 offset:0
    ds_read_b128 v[44:47], v11 offset:4096
    ds_read_b64_tr_b16 v[48:49], v15 offset:9216
    ds_read_b64_tr_b16 v[50:51], v15 offset:9984
    ds_read_b64_tr_b16 v[52:53], v15 offset:9280
    ds_read_b64_tr_b16 v[54:55], v15 offset:10048
    ds_read_b64_tr_b16 v[56:57], v15 offset:9344
    ds_read_b64_tr_b16 v[58:59], v15 offset:10112
    s_waitcnt lgkmcnt(8)
    v_mfma_f32_32x32x16_bf16 v[64:79], v[24:27], v[16:19], v[64:79]
    v_mfma_f32_32x32x16_bf16 v[80:95], v[24:27], v[20:23], v[80:95]
    v_mfma_f32_32x32x16_bf16 v[96:111], v[28:31], v[16:19], v[96:111]
    v_mfma_f32_32x32x16_bf16 v[112:127], v[28:31], v[20:23], v[112:127]
    v_mfma_f32_32x32x16_bf16 v[128:143], v[32:35], v[16:19], v[128:143]
    v_mfma_f32_32x32x16_bf16 v[144:159], v[32:35], v[20:23], v[144:159]
    s_waitcnt lgkmcnt(0)
    v_mfma_f32_32x32x16_bf16 v[64:79], v[48:51], v[40:43], v[64:79]
    v_mfma_f32_32x32x16_bf16 v[80:95], v[48:51], v[44:47], v[80:95]
    v_mfma_f32_32x32x16_bf16 v[96:111], v[52:55], v[40:43], v[96:111]
    v_mfma_f32_32x32x16_bf16 v[112:127], v[52:55], v[44:47], v[112:127]
    v_mfma_f32_32x32x16_bf16 v[128:143], v[56:59], v[40:43], v[128:143]
    v_mfma_f32_32x32x16_bf16 v[144:159], v[56:59], v[44:47], v[144:159]
    s_add_u32 s64, s65, 0
    v_mov_b32 v7, v3
    s_mov_b32 m0, s64
    s_add_u32 s64, s64, 1024
    global_load_lds_dwordx4 v7, s[62:63] sc1
    v_add_u32 v7, 65536, v7
    s_mov_b32 m0, s64
    s_add_u32 s64, s64, 1024
    global_load_lds_dwordx4 v7, s[62:63] sc1
    v_add_u32 v7, 65536, v7
    s_mov_b32 m0, s64
    s_add_u32 s64, s64, 1024
    global_load_lds_dwordx4 v7, s[62:63] sc1
    v_add_u32 v7, 65536, v7
    s_mov_b32 m0, s64
    s_add_u32 s64, s64, 1024
    global_load_lds_dwordx4 v7, s[62:63] sc1
    v_add_u32 v7, 65536, v7
    s_mov_b32 m0, s64
    s_add_u32 s64, s64, 1024
    global_load_lds_dwordx4 v7, s[62:63] sc1
    v_add_u32 v7, 65536, v7
    s_mov_b32 m0, s64
    s_add_u32 s64, s64, 1024
    global_load_lds_dwordx4 v7, s[62:63] sc1
    v_add_u32 v7, 65536, v7
    s_mov_b32 m0, s64
    s_add_u32 s64, s64, 1024
    global_load_lds_dwordx4 v7, s[62:63] sc1
    v_add_u32 v7, 65536, v7
    s_mov_b32 m0, s64
    s_add_u32 s64, s64, 1024
    global_load_lds_dwordx4 v7, s[62:63] sc1
    v_add_u32 v7, 65536, v7
    s_mov_b32 m0, s64
    s_add_u32 s64, s64, 1024
    global_load_lds_dwordx4 v4, s[40:41]
    v_add_u32 v4, 18432, v4
    s_mov_b32 m0, s64
    s_add_u32 s64, s64, 1024
    global_load_lds_dwordx4 v5, s[40:41]
    v_add_u32 v5, 18432, v5
    s_mov_b32 m0, s64
    s_add_u32 s64, s64, 1024
    global_load_lds_dwordx4 v6, s[40:41]
    v_add_u32 v6, 18432, v6
    s_mov_b32 m0, s64
    s_add_u32 s64, s64, 1024
    global_load_lds_dwordx4 v4, s[40:41]
    v_add_u32 v4, 18432, v4
    s_mov_b32 m0, s64
    s_add_u32 s64, s64, 1024
    global_load_lds_dwordx4 v5, s[40:41]
    v_add_u32 v5, 18432, v5
    s_mov_b32 m0, s64
    s_add_u32 s64, s64, 1024
    global_load_lds_dwordx4 v6, s[40:41]
    v_add_u32 v6, 18432, v6
    s_mov_b32 m0, s64
    s_add_u32 s64, s64, 1024
    global_load_lds_dwordx4 v4, s[40:41]
    v_add_u32 v4, 18432, v4
    s_mov_b32 m0, s64
    s_add_u32 s64, s64, 1024
    global_load_lds_dwordx4 v5, s[40:41]
    v_add_u32 v5, 18432, v5
    s_mov_b32 m0, s64
    s_add_u32 s64, s64, 1024
    global_load_lds_dwordx4 v6, s[40:41]
    v_add_u32 v6, 18432, v6
    s_mov_b32 m0, s64
    s_add_u32 s64, s64, 1024
    global_load_lds_dwordx4 v4, s[40:41]
    v_add_u32 v4, 18432, v4
    s_mov_b32 m0, s64
    s_add_u32 s64, s64, 1024
    global_load_lds_dwordx4 v5, s[40:41]
    v_add_u32 v5, 18432, v5
    s_mov_b32 m0, s64
    s_add_u32 s64, s64, 1024
    global_load_lds_dwordx4 v6, s[40:41]
    v_add_u32 v6, 18432, v6
    v_add_u32 v3, 128, v3
    s_waitcnt vmcnt(20)
    ds_read_b128 v[16:19], v8 offset:20480
    ds_read_b128 v[20:23], v8 offset:24576
    ds_read_b64_tr_b16 v[24:25], v15 offset:20480
    ds_read_b64_tr_b16 v[26:27], v15 offset:21248
    ds_read_b64_tr_b16 v[28:29], v15 offset:20544
    ds_read_b64_tr_b16 v[30:31], v15 offset:21312
    ds_read_b64_tr_b16 v[32:33], v15 offset:20608
    ds_read_b64_tr_b16 v[34:35], v15 offset:21376
    ds_read_b128 v[40:43], v9 offset:20480
    ds_read_b128 v[44:47], v9 offset:24576
    ds_read_b64_tr_b16 v[48:49], v15 offset:23552
    ds_read_b64_tr_b16 v[50:51], v15 offset:24320
    ds_read_b64_tr_b16 v[52:53], v15 offset:23616
    ds_read_b64_tr_b16 v[54:55], v15 offset:24384
    ds_read_b64_tr_b16 v[56:57], v15 offset:23680
    ds_read_b64_tr_b16 v[58:59], v15 offset:24448
    s_waitcnt lgkmcnt(8)
    v_mfma_f32_32x32x16_bf16 v[64:79], v[24:27], v[16:19], v[64:79]
    v_mfma_f32_32x32x16_bf16 v[80:95], v[24:27], v[20:23], v[80:95]
    v_mfma_f32_32x32x16_bf16 v[96:111], v[28:31], v[16:19], v[96:111]
    v_mfma_f32_32x32x16_bf16 v[112:127], v[28:31], v[20:23], v[112:127]
    v_mfma_f32_32x32x16_bf16 v[128:143], v[32:35], v[16:19], v[128:143]
    v_mfma_f32_32x32x16_bf16 v[144:159], v[32:35], v[20:23], v[144:159]
    ds_read_b128 v[16:19], v10 offset:20480
    ds_read_b128 v[20:23], v10 offset:24576
    ds_read_b64_tr_b16 v[24:25], v15 offset:26624
    ds_read_b64_tr_b16 v[26:27], v15 offset:27392
    ds_read_b64_tr_b16 v[28:29], v15 offset:26688
    ds_read_b64_tr_b16 v[30:31], v15 offset:27456
    ds_read_b64_tr_b16 v[32:33], v15 offset:26752
    ds_read_b64_tr_b16 v[34:35], v15 offset:27520
    s_waitcnt lgkmcnt(8)
    v_mfma_f32_32x32x16_bf16 v[64:79], v[48:51], v[40:43], v[64:79]
    v_mfma_f32_32x32x16_bf16 v[80:95], v[48:51], v[44:47], v[80:95]
    v_mfma_f32_32x32x16_bf16 v[96:111], v[52:55], v[40:43], v[96:111]
    v_mfma_f32_32x32x16_bf16 v[112:127], v[52:55], v[44:47], v[112:127]
    v_mfma_f32_32x32x16_bf16 v[128:143], v[56:59], v[40:43], v[128:143]
    v_mfma_f32_32x32x16_bf16 v[144:159], v[56:59], v[44:47], v[144:159]
    ds_read_b128 v[40:43], v11 offset:20480
    ds_read_b128 v[44:47], v11 offset:24576
    ds_read_b64_tr_b16 v[48:49], v15 offset:29696
    ds_read_b64_tr_b16 v[50:51], v15 offset:30464
    ds_read_b64_tr_b16 v[52:53], v15 offset:29760
    ds_read_b64_tr_b16 v[54:55], v15 offset:30528
    ds_read_b64_tr_b16 v[56:57], v15 offset:29824
    ds_read_b64_tr_b16 v[58:59], v15 offset:30592
    s_waitcnt lgkmcnt(8)
    v_mfma_f32_32x32x16_bf16 v[64:79], v[24:27], v[16:19], v[64:79]
    v_mfma_f32_32x32x16_bf16 v[80:95], v[24:27], v[20:23], v[80:95]
    v_mfma_f32_32x32x16_bf16 v[96:111], v[28:31], v[16:19], v[96:111]
    v_mfma_f32_32x32x16_bf16 v[112:127], v[28:31], v[20:23], v[112:127]
    v_mfma_f32_32x32x16_bf16 v[128:143], v[32:35], v[16:19], v[128:143]
    v_mfma_f32_32x32x16_bf16 v[144:159], v[32:35], v[20:23], v[144:159]
    s_waitcnt lgkmcnt(0)
    v_mfma_f32_32x32x16_bf16 v[64:79], v[48:51], v[40:43], v[64:79]
    v_mfma_f32_32x32x16_bf16 v[80:95], v[48:51], v[44:47], v[80:95]
    v_mfma_f32_32x32x16_bf16 v[96:111], v[52:55], v[40:43], v[96:111]
    v_mfma_f32_32x32x16_bf16 v[112:127], v[52:55], v[44:47], v[112:127]
    v_mfma_f32_32x32x16_bf16 v[128:143], v[56:59], v[40:43], v[128:143]
    v_mfma_f32_32x32x16_bf16 v[144:159], v[56:59], v[44:47], v[144:159]
    s_add_u32 s66, s66, 1
    s_cmp_lt_u32 s66, 7
    s_cbranch_scc1 opl_7
    s_add_u32 s64, s65, 20480
    v_mov_b32 v7, v3
    s_mov_b32 m0, s64
    s_add_u32 s64, s64, 1024
    global_load_lds_dwordx4 v7, s[62:63] sc1
    v_add_u32 v7, 65536, v7
    s_mov_b32 m0, s64
    s_add_u32 s64, s64, 1024
    global_load_lds_dwordx4 v7, s[62:63] sc1
    v_add_u32 v7, 65536, v7
    s_mov_b32 m0, s64
    s_add_u32 s64, s64, 1024
    global_load_lds_dwordx4 v7, s[62:63] sc1
    v_add_u32 v7, 65536, v7
    s_mov_b32 m0, s64
    s_add_u32 s64, s64, 1024
    global_load_lds_dwordx4 v7, s[62:63] sc1
    v_add_u32 v7, 65536, v7
    s_mov_b32 m0, s64
    s_add_u32 s64, s64, 1024
    global_load_lds_dwordx4 v7, s[62:63] sc1
    v_add_u32 v7, 65536, v7
    s_mov_b32 m0, s64
    s_add_u32 s64, s64, 1024
    global_load_lds_dwordx4 v7, s[62:63] sc1
    v_add_u32 v7, 65536, v7
    s_mov_b32 m0, s64
    s_add_u32 s64, s64, 1024
    global_load_lds_dwordx4 v7, s[62:63] sc1
    v_add_u32 v7, 65536, v7
    s_mov_b32 m0, s64
    s_add_u32 s64, s64, 1024
    global_load_lds_dwordx4 v7, s[62:63] sc1
    v_add_u32 v7, 65536, v7
    s_mov_b32 m0, s64
    s_add_u32 s64, s64, 1024
    global_load_lds_dwordx4 v4, s[40:41]
    v_add_u32 v4, 18432, v4
    s_mov_b32 m0, s64
    s_add_u32 s64, s64, 1024
    global_load_lds_dwordx4 v5, s[40:41]
    v_add_u32 v5, 18432, v5
    s_mov_b32 m0, s64
    s_add_u32 s64, s64, 1024
    global_load_lds_dwordx4 v6, s[40:41]
    v_add_u32 v6, 18432, v6
    s_mov_b32 m0, s64
    s_add_u32 s64, s64, 1024
    global_load_lds_dwordx4 v4, s[40:41]
    v_add_u32 v4, 18432, v4
    s_mov_b32 m0, s64
    s_add_u32 s64, s64, 1024
    global_load_lds_dwordx4 v5, s[40:41]
    v_add_u32 v5, 18432, v5
    s_mov_b32 m0, s64
    s_add_u32 s64, s64, 1024
    global_load_lds_dwordx4 v6, s[40:41]
    v_add_u32 v6, 18432, v6
    s_mov_b32 m0, s64
    s_add_u32 s64, s64, 1024
    global_load_lds_dwordx4 v4, s[40:41]
    v_add_u32 v4, 18432, v4
    s_mov_b32 m0, s64
    s_add_u32 s64, s64, 1024
    global_load_lds_dwordx4 v5, s[40:41]
    v_add_u32 v5, 18432, v5
    s_mov_b32 m0, s64
    s_add_u32 s64, s64, 1024
    global_load_lds_dwordx4 v6, s[40:41]
    v_add_u32 v6, 18432, v6
    s_mov_b32 m0, s64
    s_add_u32 s64, s64, 1024
    global_load_lds_dwordx4 v4, s[40:41]
    v_add_u32 v4, 18432, v4
    s_mov_b32 m0, s64
    s_add_u32 s64, s64, 1024
    global_load_lds_dwordx4 v5, s[40:41]
    v_add_u32 v5, 18432, v5
    s_mov_b32 m0, s64
    s_add_u32 s64, s64, 1024
    global_load_lds_dwordx4 v6, s[40:41]
    v_add_u32 v6, 18432, v6
    v_add_u32 v3, 128, v3
    s_waitcnt vmcnt(20)
    ds_read_b128 v[16:19], v8 offset:0
    ds_read_b128 v[20:23], v8 offset:4096
    ds_read_b64_tr_b16 v[24:25], v15 offset:0
    ds_read_b64_tr_b16 v[26:27], v15 offset:768
    ds_read_b64_tr_b16 v[28:29], v15 offset:64
    ds_read_b64_tr_b16 v[30:31], v15 offset:832
    ds_read_b64_tr_b16 v[32:33], v15 offset:128
    ds_read_b64_tr_b16 v[34:35], v15 offset:896
    ds_read_b128 v[40:43], v9 offset:0
    ds_read_b128 v[44:47], v9 offset:4096
    ds_read_b64_tr_b16 v[48:49], v15 offset:3072
    ds_read_b64_tr_b16 v[50:51], v15 offset:3840
    ds_read_b64_tr_b16 v[52:53], v15 offset:3136
    ds_read_b64_tr_b16 v[54:55], v15 offset:3904
    ds_read_b64_tr_b16 v[56:57], v15 offset:3200
    ds_read_b64_tr_b16 v[58:59], v15 offset:3968
    s_waitcnt lgkmcnt(8)
    v_mfma_f32_32x32x16_bf16 v[64:79], v[24:27], v[16:19], v[64:79]
    v_mfma_f32_32x32x16_bf16 v[80:95], v[24:27], v[20:23], v[80:95]
    v_mfma_f32_32x32x16_bf16 v[96:111], v[28:31], v[16:19], v[96:111]
    v_mfma_f32_32x32x16_bf16 v[112:127], v[28:31], v[20:23], v[112:127]
    v_mfma_f32_32x32x16_bf16 v[128:143], v[32:35], v[16:19], v[128:143]
    v_mfma_f32_32x32x16_bf16 v[144:159], v[32:35], v[20:23], v[144:159]
    ds_read_b128 v[16:19], v10 offset:0
    ds_read_b128 v[20:23], v10 offset:4096
    ds_read_b64_tr_b16 v[24:25], v15 offset:6144
    ds_read_b64_tr_b16 v[26:27], v15 offset:6912
    ds_read_b64_tr_b16 v[28:29], v15 offset:6208
    ds_read_b64_tr_b16 v[30:31], v15 offset:6976
    ds_read_b64_tr_b16 v[32:33], v15 offset:6272
    ds_read_b64_tr_b16 v[34:35], v15 offset:7040
    s_waitcnt lgkmcnt(8)
    v_mfma_f32_32x32x16_bf16 v[64:79], v[48:51], v[40:43], v[64:79]
    v_mfma_f32_32x32x16_bf16 v[80:95], v[48:51], v[44:47], v[80:95]
    v_mfma_f32_32x32x16_bf16 v[96:111], v[52:55], v[40:43], v[96:111]
    v_mfma_f32_32x32x16_bf16 v[112:127], v[52:55], v[44:47], v[112:127]
    v_mfma_f32_32x32x16_bf16 v[128:143], v[56:59], v[40:43], v[128:143]
    v_mfma_f32_32x32x16_bf16 v[144:159], v[56:59], v[44:47], v[144:159]
    ds_read_b128 v[40:43], v11 offset:0
    ds_read_b128 v[44:47], v11 offset:4096
    ds_read_b64_tr_b16 v[48:49], v15 offset:9216
    ds_read_b64_tr_b16 v[50:51], v15 offset:9984
    ds_read_b64_tr_b16 v[52:53], v15 offset:9280
    ds_read_b64_tr_b16 v[54:55], v15 offset:10048
    ds_read_b64_tr_b16 v[56:57], v15 offset:9344
    ds_read_b64_tr_b16 v[58:59], v15 offset:10112
    s_waitcnt lgkmcnt(8)
    v_mfma_f32_32x32x16_bf16 v[64:79], v[24:27], v[16:19], v[64:79]
    v_mfma_f32_32x32x16_bf16 v[80:95], v[24:27], v[20:23], v[80:95]
    v_mfma_f32_32x32x16_bf16 v[96:111], v[28:31], v[16:19], v[96:111]
    v_mfma_f32_32x32x16_bf16 v[112:127], v[28:31], v[20:23], v[112:127]
    v_mfma_f32_32x32x16_bf16 v[128:143], v[32:35], v[16:19], v[128:143]
    v_mfma_f32_32x32x16_bf16 v[144:159], v[32:35], v[20:23], v[144:159]
    s_waitcnt lgkmcnt(0)
    v_mfma_f32_32x32x16_bf16 v[64:79], v[48:51], v[40:43], v[64:79]
    v_mfma_f32_32x32x16_bf16 v[80:95], v[48:51], v[44:47], v[80:95]
    v_mfma_f32_32x32x16_bf16 v[96:111], v[52:55], v[40:43], v[96:111]
    v_mfma_f32_32x32x16_bf16 v[112:127], v[52:55], v[44:47], v[112:127]
    v_mfma_f32_32x32x16_bf16 v[128:143], v[56:59], v[40:43], v[128:143]
    v_mfma_f32_32x32x16_bf16 v[144:159], v[56:59], v[44:47], v[144:159]
    s_waitcnt vmcnt(0)
    ds_read_b128 v[16:19], v8 offset:20480
    ds_read_b128 v[20:23], v8 offset:24576
    ds_read_b64_tr_b16 v[24:25], v15 offset:20480
    ds_read_b64_tr_b16 v[26:27], v15 offset:21248
    ds_read_b64_tr_b16 v[28:29], v15 offset:20544
    ds_read_b64_tr_b16 v[30:31], v15 offset:21312
    ds_read_b64_tr_b16 v[32:33], v15 offset:20608
    ds_read_b64_tr_b16 v[34:35], v15 offset:21376
    ds_read_b128 v[40:43], v9 offset:20480
    ds_read_b128 v[44:47], v9 offset:24576
    ds_read_b64_tr_b16 v[48:49], v15 offset:23552
    ds_read_b64_tr_b16 v[50:51], v15 offset:24320
    ds_read_b64_tr_b16 v[52:53], v15 offset:23616
    ds_read_b64_tr_b16 v[54:55], v15 offset:24384
    ds_read_b64_tr_b16 v[56:57], v15 offset:23680
    ds_read_b64_tr_b16 v[58:59], v15 offset:24448
    s_waitcnt lgkmcnt(8)
    v_mfma_f32_32x32x16_bf16 v[64:79], v[24:27], v[16:19], v[64:79]
    v_mfma_f32_32x32x16_bf16 v[80:95], v[24:27], v[20:23], v[80:95]
    v_mfma_f32_32x32x16_bf16 v[96:111], v[28:31], v[16:19], v[96:111]
    v_mfma_f32_32x32x16_bf16 v[112:127], v[28:31], v[20:23], v[112:127]
    v_mfma_f32_32x32x16_bf16 v[128:143], v[32:35], v[16:19], v[128:143]
    v_mfma_f32_32x32x16_bf16 v[144:159], v[32:35], v[20:23], v[144:159]
    ds_read_b128 v[16:19], v10 offset:20480
    ds_read_b128 v[20:23], v10 offset:24576
    ds_read_b64_tr_b16 v[24:25], v15 offset:26624
    ds_read_b64_tr_b16 v[26:27], v15 offset:27392
    ds_read_b64_tr_b16 v[28:29], v15 offset:26688
    ds_read_b64_tr_b16 v[30:31], v15 offset:27456
    ds_read_b64_tr_b16 v[32:33], v15 offset:26752
    ds_read_b64_tr_b16 v[34:35], v15 offset:27520
    s_waitcnt lgkmcnt(8)
    v_mfma_f32_32x32x16_bf16 v[64:79], v[48:51], v[40:43], v[64:79]
    v_mfma_f32_32x32x16_bf16 v[80:95], v[48:51], v[44:47], v[80:95]
    v_mfma_f32_32x32x16_bf16 v[96:111], v[52:55], v[40:43], v[96:111]
    v_mfma_f32_32x32x16_bf16 v[112:127], v[52:55], v[44:47], v[112:127]
    v_mfma_f32_32x32x16_bf16 v[128:143], v[56:59], v[40:43], v[128:143]
    v_mfma_f32_32x32x16_bf16 v[144:159], v[56:59], v[44:47], v[144:159]
    ds_read_b128 v[40:43], v11 offset:20480
    ds_read_b128 v[44:47], v11 offset:24576
    ds_read_b64_tr_b16 v[48:49], v15 offset:29696
    ds_read_b64_tr_b16 v[50:51], v15 offset:30464
    ds_read_b64_tr_b16 v[52:53], v15 offset:29760
    ds_read_b64_tr_b16 v[54:55], v15 offset:30528
    ds_read_b64_tr_b16 v[56:57], v15 offset:29824
    ds_read_b64_tr_b16 v[58:59], v15 offset:30592
    s_waitcnt lgkmcnt(8)
    v_mfma_f32_32x32x16_bf16 v[64:79], v[24:27], v[16:19], v[64:79]
    v_mfma_f32_32x32x16_bf16 v[80:95], v[24:27], v[20:23], v[80:95]
    v_mfma_f32_32x32x16_bf16 v[96:111], v[28:31], v[16:19], v[96:111]
    v_mfma_f32_32x32x16_bf16 v[112:127], v[28:31], v[20:23], v[112:127]
    v_mfma_f32_32x32x16_bf16 v[128:143], v[32:35], v[16:19], v[128:143]
    v_mfma_f32_32x32x16_bf16 v[144:159], v[32:35], v[20:23], v[144:159]
    s_waitcnt lgkmcnt(0)
    v_mfma_f32_32x32x16_bf16 v[64:79], v[48:51], v[40:43], v[64:79]
    v_mfma_f32_32x32x16_bf16 v[80:95], v[48:51], v[44:47], v[80:95]
    v_mfma_f32_32x32x16_bf16 v[96:111], v[52:55], v[40:43], v[96:111]
    v_mfma_f32_32x32x16_bf16 v[112:127], v[52:55], v[44:47], v[112:127]
    v_mfma_f32_32x32x16_bf16 v[128:143], v[56:59], v[40:43], v[128:143]
    v_mfma_f32_32x32x16_bf16 v[144:159], v[56:59], v[44:47], v[144:159]
    s_nop 7
    s_nop 7
    s_barrier
    v_lshlrev_b32 v7, 4, v2
    s_mul_i32 s57, s56, 24576
    v_add_u32 v13, s57, v7
    ds_write_b128 v13, v[64:67] offset:0
    ds_write_b128 v13, v[68:71] offset:1024
    ds_write_b128 v13, v[72:75] offset:2048
    ds_write_b128 v13, v[76:79] offset:3072
    ds_write_b128 v13, v[80:83] offset:4096
    ds_write_b128 v13, v[84:87] offset:5120
    ds_write_b128 v13, v[88:91] offset:6144
    ds_write_b128 v13, v[92:95] offset:7168
    ds_write_b128 v13, v[96:99] offset:8192
    ds_write_b128 v13, v[100:103] offset:9216
    ds_write_b128 v13, v[104:107] offset:10240
    ds_write_b128 v13, v[108:111] offset:11264
    ds_write_b128 v13, v[112:115] offset:12288
    ds_write_b128 v13, v[116:119] offset:13312
    ds_write_b128 v13, v[120:123] offset:14336
    ds_write_b128 v13, v[124:127] offset:15360
    ds_write_b128 v13, v[128:131] offset:16384
    ds_write_b128 v13, v[132:135] offset:17408
    ds_write_b128 v13, v[136:139] offset:18432
    ds_write_b128 v13, v[140:143] offset:19456
    ds_write_b128 v13, v[144:147] offset:20480
    ds_write_b128 v13, v[148:151] offset:21504
    ds_write_b128 v13, v[152:155] offset:22528
    ds_write_b128 v13, v[156:159] offset:23552
    s_mul_i32 s57, s56, 6144
    v_add_u32 v13, s57, v7
    v_add_u32 v7, 49152, v13
    s_waitcnt lgkmcnt(0)
    s_barrier
    ds_read_b128 v[64:67], v13 offset:0
    ds_read_b128 v[68:71], v13 offset:1024
    ds_read_b128 v[72:75], v13 offset:2048
    ds_read_b128 v[76:79], v13 offset:3072
    ds_read_b128 v[80:83], v13 offset:4096
    ds_read_b128 v[84:87], v13 offset:5120
    ds_read_b128 v[88:91], v13 offset:24576
    ds_read_b128 v[92:95], v13 offset:25600
    ds_read_b128 v[96:99], v13 offset:26624
    ds_read_b128 v[100:103], v13 offset:27648
    ds_read_b128 v[104:107], v13 offset:28672
    ds_read_b128 v[108:111], v13 offset:29696
    ds_read_b128 v[112:115], v7 offset:0
    ds_read_b128 v[116:119], v7 offset:1024
    ds_read_b128 v[120:123], v7 offset:2048
    ds_read_b128 v[124:127], v7 offset:3072
    ds_read_b128 v[128:131], v7 offset:4096
    ds_read_b128 v[132:135], v7 offset:5120
    ds_read_b128 v[136:139], v7 offset:24576
    ds_read_b128 v[140:143], v7 offset:25600
    ds_read_b128 v[144:147], v7 offset:26624
    ds_read_b128 v[148:151], v7 offset:27648
    ds_read_b128 v[152:155], v7 offset:28672
    ds_read_b128 v[156:159], v7 offset:29696
    s_mul_i32 s57, s56, 3
    s_add_u32 s57, s57, 0
    s_lshr_b32 s58, s57, 1
    s_and_b32 s59, s58, 1
    s_lshr_b32 s58, s58, 1
    s_and_b32 s57, s57, 1
    s_lshl_b32 s58, s58, 6
    s_lshl_b32 s57, s57, 5
    s_add_u32 s57, s57, s58
    s_mul_i32 s58, s16, 192
    s_add_u32 s57, s57, s58
    s_lshl_b32 s59, s59, 5
    s_lshl_b32 s58, s15, 6
    s_add_u32 s59, s59, s58
    v_add_u32 v16, s59, v14
    v_lshlrev_b32 v17, 2, v16
    v_mul_u32_u24 v16, 1152, v16
    v_lshl_add_u32 v16, v12, 4, v16
    v_add_u32 v20, s57, v16
    s_mov_b32 s57, 83886080
    s_mov_b32 s58, 88080384
    buffer_load_dwordx4 v[28:31], v20, s[48:51], s57 offen sc1
    buffer_load_dword v24, v17, s[48:51], s58 offen sc1
    s_mul_i32 s57, s56, 3
    s_add_u32 s57, s57, 1
    s_lshr_b32 s58, s57, 1
    s_and_b32 s59, s58, 1
    s_lshr_b32 s58, s58, 1
    s_and_b32 s57, s57, 1
    s_lshl_b32 s58, s58, 6
    s_lshl_b32 s57, s57, 5
    s_add_u32 s57, s57, s58
    s_mul_i32 s58, s16, 192
    s_add_u32 s57, s57, s58
    s_lshl_b32 s59, s59, 5
    s_lshl_b32 s58, s15, 6
    s_add_u32 s59, s59, s58
    v_add_u32 v16, s59, v14
    v_lshlrev_b32 v17, 2, v16
    v_mul_u32_u24 v16, 1152, v16
    v_lshl_add_u32 v16, v12, 4, v16
    v_add_u32 v21, s57, v16
    s_mov_b32 s57, 83886080
    s_mov_b32 s58, 88080384
    buffer_load_dwordx4 v[32:35], v21, s[48:51], s57 offen sc1
    buffer_load_dword v25, v17, s[48:51], s58 offen sc1
    s_mul_i32 s57, s56, 3
    s_add_u32 s57, s57, 2
    s_lshr_b32 s58, s57, 1
    s_and_b32 s59, s58, 1
    s_lshr_b32 s58, s58, 1
    s_and_b32 s57, s57, 1
    s_lshl_b32 s58, s58, 6
    s_lshl_b32 s57, s57, 5
    s_add_u32 s57, s57, s58
    s_mul_i32 s58, s16, 192
    s_add_u32 s57, s57, s58
    s_lshl_b32 s59, s59, 5
    s_lshl_b32 s58, s15, 6
    s_add_u32 s59, s59, s58
    v_add_u32 v16, s59, v14
    v_lshlrev_b32 v17, 2, v16
    v_mul_u32_u24 v16, 1152, v16
    v_lshl_add_u32 v16, v12, 4, v16
    v_add_u32 v22, s57, v16
    s_mov_b32 s57, 83886080
    s_mov_b32 s58, 88080384
    buffer_load_dwordx4 v[36:39], v22, s[48:51], s57 offen sc1
    buffer_load_dword v26, v17, s[48:51], s58 offen sc1
    s_waitcnt lgkmcnt(0)
    v_add_f32 v64, v64, v88
    v_add_f32 v112, v112, v136
    v_add_f32 v65, v65, v89
    v_add_f32 v113, v113, v137
    v_add_f32 v66, v66, v90
    v_add_f32 v114, v114, v138
    v_add_f32 v67, v67, v91
    v_add_f32 v115, v115, v139
    v_add_f32 v68, v68, v92
    v_add_f32 v116, v116, v140
    v_add_f32 v69, v69, v93
    v_add_f32 v117, v117, v141
    v_add_f32 v70, v70, v94
    v_add_f32 v118, v118, v142
    v_add_f32 v71, v71, v95
    v_add_f32 v119, v119, v143
    v_add_f32 v64, v64, v112
    v_add_f32 v65, v65, v113
    v_add_f32 v66, v66, v114
    v_add_f32 v67, v67, v115
    v_add_f32 v68, v68, v116
    v_add_f32 v69, v69, v117
    v_add_f32 v70, v70, v118
    v_add_f32 v71, v71, v119
    v_add_f32 v72, v72, v96
    v_add_f32 v120, v120, v144
    v_add_f32 v73, v73, v97
    v_add_f32 v121, v121, v145
    v_add_f32 v74, v74, v98
    v_add_f32 v122, v122, v146
    v_add_f32 v75, v75, v99
    v_add_f32 v123, v123, v147
    v_add_f32 v76, v76, v100
    v_add_f32 v124, v124, v148
    v_add_f32 v77, v77, v101
    v_add_f32 v125, v125, v149
    v_add_f32 v78, v78, v102
    v_add_f32 v126, v126, v150
    v_add_f32 v79, v79, v103
    v_add_f32 v127, v127, v151
    v_add_f32 v72, v72, v120
    v_add_f32 v73, v73, v121
    v_add_f32 v74, v74, v122
    v_add_f32 v75, v75, v123
    v_add_f32 v76, v76, v124
    v_add_f32 v77, v77, v125
    v_add_f32 v78, v78, v126
    v_add_f32 v79, v79, v127
    v_add_f32 v80, v80, v104
    v_add_f32 v128, v128, v152
    v_add_f32 v81, v81, v105
    v_add_f32 v129, v129, v153
    v_add_f32 v82, v82, v106
    v_add_f32 v130, v130, v154
    v_add_f32 v83, v83, v107
    v_add_f32 v131, v131, v155
    v_add_f32 v84, v84, v108
    v_add_f32 v132, v132, v156
    v_add_f32 v85, v85, v109
    v_add_f32 v133, v133, v157
    v_add_f32 v86, v86, v110
    v_add_f32 v134, v134, v158
    v_add_f32 v87, v87, v111
    v_add_f32 v135, v135, v159
    v_add_f32 v80, v80, v128
    v_add_f32 v81, v81, v129
    v_add_f32 v82, v82, v130
    v_add_f32 v83, v83, v131
    v_add_f32 v84, v84, v132
    v_add_f32 v85, v85, v133
    v_add_f32 v86, v86, v134
    v_add_f32 v87, v87, v135
    s_waitcnt vmcnt(0)
    v_sub_f32 v27, 1.0, v24
    v_cvt_pk_bf16_f32 v27, v27, v27
    v_lshlrev_b32 v27, 16, v27
    v_cvt_pk_bf16_f32 v40, v64, v65
    v_lshlrev_b32 v41, 16, v40
    v_and_b32 v42, 0xffff0000, v40
    v_mul_f32 v41, v41, v27
    v_mul_f32 v42, v42, v27
    v_cvt_pk_bf16_f32 v40, v41, v42
    v_lshlrev_b32 v43, 16, v28
    v_and_b32 v44, 0xffff0000, v28
    v_mul_f32 v43, v43, v24
    v_mul_f32 v44, v44, v24
    v_cvt_pk_bf16_f32 v45, v43, v44
    v_lshlrev_b32 v41, 16, v40
    v_and_b32 v42, 0xffff0000, v40
    v_lshlrev_b32 v43, 16, v45
    v_and_b32 v44, 0xffff0000, v45
    v_add_f32 v41, v41, v43
    v_add_f32 v42, v42, v44
    v_cvt_pk_bf16_f32 v48, v41, v42
    v_cvt_pk_bf16_f32 v40, v66, v67
    v_lshlrev_b32 v41, 16, v40
    v_and_b32 v42, 0xffff0000, v40
    v_mul_f32 v41, v41, v27
    v_mul_f32 v42, v42, v27
    v_cvt_pk_bf16_f32 v40, v41, v42
    v_lshlrev_b32 v43, 16, v29
    v_and_b32 v44, 0xffff0000, v29
    v_mul_f32 v43, v43, v24
    v_mul_f32 v44, v44, v24
    v_cvt_pk_bf16_f32 v45, v43, v44
    v_lshlrev_b32 v41, 16, v40
    v_and_b32 v42, 0xffff0000, v40
    v_lshlrev_b32 v43, 16, v45
    v_and_b32 v44, 0xffff0000, v45
    v_add_f32 v41, v41, v43
    v_add_f32 v42, v42, v44
    v_cvt_pk_bf16_f32 v49, v41, v42
    v_cvt_pk_bf16_f32 v40, v68, v69
    v_lshlrev_b32 v41, 16, v40
    v_and_b32 v42, 0xffff0000, v40
    v_mul_f32 v41, v41, v27
    v_mul_f32 v42, v42, v27
    v_cvt_pk_bf16_f32 v40, v41, v42
    v_lshlrev_b32 v43, 16, v30
    v_and_b32 v44, 0xffff0000, v30
    v_mul_f32 v43, v43, v24
    v_mul_f32 v44, v44, v24
    v_cvt_pk_bf16_f32 v45, v43, v44
    v_lshlrev_b32 v41, 16, v40
    v_and_b32 v42, 0xffff0000, v40
    v_lshlrev_b32 v43, 16, v45
    v_and_b32 v44, 0xffff0000, v45
    v_add_f32 v41, v41, v43
    v_add_f32 v42, v42, v44
    v_cvt_pk_bf16_f32 v50, v41, v42
    v_cvt_pk_bf16_f32 v40, v70, v71
    v_lshlrev_b32 v41, 16, v40
    v_and_b32 v42, 0xffff0000, v40
    v_mul_f32 v41, v41, v27
    v_mul_f32 v42, v42, v27
    v_cvt_pk_bf16_f32 v40, v41, v42
    v_lshlrev_b32 v43, 16, v31
    v_and_b32 v44, 0xffff0000, v31
    v_mul_f32 v43, v43, v24
    v_mul_f32 v44, v44, v24
    v_cvt_pk_bf16_f32 v45, v43, v44
    v_lshlrev_b32 v41, 16, v40
    v_and_b32 v42, 0xffff0000, v40
    v_lshlrev_b32 v43, 16, v45
    v_and_b32 v44, 0xffff0000, v45
    v_add_f32 v41, v41, v43
    v_add_f32 v42, v42, v44
    v_cvt_pk_bf16_f32 v51, v41, v42
    buffer_store_dwordx4 v[48:51], v20, s[52:55], 0 offen
    v_sub_f32 v27, 1.0, v25
    v_cvt_pk_bf16_f32 v27, v27, v27
    v_lshlrev_b32 v27, 16, v27
    v_cvt_pk_bf16_f32 v40, v72, v73
    v_lshlrev_b32 v41, 16, v40
    v_and_b32 v42, 0xffff0000, v40
    v_mul_f32 v41, v41, v27
    v_mul_f32 v42, v42, v27
    v_cvt_pk_bf16_f32 v40, v41, v42
    v_lshlrev_b32 v43, 16, v32
    v_and_b32 v44, 0xffff0000, v32
    v_mul_f32 v43, v43, v25
    v_mul_f32 v44, v44, v25
    v_cvt_pk_bf16_f32 v45, v43, v44
    v_lshlrev_b32 v41, 16, v40
    v_and_b32 v42, 0xffff0000, v40
    v_lshlrev_b32 v43, 16, v45
    v_and_b32 v44, 0xffff0000, v45
    v_add_f32 v41, v41, v43
    v_add_f32 v42, v42, v44
    v_cvt_pk_bf16_f32 v52, v41, v42
    v_cvt_pk_bf16_f32 v40, v74, v75
    v_lshlrev_b32 v41, 16, v40
    v_and_b32 v42, 0xffff0000, v40
    v_mul_f32 v41, v41, v27
    v_mul_f32 v42, v42, v27
    v_cvt_pk_bf16_f32 v40, v41, v42
    v_lshlrev_b32 v43, 16, v33
    v_and_b32 v44, 0xffff0000, v33
    v_mul_f32 v43, v43, v25
    v_mul_f32 v44, v44, v25
    v_cvt_pk_bf16_f32 v45, v43, v44
    v_lshlrev_b32 v41, 16, v40
    v_and_b32 v42, 0xffff0000, v40
    v_lshlrev_b32 v43, 16, v45
    v_and_b32 v44, 0xffff0000, v45
    v_add_f32 v41, v41, v43
    v_add_f32 v42, v42, v44
    v_cvt_pk_bf16_f32 v53, v41, v42
    v_cvt_pk_bf16_f32 v40, v76, v77
    v_lshlrev_b32 v41, 16, v40
    v_and_b32 v42, 0xffff0000, v40
    v_mul_f32 v41, v41, v27
    v_mul_f32 v42, v42, v27
    v_cvt_pk_bf16_f32 v40, v41, v42
    v_lshlrev_b32 v43, 16, v34
    v_and_b32 v44, 0xffff0000, v34
    v_mul_f32 v43, v43, v25
    v_mul_f32 v44, v44, v25
    v_cvt_pk_bf16_f32 v45, v43, v44
    v_lshlrev_b32 v41, 16, v40
    v_and_b32 v42, 0xffff0000, v40
    v_lshlrev_b32 v43, 16, v45
    v_and_b32 v44, 0xffff0000, v45
    v_add_f32 v41, v41, v43
    v_add_f32 v42, v42, v44
    v_cvt_pk_bf16_f32 v54, v41, v42
    v_cvt_pk_bf16_f32 v40, v78, v79
    v_lshlrev_b32 v41, 16, v40
    v_and_b32 v42, 0xffff0000, v40
    v_mul_f32 v41, v41, v27
    v_mul_f32 v42, v42, v27
    v_cvt_pk_bf16_f32 v40, v41, v42
    v_lshlrev_b32 v43, 16, v35
    v_and_b32 v44, 0xffff0000, v35
    v_mul_f32 v43, v43, v25
    v_mul_f32 v44, v44, v25
    v_cvt_pk_bf16_f32 v45, v43, v44
    v_lshlrev_b32 v41, 16, v40
    v_and_b32 v42, 0xffff0000, v40
    v_lshlrev_b32 v43, 16, v45
    v_and_b32 v44, 0xffff0000, v45
    v_add_f32 v41, v41, v43
    v_add_f32 v42, v42, v44
    v_cvt_pk_bf16_f32 v55, v41, v42
    buffer_store_dwordx4 v[52:55], v21, s[52:55], 0 offen
    v_sub_f32 v27, 1.0, v26
    v_cvt_pk_bf16_f32 v27, v27, v27
    v_lshlrev_b32 v27, 16, v27
    v_cvt_pk_bf16_f32 v40, v80, v81
    v_lshlrev_b32 v41, 16, v40
    v_and_b32 v42, 0xffff0000, v40
    v_mul_f32 v41, v41, v27
    v_mul_f32 v42, v42, v27
    v_cvt_pk_bf16_f32 v40, v41, v42
    v_lshlrev_b32 v43, 16, v36
    v_and_b32 v44, 0xffff0000, v36
    v_mul_f32 v43, v43, v26
    v_mul_f32 v44, v44, v26
    v_cvt_pk_bf16_f32 v45, v43, v44
    v_lshlrev_b32 v41, 16, v40
    v_and_b32 v42, 0xffff0000, v40
    v_lshlrev_b32 v43, 16, v45
    v_and_b32 v44, 0xffff0000, v45
    v_add_f32 v41, v41, v43
    v_add_f32 v42, v42, v44
    v_cvt_pk_bf16_f32 v56, v41, v42
    v_cvt_pk_bf16_f32 v40, v82, v83
    v_lshlrev_b32 v41, 16, v40
    v_and_b32 v42, 0xffff0000, v40
    v_mul_f32 v41, v41, v27
    v_mul_f32 v42, v42, v27
    v_cvt_pk_bf16_f32 v40, v41, v42
    v_lshlrev_b32 v43, 16, v37
    v_and_b32 v44, 0xffff0000, v37
    v_mul_f32 v43, v43, v26
    v_mul_f32 v44, v44, v26
    v_cvt_pk_bf16_f32 v45, v43, v44
    v_lshlrev_b32 v41, 16, v40
    v_and_b32 v42, 0xffff0000, v40
    v_lshlrev_b32 v43, 16, v45
    v_and_b32 v44, 0xffff0000, v45
    v_add_f32 v41, v41, v43
    v_add_f32 v42, v42, v44
    v_cvt_pk_bf16_f32 v57, v41, v42
    v_cvt_pk_bf16_f32 v40, v84, v85
    v_lshlrev_b32 v41, 16, v40
    v_and_b32 v42, 0xffff0000, v40
    v_mul_f32 v41, v41, v27
    v_mul_f32 v42, v42, v27
    v_cvt_pk_bf16_f32 v40, v41, v42
    v_lshlrev_b32 v43, 16, v38
    v_and_b32 v44, 0xffff0000, v38
    v_mul_f32 v43, v43, v26
    v_mul_f32 v44, v44, v26
    v_cvt_pk_bf16_f32 v45, v43, v44
    v_lshlrev_b32 v41, 16, v40
    v_and_b32 v42, 0xffff0000, v40
    v_lshlrev_b32 v43, 16, v45
    v_and_b32 v44, 0xffff0000, v45
    v_add_f32 v41, v41, v43
    v_add_f32 v42, v42, v44
    v_cvt_pk_bf16_f32 v58, v41, v42
    v_cvt_pk_bf16_f32 v40, v86, v87
    v_lshlrev_b32 v41, 16, v40
    v_and_b32 v42, 0xffff0000, v40
    v_mul_f32 v41, v41, v27
    v_mul_f32 v42, v42, v27
    v_cvt_pk_bf16_f32 v40, v41, v42
    v_lshlrev_b32 v43, 16, v39
    v_and_b32 v44, 0xffff0000, v39
    v_mul_f32 v43, v43, v26
    v_mul_f32 v44, v44, v26
    v_cvt_pk_bf16_f32 v45, v43, v44
    v_lshlrev_b32 v41, 16, v40
    v_and_b32 v42, 0xffff0000, v40
    v_lshlrev_b32 v43, 16, v45
    v_and_b32 v44, 0xffff0000, v45
    v_add_f32 v41, v41, v43
    v_add_f32 v42, v42, v44
    v_cvt_pk_bf16_f32 v59, v41, v42
    buffer_store_dwordx4 v[56:59], v22, s[52:55], 0 offen
    s_branch L_fetch
L_sp:
    s_sub_u32 s9, s8, 968
    s_mul_i32 s15, s9, 1366
    s_lshr_b32 s15, s15, 16
    s_mul_i32 s12, s15, 48
    s_sub_u32 s9, s9, s12
    s_lshr_b32 s16, s9, 3
    s_and_b32 s17, s9, 7
    s_mul_i32 s18, s15, 6
    s_add_u32 s18, s18, s16
    s_add_u32 s15, s15, 27
    v_readfirstlane_b32 s14, v0
    s_nop 0
    s_cmp_lg_u32 s14, 0
    s_cbranch_scc1 wd_8_ok
    v_mov_b32 v1, 0
    s_mov_b64 exec, 1
wd_8:
    global_load_dword v2, v1, s[4:5] offset:12 sc1
    s_waitcnt vmcnt(0)
    v_readfirstlane_b32 s14, v2
    s_nop 0
    s_cmp_ge_u32 s14, 352
    s_cbranch_scc1 wd_8_ok
    s_sleep 12
    s_branch wd_8
wd_8_ok:
    s_mov_b64 exec, -1
    s_barrier
    s_lshr_b32 s28, s15, 1
    v_readfirstlane_b32 s14, v0
    s_nop 0
    s_cmp_lg_u32 s14, 0
    s_cbranch_scc1 wb_9_ok
    s_and_b32 s12, s28, 3
    s_lshl_b32 s12, s12, 3
    s_and_b32 s13, s28, 0xfc
    v_mov_b32 v1, s13
    s_mov_b64 exec, 1
wb_9:
    global_load_dword v2, v1, s[4:5] offset:32 sc1
    s_waitcnt vmcnt(0)
    v_readfirstlane_b32 s14, v2
    s_nop 0
    s_lshr_b32 s14, s14, s12
    s_and_b32 s14, s14, 0xff
    s_cmp_ge_u32 s14, 32
    s_cbranch_scc1 wb_9_ok
    s_sleep 12
    s_branch wb_9
wb_9_ok:
    s_mov_b64 exec, -1
    s_barrier
    s_load_dwordx2 s[60:61], s[0:1], 112
    s_load_dwordx2 s[62:63], s[0:1], 152
    s_load_dwordx2 s[64:65], s[0:1], 136
    v_lshrrev_b32 v1, 6, v0
    v_and_b32 v2, 63, v0
    v_readfirstlane_b32 s76, v1
    s_waitcnt lgkmcnt(0)
    s_mov_b32 s68, s62
    s_mov_b32 s69, s63
    s_mov_b32 s70, 268435456
    s_mov_b32 s71, 0x00020000
    s_mov_b32 s72, s64
    s_mov_b32 s73, s65
    s_mov_b32 s74, 2359296
    s_mov_b32 s75, 0x00020000
    s_add_u32 s82, s62, 67108864
    s_addc_u32 s83, s63, 0
    s_mul_i32 s85, s76, 40960
    v_lshrrev_b32 v7, 3, v2
    v_and_b32 v8, 7, v2
    v_xor_b32 v8, v8, v7
    s_lshl_b32 s77, s15, 6
    v_add_u32 v7, s77, v7
    v_lshlrev_b32 v7, 13, v7
    v_lshl_add_u32 v7, v8, 4, v7
    s_mul_i32 s79, s76, 128
    s_mul_i32 s77, s17, 512
    s_add_u32 s79, s79, s77
    s_lshl_b32 s77, s79, 1
    v_add_u32 v3, s77, v7
    s_mul_i32 s77, s79, 1152
    s_mul_i32 s78, s16, 192
    s_add_u32 s77, s77, s78
    s_mov_b32 s78, 0xaaab
    v_add_u32 v7, 0, v2
    v_mul_u32_u24 v8, s78, v7
    v_lshrrev_b32 v8, 19, v8
    v_mul_u32_u24 v9, 12, v8
    v_sub_u32 v9, v7, v9
    v_mul_u32_u24 v8, 1152, v8
    v_lshl_add_u32 v8, v9, 4, v8
    v_add_u32 v4, s77, v8
    v_add_u32 v7, 64, v2
    v_mul_u32_u24 v8, s78, v7
    v_lshrrev_b32 v8, 19, v8
    v_mul_u32_u24 v9, 12, v8
    v_sub_u32 v9, v7, v9
    v_mul_u32_u24 v8, 1152, v8
    v_lshl_add_u32 v8, v9, 4, v8
    v_add_u32 v5, s77, v8
    v_add_u32 v7, 128, v2
    v_mul_u32_u24 v8, s78, v7
    v_lshrrev_b32 v8, 19, v8
    v_mul_u32_u24 v9, 12, v8
    v_sub_u32 v9, v7, v9
    v_mul_u32_u24 v8, 1152, v8
    v_lshl_add_u32 v8, v9, 4, v8
    v_add_u32 v6, s77, v8
    v_and_b32 v14, 31, v2
    v_and_b32 v7, 7, v14
    v_lshrrev_b32 v12, 5, v2
    v_add_u32 v13, 0, v12
    v_xor_b32 v13, v13, v7
    v_lshlrev_b32 v13, 4, v13
    v_lshl_add_u32 v13, v14, 7, v13
    v_add_u32 v8, s85, v13
    v_add_u32 v13, 2, v12
    v_xor_b32 v13, v13, v7
    v_lshlrev_b32 v13, 4, v13
    v_lshl_add_u32 v13, v14, 7, v13
    v_add_u32 v9, s85, v13
    v_add_u32 v13, 4, v12
    v_xor_b32 v13, v13, v7
    v_lshlrev_b32 v13, 4, v13
    v_lshl_add_u32 v13, v14, 7, v13
    v_add_u32 v10, s85, v13
    v_add_u32 v13, 6, v12
    v_xor_b32 v13, v13, v7
    v_lshlrev_b32 v13, 4, v13
    v_lshl_add_u32 v13, v14, 7, v13
    v_add_u32 v11, s85, v13
    v_bfe_u32 v7, v2, 2, 2
    v_lshl_add_u32 v7, v12, 3, v7
    v_mul_u32_u24 v7, 192, v7
    v_bfe_u32 v13, v2, 4, 1
    v_lshl_add_u32 v7, v13, 5, v7
    v_and_b32 v13, 1, v2
    v_lshl_add_u32 v7, v13, 4, v7
    v_bfe_u32 v13, v2, 1, 1
    v_lshl_add_u32 v7, v13, 3, v7
    s_add_u32 s77, s85, 8192
    v_add_u32 v15, s77, v7
    s_add_u32 s84, s85, 8192
    v_mov_b32 v7, v3
    s_mov_b32 m0, s84
    s_add_u32 s84, s84, 1024
    global_load_lds_dwordx4 v4, s[60:61]
    v_add_u32 v4, 18432, v4
    s_mov_b32 m0, s84
    s_add_u32 s84, s84, 1024
    global_load_lds_dwordx4 v5, s[60:61]
    v_add_u32 v5, 18432, v5
    s_mov_b32 m0, s84
    s_add_u32 s84, s84, 1024
    global_load_lds_dwordx4 v6, s[60:61]
    v_add_u32 v6, 18432, v6
    s_mov_b32 m0, s84
    s_add_u32 s84, s84, 1024
    global_load_lds_dwordx4 v4, s[60:61]
    v_add_u32 v4, 18432, v4
    s_mov_b32 m0, s84
    s_add_u32 s84, s84, 1024
    global_load_lds_dwordx4 v5, s[60:61]
    v_add_u32 v5, 18432, v5
    s_mov_b32 m0, s84
    s_add_u32 s84, s84, 1024
    global_load_lds_dwordx4 v6, s[60:61]
    v_add_u32 v6, 18432, v6
    s_mov_b32 m0, s84
    s_add_u32 s84, s84, 1024
    global_load_lds_dwordx4 v4, s[60:61]
    v_add_u32 v4, 18432, v4
    s_mov_b32 m0, s84
    s_add_u32 s84, s84, 1024
    global_load_lds_dwordx4 v5, s[60:61]
    v_add_u32 v5, 18432, v5
    s_mov_b32 m0, s84
    s_add_u32 s84, s84, 1024
    global_load_lds_dwordx4 v6, s[60:61]
    v_add_u32 v6, 18432, v6
    s_mov_b32 m0, s84
    s_add_u32 s84, s84, 1024
    global_load_lds_dwordx4 v4, s[60:61]
    v_add_u32 v4, 18432, v4
    s_mov_b32 m0, s84
    s_add_u32 s84, s84, 1024
    global_load_lds_dwordx4 v5, s[60:61]
    v_add_u32 v5, 18432, v5
    s_mov_b32 m0, s84
    s_add_u32 s84, s84, 1024
    global_load_lds_dwordx4 v6, s[60:61]
    v_add_u32 v6, 18432, v6
    s_add_u32 s84, s85, 28672
    v_mov_b32 v7, v3
    s_mov_b32 m0, s84
    s_add_u32 s84, s84, 1024
    global_load_lds_dwordx4 v4, s[60:61]
    v_add_u32 v4, 18432, v4
    s_mov_b32 m0, s84
    s_add_u32 s84, s84, 1024
    global_load_lds_dwordx4 v5, s[60:61]
    v_add_u32 v5, 18432, v5
    s_mov_b32 m0, s84
    s_add_u32 s84, s84, 1024
    global_load_lds_dwordx4 v6, s[60:61]
    v_add_u32 v6, 18432, v6
    s_mov_b32 m0, s84
    s_add_u32 s84, s84, 1024
    global_load_lds_dwordx4 v4, s[60:61]
    v_add_u32 v4, 18432, v4
    s_mov_b32 m0, s84
    s_add_u32 s84, s84, 1024
    global_load_lds_dwordx4 v5, s[60:61]
    v_add_u32 v5, 18432, v5
    s_mov_b32 m0, s84
    s_add_u32 s84, s84, 1024
    global_load_lds_dwordx4 v6, s[60:61]
    v_add_u32 v6, 18432, v6
    s_mov_b32 m0, s84
    s_add_u32 s84, s84, 1024
    global_load_lds_dwordx4 v4, s[60:61]
    v_add_u32 v4, 18432, v4
    s_mov_b32 m0, s84
    s_add_u32 s84, s84, 1024
    global_load_lds_dwordx4 v5, s[60:61]
    v_add_u32 v5, 18432, v5
    s_mov_b32 m0, s84
    s_add_u32 s84, s84, 1024
    global_load_lds_dwordx4 v6, s[60:61]
    v_add_u32 v6, 18432, v6
    s_mov_b32 m0, s84
    s_add_u32 s84, s84, 1024
    global_load_lds_dwordx4 v4, s[60:61]
    v_add_u32 v4, 18432, v4
    s_mov_b32 m0, s84
    s_add_u32 s84, s84, 1024
    global_load_lds_dwordx4 v5, s[60:61]
    v_add_u32 v5, 18432, v5
    s_mov_b32 m0, s84
    s_add_u32 s84, s84, 1024
    global_load_lds_dwordx4 v6, s[60:61]
    v_add_u32 v6, 18432, v6
    v_mov_b32 v202, v15
    v_accvgpr_write_b32 a0, 0
    v_accvgpr_write_b32 a1, 0
    v_accvgpr_write_b32 a2, 0
    v_accvgpr_write_b32 a3, 0
    v_accvgpr_write_b32 a4, 0
    v_accvgpr_write_b32 a5, 0
    v_accvgpr_write_b32 a6, 0
    v_accvgpr_write_b32 a7, 0
    v_accvgpr_write_b32 a8, 0
    v_accvgpr_write_b32 a9, 0
    v_accvgpr_write_b32 a10, 0
    v_accvgpr_write_b32 a11, 0
    v_accvgpr_write_b32 a12, 0
    v_accvgpr_write_b32 a13, 0
    v_accvgpr_write_b32 a14, 0
    v_accvgpr_write_b32 a15, 0
    v_accvgpr_write_b32 a16, 0
    v_accvgpr_write_b32 a17, 0
    v_accvgpr_write_b32 a18, 0
    v_accvgpr_write_b32 a19, 0
    v_accvgpr_write_b32 a20, 0
    v_accvgpr_write_b32 a21, 0
    v_accvgpr_write_b32 a22, 0
    v_accvgpr_write_b32 a23, 0
    v_accvgpr_write_b32 a24, 0
    v_accvgpr_write_b32 a25, 0
    v_accvgpr_write_b32 a26, 0
    v_accvgpr_write_b32 a27, 0
    v_accvgpr_write_b32 a28, 0
    v_accvgpr_write_b32 a29, 0
    v_accvgpr_write_b32 a30, 0
    v_accvgpr_write_b32 a31, 0
    v_accvgpr_write_b32 a32, 0
    v_accvgpr_write_b32 a33, 0
    v_accvgpr_write_b32 a34, 0
    v_accvgpr_write_b32 a35, 0
    v_accvgpr_write_b32 a36, 0
    v_accvgpr_write_b32 a37, 0
    v_accvgpr_write_b32 a38, 0
    v_accvgpr_write_b32 a39, 0
    v_accvgpr_write_b32 a40, 0
    v_accvgpr_write_b32 a41, 0
    v_accvgpr_write_b32 a42, 0
    v_accvgpr_write_b32 a43, 0
    v_accvgpr_write_b32 a44, 0
    v_accvgpr_write_b32 a45, 0
    v_accvgpr_write_b32 a46, 0
    v_accvgpr_write_b32 a47, 0
    v_accvgpr_write_b32 a48, 0
    v_accvgpr_write_b32 a49, 0
    v_accvgpr_write_b32 a50, 0
    v_accvgpr_write_b32 a51, 0
    v_accvgpr_write_b32 a52, 0
    v_accvgpr_write_b32 a53, 0
    v_accvgpr_write_b32 a54, 0
    v_accvgpr_write_b32 a55, 0
    v_accvgpr_write_b32 a56, 0
    v_accvgpr_write_b32 a57, 0
    v_accvgpr_write_b32 a58, 0
    v_accvgpr_write_b32 a59, 0
    v_accvgpr_write_b32 a60, 0
    v_accvgpr_write_b32 a61, 0
    v_accvgpr_write_b32 a62, 0
    v_accvgpr_write_b32 a63, 0
    v_accvgpr_write_b32 a64, 0
    v_accvgpr_write_b32 a65, 0
    v_accvgpr_write_b32 a66, 0
    v_accvgpr_write_b32 a67, 0
    v_accvgpr_write_b32 a68, 0
    v_accvgpr_write_b32 a69, 0
    v_accvgpr_write_b32 a70, 0
    v_accvgpr_write_b32 a71, 0
    v_accvgpr_write_b32 a72, 0
    v_accvgpr_write_b32 a73, 0
    v_accvgpr_write_b32 a74, 0
    v_accvgpr_write_b32 a75, 0
    v_accvgpr_write_b32 a76, 0
    v_accvgpr_write_b32 a77, 0
    v_accvgpr_write_b32 a78, 0
    v_accvgpr_write_b32 a79, 0
    v_accvgpr_write_b32 a80, 0
    v_accvgpr_write_b32 a81, 0
    v_accvgpr_write_b32 a82, 0
    v_accvgpr_write_b32 a83, 0
    v_accvgpr_write_b32 a84, 0
    v_accvgpr_write_b32 a85, 0
    v_accvgpr_write_b32 a86, 0
    v_accvgpr_write_b32 a87, 0
    v_accvgpr_write_b32 a88, 0
    v_accvgpr_write_b32 a89, 0
    v_accvgpr_write_b32 a90, 0
    v_accvgpr_write_b32 a91, 0
    v_accvgpr_write_b32 a92, 0
    v_accvgpr_write_b32 a93, 0
    v_accvgpr_write_b32 a94, 0
    v_accvgpr_write_b32 a95, 0
    s_lshl_b32 s28, s15, 1
    s_add_u32 s28, s28, 0
    s_lshl_b32 s29, s17, 2
    s_add_u32 s29, s29, s76
    s_load_dwordx2 s[40:41], s[0:1], 152
    v_and_b32 v2, 63, v0
    v_and_b32 v3, 31, v2
    v_lshrrev_b32 v4, 5, v2
    v_bfe_u32 v5, v3, 3, 1
    v_lshlrev_b32 v5, 4, v5
    v_lshrrev_b32 v6, 4, v3
    v_lshl_add_u32 v5, v6, 3, v5
    v_and_b32 v6, 7, v3
    v_add_u32 v5, v5, v6
    s_waitcnt lgkmcnt(0)
    s_mov_b32 s44, s40
    s_mov_b32 s45, s41
    s_mov_b32 s46, 268435456
    s_mov_b32 s47, 0x00020000
    s_lshl_b32 s48, s28, 5
    s_add_u32 s48, s48, s29
    s_lshl_b32 s49, s48, 13
    s_add_u32 s52, s49, 33554432
    s_add_u32 s53, s49, 0
    s_add_u32 s54, s49, 16777216
    s_lshl_b32 s49, s48, 12
    s_add_u32 s55, s49, 50331648
    s_lshl_b32 s49, s28, 18
    s_lshl_b32 s50, s29, 8
    s_add_u32 s56, s49, s50
    s_add_u32 s56, s56, 67108864
    s_mov_b32 s57, 0x3e0293ee
    v_lshrrev_b32 v6, 4, v3
    v_lshlrev_b32 v6, 10, v6
    v_and_b32 v7, 15, v3
    v_lshl_add_u32 v6, v7, 4, v6
    v_lshl_add_u32 v8, v4, 8, v6
    v_lshrrev_b32 v6, 4, v5
    v_lshlrev_b32 v6, 10, v6
    v_and_b32 v7, 15, v5
    v_lshl_add_u32 v6, v7, 4, v6
    v_lshl_add_u32 v9, v4, 8, v6
    v_and_b32 v6, 7, v3
    v_lshlrev_b32 v6, 6, v6
    v_lshl_add_u32 v10, v4, 4, v6
    v_lshrrev_b32 v6, 4, v3
    v_lshlrev_b32 v6, 4, v6
    v_bfe_u32 v7, v3, 2, 1
    v_lshl_add_u32 v6, v7, 3, v6
    v_bfe_u32 v7, v3, 3, 1
    v_lshl_add_u32 v6, v7, 2, v6
    v_and_b32 v7, 3, v3
    v_add_u32 v6, v6, v7
    v_lshrrev_b32 v7, 4, v6
    v_and_b32 v11, 15, v6
    v_lshlrev_b32 v12, 10, v7
    v_lshl_add_u32 v12, v11, 4, v12
    v_lshl_add_u32 v12, v4, 8, v12
    v_lshlrev_b32 v13, 6, v7
    v_lshl_add_u32 v13, v11, 2, v13
    v_lshl_add_u32 v13, v4, 8, v13
    v_lshlrev_b32 v14, 13, v3
    v_lshl_add_u32 v14, v4, 4, v14
    buffer_load_dwordx4 v[16:19], v8, s[44:47], s52 offen offset:0 sc1
    buffer_load_dwordx4 v[48:51], v9, s[44:47], s53 offen offset:0 sc1
    buffer_load_dwordx4 v[20:23], v8, s[44:47], s52 offen offset:512 sc1
    buffer_load_dwordx4 v[52:55], v9, s[44:47], s53 offen offset:512 sc1
    buffer_load_dwordx4 v[24:27], v8, s[44:47], s52 offen offset:2048 sc1
    buffer_load_dwordx4 v[56:59], v9, s[44:47], s53 offen offset:2048 sc1
    buffer_load_dwordx4 v[28:31], v8, s[44:47], s52 offen offset:2560 sc1
    buffer_load_dwordx4 v[60:63], v9, s[44:47], s53 offen offset:2560 sc1
    s_add_u32 s48, s52, 4096
    s_add_u32 s49, s53, 4096
    s_add_u32 s50, s54, 4096
    buffer_load_dwordx4 v[32:35], v8, s[44:47], s48 offen offset:0 sc1
    buffer_load_dwordx4 v[64:67], v9, s[44:47], s49 offen offset:0 sc1
    buffer_load_dwordx4 v[36:39], v8, s[44:47], s48 offen offset:512 sc1
    buffer_load_dwordx4 v[68:71], v9, s[44:47], s49 offen offset:512 sc1
    buffer_load_dwordx4 v[40:43], v8, s[44:47], s48 offen offset:2048 sc1
    buffer_load_dwordx4 v[72:75], v9, s[44:47], s49 offen offset:2048 sc1
    buffer_load_dwordx4 v[44:47], v8, s[44:47], s48 offen offset:2560 sc1
    buffer_load_dwordx4 v[76:79], v9, s[44:47], s49 offen offset:2560 sc1
    buffer_load_dwordx4 v[112:115], v12, s[44:47], s54 offen offset:0 sc1
    buffer_load_dwordx4 v[116:119], v12, s[44:47], s54 offen offset:512 sc1
    buffer_load_dwordx4 v[124:127], v12, s[44:47], s54 offen offset:2048 sc1
    buffer_load_dwordx4 v[128:131], v12, s[44:47], s54 offen offset:2560 sc1
    buffer_load_dwordx4 v[136:139], v12, s[44:47], s50 offen offset:0 sc1
    buffer_load_dwordx4 v[140:143], v12, s[44:47], s50 offen offset:512 sc1
    buffer_load_dwordx4 v[148:151], v12, s[44:47], s50 offen offset:2048 sc1
    buffer_load_dwordx4 v[152:155], v12, s[44:47], s50 offen offset:2560 sc1
    s_waitcnt vmcnt(8)
    v_mfma_f32_32x32x16_bf16 v[160:175], v[48:51], v[16:19], 0
    v_mfma_f32_32x32x16_bf16 v[160:175], v[52:55], v[20:23], v[160:175]
    v_mfma_f32_32x32x16_bf16 v[160:175], v[56:59], v[24:27], v[160:175]
    v_mfma_f32_32x32x16_bf16 v[160:175], v[60:63], v[28:31], v[160:175]
    v_mfma_f32_32x32x16_bf16 v[160:175], v[64:67], v[32:35], v[160:175]
    v_mfma_f32_32x32x16_bf16 v[160:175], v[68:71], v[36:39], v[160:175]
    v_mfma_f32_32x32x16_bf16 v[160:175], v[72:75], v[40:43], v[160:175]
    v_mfma_f32_32x32x16_bf16 v[160:175], v[76:79], v[44:47], v[160:175]
    s_or_b32 s30, s28, 3
    s_cmp_ge_u32 s28, 56
    s_cselect_b32 s30, s28, s30
    v_readfirstlane_b32 s14, v0
    s_nop 0
    s_cmp_lg_u32 s14, 0
    s_cbranch_scc1 wf_10_ok
    s_lshl_b32 s13, s30, 7
    s_add_u32 s13, s13, 8192
    v_mov_b32 v200, s13
    s_mov_b64 exec, 1
wf_10:
    global_load_dword v201, v200, s[26:27] sc1
    s_waitcnt vmcnt(0)
    v_readfirstlane_b32 s14, v201
    s_nop 0
    s_cmp_ge_u32 s14, 32
    s_cbranch_scc1 wf_10_ok
    s_sleep 4
    s_branch wf_10
wf_10_ok:
    s_mov_b64 exec, -1
    s_barrier
    buffer_load_dwordx4 v[80:83], v10, s[44:47], s55 offen offset:0 sc1
    buffer_load_dwordx4 v[84:87], v10, s[44:47], s55 offen offset:32 sc1
    buffer_load_dwordx4 v[88:91], v10, s[44:47], s55 offen offset:1024 sc1
    buffer_load_dwordx4 v[92:95], v10, s[44:47], s55 offen offset:1056 sc1
    buffer_load_dwordx4 v[96:99], v10, s[44:47], s55 offen offset:2048 sc1
    buffer_load_dwordx4 v[100:103], v10, s[44:47], s55 offen offset:2080 sc1
    buffer_load_dwordx4 v[104:107], v10, s[44:47], s55 offen offset:3072 sc1
    buffer_load_dwordx4 v[108:111], v10, s[44:47], s55 offen offset:3104 sc1
    buffer_load_dword v120, v13, s[44:47], s55 offen offset:512 sc1
    buffer_load_dword v121, v13, s[44:47], s55 offen offset:640 sc1
    v_mov_b32 v122, 0
    v_mov_b32 v123, 0
    buffer_load_dword v132, v13, s[44:47], s55 offen offset:1536 sc1
    buffer_load_dword v133, v13, s[44:47], s55 offen offset:1664 sc1
    v_mov_b32 v134, 0
    v_mov_b32 v135, 0
    buffer_load_dword v144, v13, s[44:47], s55 offen offset:2560 sc1
    buffer_load_dword v145, v13, s[44:47], s55 offen offset:2688 sc1
    v_mov_b32 v146, 0
    v_mov_b32 v147, 0
    buffer_load_dword v156, v13, s[44:47], s55 offen offset:3584 sc1
    buffer_load_dword v157, v13, s[44:47], s55 offen offset:3712 sc1
    v_mov_b32 v158, 0
    v_mov_b32 v159, 0
    s_waitcnt vmcnt(8)
    v_mfma_f32_32x32x16_bf16 v[176:191], v[80:83], v[16:19], 0
    v_mfma_f32_32x32x16_bf16 v[176:191], v[84:87], v[20:23], v[176:191]
    v_mfma_f32_32x32x16_bf16 v[176:191], v[88:91], v[24:27], v[176:191]
    v_mfma_f32_32x32x16_bf16 v[176:191], v[92:95], v[28:31], v[176:191]
    v_mfma_f32_32x32x16_bf16 v[176:191], v[96:99], v[32:35], v[176:191]
    v_mfma_f32_32x32x16_bf16 v[176:191], v[100:103], v[36:39], v[176:191]
    v_mfma_f32_32x32x16_bf16 v[176:191], v[104:107], v[40:43], v[176:191]
    v_mfma_f32_32x32x16_bf16 v[176:191], v[108:111], v[44:47], v[176:191]
    v_lshlrev_b32 v6, 2, v4
    v_sub_u32 v6, v3, v6
    v_mov_b32 v7, 0xff800000
    v_cmp_gt_i32 vcc, 0, v6
    s_nop 1
    v_cndmask_b32 v160, v160, v7, vcc
    v_cmp_gt_i32 vcc, 1, v6
    s_nop 1
    v_cndmask_b32 v161, v161, v7, vcc
    v_cmp_gt_i32 vcc, 2, v6
    s_nop 1
    v_cndmask_b32 v162, v162, v7, vcc
    v_cmp_gt_i32 vcc, 3, v6
    s_nop 1
    v_cndmask_b32 v163, v163, v7, vcc
    v_cmp_gt_i32 vcc, 16, v6
    s_nop 1
    v_cndmask_b32 v164, v164, v7, vcc
    v_cmp_gt_i32 vcc, 17, v6
    s_nop 1
    v_cndmask_b32 v165, v165, v7, vcc
    v_cmp_gt_i32 vcc, 18, v6
    s_nop 1
    v_cndmask_b32 v166, v166, v7, vcc
    v_cmp_gt_i32 vcc, 19, v6
    s_nop 1
    v_cndmask_b32 v167, v167, v7, vcc
    v_cmp_gt_i32 vcc, 8, v6
    s_nop 1
    v_cndmask_b32 v168, v168, v7, vcc
    v_cmp_gt_i32 vcc, 9, v6
    s_nop 1
    v_cndmask_b32 v169, v169, v7, vcc
    v_cmp_gt_i32 vcc, 10, v6
    s_nop 1
    v_cndmask_b32 v170, v170, v7, vcc
    v_cmp_gt_i32 vcc, 11, v6
    s_nop 1
    v_cndmask_b32 v171, v171, v7, vcc
    v_cmp_gt_i32 vcc, 24, v6
    s_nop 1
    v_cndmask_b32 v172, v172, v7, vcc
    v_cmp_gt_i32 vcc, 25, v6
    s_nop 1
    v_cndmask_b32 v173, v173, v7, vcc
    v_cmp_gt_i32 vcc, 26, v6
    s_nop 1
    v_cndmask_b32 v174, v174, v7, vcc
    v_cmp_gt_i32 vcc, 27, v6
    s_nop 1
    v_cndmask_b32 v175, v175, v7, vcc
    v_max3_f32 v15, v160, v161, v162
    v_max3_f32 v15, v15, v163, v164
    v_max3_f32 v15, v15, v165, v166
    v_max3_f32 v15, v15, v167, v168
    v_max3_f32 v15, v15, v169, v170
    v_max3_f32 v15, v15, v171, v172
    v_max3_f32 v15, v15, v173, v174
    v_max3_f32 v15, v15, v175, v176
    v_max3_f32 v15, v15, v177, v178
    v_max_f32 v15, v15, v179
    v_mov_b32 v6, v15
    s_nop 1
    v_permlane32_swap_b32 v6, v15
    v_max_f32 v15, v15, v6
    v_mul_f32 v15, s57, v15
    v_fma_f32 v160, v160, s57, -v15
    v_fma_f32 v161, v161, s57, -v15
    v_fma_f32 v162, v162, s57, -v15
    v_fma_f32 v163, v163, s57, -v15
    v_fma_f32 v164, v164, s57, -v15
    v_fma_f32 v165, v165, s57, -v15
    v_fma_f32 v166, v166, s57, -v15
    v_fma_f32 v167, v167, s57, -v15
    v_fma_f32 v168, v168, s57, -v15
    v_fma_f32 v169, v169, s57, -v15
    v_fma_f32 v170, v170, s57, -v15
    v_fma_f32 v171, v171, s57, -v15
    v_fma_f32 v172, v172, s57, -v15
    v_fma_f32 v173, v173, s57, -v15
    v_fma_f32 v174, v174, s57, -v15
    v_fma_f32 v175, v175, s57, -v15
    v_fma_f32 v176, v176, s57, -v15
    v_fma_f32 v177, v177, s57, -v15
    v_fma_f32 v178, v178, s57, -v15
    v_fma_f32 v179, v179, s57, -v15
    v_exp_f32 v160, v160
    v_exp_f32 v161, v161
    v_exp_f32 v162, v162
    v_exp_f32 v163, v163
    v_exp_f32 v164, v164
    v_exp_f32 v165, v165
    v_exp_f32 v166, v166
    v_exp_f32 v167, v167
    v_exp_f32 v168, v168
    v_exp_f32 v169, v169
    v_exp_f32 v170, v170
    v_exp_f32 v171, v171
    v_exp_f32 v172, v172
    v_exp_f32 v173, v173
    v_exp_f32 v174, v174
    v_exp_f32 v175, v175
    v_exp_f32 v176, v176
    v_exp_f32 v177, v177
    v_exp_f32 v178, v178
    v_exp_f32 v179, v179
    v_add_f32 v15, v160, v161
    v_add_f32 v15, v15, v162
    v_add_f32 v15, v15, v163
    v_add_f32 v15, v15, v164
    v_add_f32 v15, v15, v165
    v_add_f32 v15, v15, v166
    v_add_f32 v15, v15, v167
    v_add_f32 v15, v15, v168
    v_add_f32 v15, v15, v169
    v_add_f32 v15, v15, v170
    v_add_f32 v15, v15, v171
    v_add_f32 v15, v15, v172
    v_add_f32 v15, v15, v173
    v_add_f32 v15, v15, v174
    v_add_f32 v15, v15, v175
    v_add_f32 v15, v15, v176
    v_add_f32 v15, v15, v177
    v_add_f32 v15, v15, v178
    v_add_f32 v15, v15, v179
    v_mov_b32 v6, v15
    s_nop 1
    v_permlane32_swap_b32 v6, v15
    v_add_f32 v15, v15, v6
    v_rcp_f32 v15, v15
    s_nop 0
    v_mul_f32 v160, v160, v15
    v_mul_f32 v161, v161, v15
    v_mul_f32 v162, v162, v15
    v_mul_f32 v163, v163, v15
    v_mul_f32 v164, v164, v15
    v_mul_f32 v165, v165, v15
    v_mul_f32 v166, v166, v15
    v_mul_f32 v167, v167, v15
    v_mul_f32 v168, v168, v15
    v_mul_f32 v169, v169, v15
    v_mul_f32 v170, v170, v15
    v_mul_f32 v171, v171, v15
    v_mul_f32 v172, v172, v15
    v_mul_f32 v173, v173, v15
    v_mul_f32 v174, v174, v15
    v_mul_f32 v175, v175, v15
    v_mul_f32 v176, v176, v15
    v_mul_f32 v177, v177, v15
    v_mul_f32 v178, v178, v15
    v_mul_f32 v179, v179, v15
    v_cvt_pk_bf16_f32 v16, v160, v161
    v_cvt_pk_bf16_f32 v17, v164, v165
    v_cvt_pk_bf16_f32 v18, v162, v163
    v_cvt_pk_bf16_f32 v19, v166, v167
    v_cvt_pk_bf16_f32 v20, v168, v169
    v_cvt_pk_bf16_f32 v21, v172, v173
    v_cvt_pk_bf16_f32 v22, v170, v171
    v_cvt_pk_bf16_f32 v23, v174, v175
    v_cvt_pk_bf16_f32 v24, v176, v177
    v_cvt_pk_bf16_f32 v25, v178, v179
    v_mov_b32 v26, 0
    v_mov_b32 v27, 0
    s_waitcnt vmcnt(0)
    v_mfma_f32_32x32x16_bf16 v[48:63], v[112:115], v[16:19], 0
    v_mfma_f32_32x32x16_bf16 v[48:63], v[116:119], v[20:23], v[48:63]
    v_mfma_f32_32x32x16_bf16 v[48:63], v[120:123], v[24:27], v[48:63]
    v_mfma_f32_32x32x16_bf16 v[64:79], v[124:127], v[16:19], 0
    v_mfma_f32_32x32x16_bf16 v[64:79], v[128:131], v[20:23], v[64:79]
    v_mfma_f32_32x32x16_bf16 v[64:79], v[132:135], v[24:27], v[64:79]
    v_mfma_f32_32x32x16_bf16 v[80:95], v[136:139], v[16:19], 0
    v_mfma_f32_32x32x16_bf16 v[80:95], v[140:143], v[20:23], v[80:95]
    v_mfma_f32_32x32x16_bf16 v[80:95], v[144:147], v[24:27], v[80:95]
    v_mfma_f32_32x32x16_bf16 v[96:111], v[148:151], v[16:19], 0
    v_mfma_f32_32x32x16_bf16 v[96:111], v[152:155], v[20:23], v[96:111]
    v_mfma_f32_32x32x16_bf16 v[96:111], v[156:159], v[24:27], v[96:111]
    s_nop 2
    v_cvt_pk_bf16_f32 v160, v48, v49
    v_cvt_pk_bf16_f32 v161, v50, v51
    v_cvt_pk_bf16_f32 v162, v52, v53
    v_cvt_pk_bf16_f32 v163, v54, v55
    v_cvt_pk_bf16_f32 v164, v56, v57
    v_cvt_pk_bf16_f32 v165, v58, v59
    v_cvt_pk_bf16_f32 v166, v60, v61
    v_cvt_pk_bf16_f32 v167, v62, v63
    v_cvt_pk_bf16_f32 v168, v64, v65
    v_cvt_pk_bf16_f32 v169, v66, v67
    v_cvt_pk_bf16_f32 v170, v68, v69
    v_cvt_pk_bf16_f32 v171, v70, v71
    v_cvt_pk_bf16_f32 v172, v72, v73
    v_cvt_pk_bf16_f32 v173, v74, v75
    v_cvt_pk_bf16_f32 v174, v76, v77
    v_cvt_pk_bf16_f32 v175, v78, v79
    v_cvt_pk_bf16_f32 v176, v80, v81
    v_cvt_pk_bf16_f32 v177, v82, v83
    v_cvt_pk_bf16_f32 v178, v84, v85
    v_cvt_pk_bf16_f32 v179, v86, v87
    v_cvt_pk_bf16_f32 v180, v88, v89
    v_cvt_pk_bf16_f32 v181, v90, v91
    v_cvt_pk_bf16_f32 v182, v92, v93
    v_cvt_pk_bf16_f32 v183, v94, v95
    v_cvt_pk_bf16_f32 v184, v96, v97
    v_cvt_pk_bf16_f32 v185, v98, v99
    v_cvt_pk_bf16_f32 v186, v100, v101
    v_cvt_pk_bf16_f32 v187, v102, v103
    v_cvt_pk_bf16_f32 v188, v104, v105
    v_cvt_pk_bf16_f32 v189, v106, v107
    v_cvt_pk_bf16_f32 v190, v108, v109
    v_cvt_pk_bf16_f32 v191, v110, v111
    ds_read_b64_tr_b16 v[204:205], v202 offset:0
    ds_read_b64_tr_b16 v[206:207], v202 offset:768
    ds_read_b64_tr_b16 v[208:209], v202 offset:64
    ds_read_b64_tr_b16 v[210:211], v202 offset:832
    ds_read_b64_tr_b16 v[212:213], v202 offset:128
    ds_read_b64_tr_b16 v[214:215], v202 offset:896
    ds_read_b64_tr_b16 v[216:217], v202 offset:3072
    ds_read_b64_tr_b16 v[218:219], v202 offset:3840
    ds_read_b64_tr_b16 v[220:221], v202 offset:3136
    ds_read_b64_tr_b16 v[222:223], v202 offset:3904
    ds_read_b64_tr_b16 v[224:225], v202 offset:3200
    ds_read_b64_tr_b16 v[226:227], v202 offset:3968
    s_waitcnt lgkmcnt(6)
    v_mfma_f32_32x32x16_bf16 a[0:15], v[204:207], v[160:163], a[0:15]
    v_mfma_f32_32x32x16_bf16 a[32:47], v[208:211], v[160:163], a[32:47]
    v_mfma_f32_32x32x16_bf16 a[64:79], v[212:215], v[160:163], a[64:79]
    ds_read_b64_tr_b16 v[204:205], v202 offset:6144
    ds_read_b64_tr_b16 v[206:207], v202 offset:6912
    ds_read_b64_tr_b16 v[208:209], v202 offset:6208
    ds_read_b64_tr_b16 v[210:211], v202 offset:6976
    ds_read_b64_tr_b16 v[212:213], v202 offset:6272
    ds_read_b64_tr_b16 v[214:215], v202 offset:7040
    s_waitcnt lgkmcnt(6)
    v_mfma_f32_32x32x16_bf16 a[0:15], v[216:219], v[164:167], a[0:15]
    v_mfma_f32_32x32x16_bf16 a[32:47], v[220:223], v[164:167], a[32:47]
    v_mfma_f32_32x32x16_bf16 a[64:79], v[224:227], v[164:167], a[64:79]
    ds_read_b64_tr_b16 v[216:217], v202 offset:9216
    ds_read_b64_tr_b16 v[218:219], v202 offset:9984
    ds_read_b64_tr_b16 v[220:221], v202 offset:9280
    ds_read_b64_tr_b16 v[222:223], v202 offset:10048
    ds_read_b64_tr_b16 v[224:225], v202 offset:9344
    ds_read_b64_tr_b16 v[226:227], v202 offset:10112
    s_waitcnt lgkmcnt(6)
    v_mfma_f32_32x32x16_bf16 a[0:15], v[204:207], v[168:171], a[0:15]
    v_mfma_f32_32x32x16_bf16 a[32:47], v[208:211], v[168:171], a[32:47]
    v_mfma_f32_32x32x16_bf16 a[64:79], v[212:215], v[168:171], a[64:79]
    ds_read_b64_tr_b16 v[204:205], v202 offset:20480
    ds_read_b64_tr_b16 v[206:207], v202 offset:21248
    ds_read_b64_tr_b16 v[208:209], v202 offset:20544
    ds_read_b64_tr_b16 v[210:211], v202 offset:21312
    ds_read_b64_tr_b16 v[212:213], v202 offset:20608
    ds_read_b64_tr_b16 v[214:215], v202 offset:21376
    s_waitcnt lgkmcnt(6)
    v_mfma_f32_32x32x16_bf16 a[0:15], v[216:219], v[172:175], a[0:15]
    v_mfma_f32_32x32x16_bf16 a[32:47], v[220:223], v[172:175], a[32:47]
    v_mfma_f32_32x32x16_bf16 a[64:79], v[224:227], v[172:175], a[64:79]
    ds_read_b64_tr_b16 v[216:217], v202 offset:23552
    ds_read_b64_tr_b16 v[218:219], v202 offset:24320
    ds_read_b64_tr_b16 v[220:221], v202 offset:23616
    ds_read_b64_tr_b16 v[222:223], v202 offset:24384
    ds_read_b64_tr_b16 v[224:225], v202 offset:23680
    ds_read_b64_tr_b16 v[226:227], v202 offset:24448
    s_waitcnt lgkmcnt(6)
    v_mfma_f32_32x32x16_bf16 a[0:15], v[204:207], v[176:179], a[0:15]
    v_mfma_f32_32x32x16_bf16 a[32:47], v[208:211], v[176:179], a[32:47]
    v_mfma_f32_32x32x16_bf16 a[64:79], v[212:215], v[176:179], a[64:79]
    ds_read_b64_tr_b16 v[204:205], v202 offset:26624
    ds_read_b64_tr_b16 v[206:207], v202 offset:27392
    ds_read_b64_tr_b16 v[208:209], v202 offset:26688
    ds_read_b64_tr_b16 v[210:211], v202 offset:27456
    ds_read_b64_tr_b16 v[212:213], v202 offset:26752
    ds_read_b64_tr_b16 v[214:215], v202 offset:27520
    s_waitcnt lgkmcnt(6)
    v_mfma_f32_32x32x16_bf16 a[0:15], v[216:219], v[180:183], a[0:15]
    v_mfma_f32_32x32x16_bf16 a[32:47], v[220:223], v[180:183], a[32:47]
    v_mfma_f32_32x32x16_bf16 a[64:79], v[224:227], v[180:183], a[64:79]
    ds_read_b64_tr_b16 v[216:217], v202 offset:29696
    ds_read_b64_tr_b16 v[218:219], v202 offset:30464
    ds_read_b64_tr_b16 v[220:221], v202 offset:29760
    ds_read_b64_tr_b16 v[222:223], v202 offset:30528
    ds_read_b64_tr_b16 v[224:225], v202 offset:29824
    ds_read_b64_tr_b16 v[226:227], v202 offset:30592
    s_waitcnt lgkmcnt(6)
    v_mfma_f32_32x32x16_bf16 a[0:15], v[204:207], v[184:187], a[0:15]
    v_mfma_f32_32x32x16_bf16 a[32:47], v[208:211], v[184:187], a[32:47]
    v_mfma_f32_32x32x16_bf16 a[64:79], v[212:215], v[184:187], a[64:79]
    s_waitcnt lgkmcnt(0)
    v_mfma_f32_32x32x16_bf16 a[0:15], v[216:219], v[188:191], a[0:15]
    v_mfma_f32_32x32x16_bf16 a[32:47], v[220:223], v[188:191], a[32:47]
    v_mfma_f32_32x32x16_bf16 a[64:79], v[224:227], v[188:191], a[64:79]
    s_lshl_b32 s28, s15, 1
    s_add_u32 s28, s28, 1
    s_lshl_b32 s29, s17, 2
    s_add_u32 s29, s29, s76
    s_load_dwordx2 s[40:41], s[0:1], 152
    v_and_b32 v2, 63, v0
    v_and_b32 v3, 31, v2
    v_lshrrev_b32 v4, 5, v2
    v_bfe_u32 v5, v3, 3, 1
    v_lshlrev_b32 v5, 4, v5
    v_lshrrev_b32 v6, 4, v3
    v_lshl_add_u32 v5, v6, 3, v5
    v_and_b32 v6, 7, v3
    v_add_u32 v5, v5, v6
    s_waitcnt lgkmcnt(0)
    s_mov_b32 s44, s40
    s_mov_b32 s45, s41
    s_mov_b32 s46, 268435456
    s_mov_b32 s47, 0x00020000
    s_lshl_b32 s48, s28, 5
    s_add_u32 s48, s48, s29
    s_lshl_b32 s49, s48, 13
    s_add_u32 s52, s49, 33554432
    s_add_u32 s53, s49, 0
    s_add_u32 s54, s49, 16777216
    s_lshl_b32 s49, s48, 12
    s_add_u32 s55, s49, 50331648
    s_lshl_b32 s49, s28, 18
    s_lshl_b32 s50, s29, 8
    s_add_u32 s56, s49, s50
    s_add_u32 s56, s56, 67108864
    s_mov_b32 s57, 0x3e0293ee
    v_lshrrev_b32 v6, 4, v3
    v_lshlrev_b32 v6, 10, v6
    v_and_b32 v7, 15, v3
    v_lshl_add_u32 v6, v7, 4, v6
    v_lshl_add_u32 v8, v4, 8, v6
    v_lshrrev_b32 v6, 4, v5
    v_lshlrev_b32 v6, 10, v6
    v_and_b32 v7, 15, v5
    v_lshl_add_u32 v6, v7, 4, v6
    v_lshl_add_u32 v9, v4, 8, v6
    v_and_b32 v6, 7, v3
    v_lshlrev_b32 v6, 6, v6
    v_lshl_add_u32 v10, v4, 4, v6
    v_lshrrev_b32 v6, 4, v3
    v_lshlrev_b32 v6, 4, v6
    v_bfe_u32 v7, v3, 2, 1
    v_lshl_add_u32 v6, v7, 3, v6
    v_bfe_u32 v7, v3, 3, 1
    v_lshl_add_u32 v6, v7, 2, v6
    v_and_b32 v7, 3, v3
    v_add_u32 v6, v6, v7
    v_lshrrev_b32 v7, 4, v6
    v_and_b32 v11, 15, v6
    v_lshlrev_b32 v12, 10, v7
    v_lshl_add_u32 v12, v11, 4, v12
    v_lshl_add_u32 v12, v4, 8, v12
    v_lshlrev_b32 v13, 6, v7
    v_lshl_add_u32 v13, v11, 2, v13
    v_lshl_add_u32 v13, v4, 8, v13
    v_lshlrev_b32 v14, 13, v3
    v_lshl_add_u32 v14, v4, 4, v14
    buffer_load_dwordx4 v[16:19], v8, s[44:47], s52 offen offset:0 sc1
    buffer_load_dwordx4 v[48:51], v9, s[44:47], s53 offen offset:0 sc1
    buffer_load_dwordx4 v[20:23], v8, s[44:47], s52 offen offset:512 sc1
    buffer_load_dwordx4 v[52:55], v9, s[44:47], s53 offen offset:512 sc1
    buffer_load_dwordx4 v[24:27], v8, s[44:47], s52 offen offset:2048 sc1
    buffer_load_dwordx4 v[56:59], v9, s[44:47], s53 offen offset:2048 sc1
    buffer_load_dwordx4 v[28:31], v8, s[44:47], s52 offen offset:2560 sc1
    buffer_load_dwordx4 v[60:63], v9, s[44:47], s53 offen offset:2560 sc1
    s_add_u32 s48, s52, 4096
    s_add_u32 s49, s53, 4096
    s_add_u32 s50, s54, 4096
    buffer_load_dwordx4 v[32:35], v8, s[44:47], s48 offen offset:0 sc1
    buffer_load_dwordx4 v[64:67], v9, s[44:47], s49 offen offset:0 sc1
    buffer_load_dwordx4 v[36:39], v8, s[44:47], s48 offen offset:512 sc1
    buffer_load_dwordx4 v[68:71], v9, s[44:47], s49 offen offset:512 sc1
    buffer_load_dwordx4 v[40:43], v8, s[44:47], s48 offen offset:2048 sc1
    buffer_load_dwordx4 v[72:75], v9, s[44:47], s49 offen offset:2048 sc1
    buffer_load_dwordx4 v[44:47], v8, s[44:47], s48 offen offset:2560 sc1
    buffer_load_dwordx4 v[76:79], v9, s[44:47], s49 offen offset:2560 sc1
    buffer_load_dwordx4 v[112:115], v12, s[44:47], s54 offen offset:0 sc1
    buffer_load_dwordx4 v[116:119], v12, s[44:47], s54 offen offset:512 sc1
    buffer_load_dwordx4 v[124:127], v12, s[44:47], s54 offen offset:2048 sc1
    buffer_load_dwordx4 v[128:131], v12, s[44:47], s54 offen offset:2560 sc1
    buffer_load_dwordx4 v[136:139], v12, s[44:47], s50 offen offset:0 sc1
    buffer_load_dwordx4 v[140:143], v12, s[44:47], s50 offen offset:512 sc1
    buffer_load_dwordx4 v[148:151], v12, s[44:47], s50 offen offset:2048 sc1
    buffer_load_dwordx4 v[152:155], v12, s[44:47], s50 offen offset:2560 sc1
    s_waitcnt vmcnt(8)
    v_mfma_f32_32x32x16_bf16 v[160:175], v[48:51], v[16:19], 0
    v_mfma_f32_32x32x16_bf16 v[160:175], v[52:55], v[20:23], v[160:175]
    v_mfma_f32_32x32x16_bf16 v[160:175], v[56:59], v[24:27], v[160:175]
    v_mfma_f32_32x32x16_bf16 v[160:175], v[60:63], v[28:31], v[160:175]
    v_mfma_f32_32x32x16_bf16 v[160:175], v[64:67], v[32:35], v[160:175]
    v_mfma_f32_32x32x16_bf16 v[160:175], v[68:71], v[36:39], v[160:175]
    v_mfma_f32_32x32x16_bf16 v[160:175], v[72:75], v[40:43], v[160:175]
    v_mfma_f32_32x32x16_bf16 v[160:175], v[76:79], v[44:47], v[160:175]
    s_or_b32 s30, s28, 3
    s_cmp_ge_u32 s28, 56
    s_cselect_b32 s30, s28, s30
    v_readfirstlane_b32 s14, v0
    s_nop 0
    s_cmp_lg_u32 s14, 0
    s_cbranch_scc1 wf_11_ok
    s_lshl_b32 s13, s30, 7
    s_add_u32 s13, s13, 8192
    v_mov_b32 v200, s13
    s_mov_b64 exec, 1
wf_11:
    global_load_dword v201, v200, s[26:27] sc1
    s_waitcnt vmcnt(0)
    v_readfirstlane_b32 s14, v201
    s_nop 0
    s_cmp_ge_u32 s14, 32
    s_cbranch_scc1 wf_11_ok
    s_sleep 4
    s_branch wf_11
wf_11_ok:
    s_mov_b64 exec, -1
    s_barrier
    buffer_load_dwordx4 v[80:83], v10, s[44:47], s55 offen offset:0 sc1
    buffer_load_dwordx4 v[84:87], v10, s[44:47], s55 offen offset:32 sc1
    buffer_load_dwordx4 v[88:91], v10, s[44:47], s55 offen offset:1024 sc1
    buffer_load_dwordx4 v[92:95], v10, s[44:47], s55 offen offset:1056 sc1
    buffer_load_dwordx4 v[96:99], v10, s[44:47], s55 offen offset:2048 sc1
    buffer_load_dwordx4 v[100:103], v10, s[44:47], s55 offen offset:2080 sc1
    buffer_load_dwordx4 v[104:107], v10, s[44:47], s55 offen offset:3072 sc1
    buffer_load_dwordx4 v[108:111], v10, s[44:47], s55 offen offset:3104 sc1
    buffer_load_dword v120, v13, s[44:47], s55 offen offset:512 sc1
    buffer_load_dword v121, v13, s[44:47], s55 offen offset:640 sc1
    v_mov_b32 v122, 0
    v_mov_b32 v123, 0
    buffer_load_dword v132, v13, s[44:47], s55 offen offset:1536 sc1
    buffer_load_dword v133, v13, s[44:47], s55 offen offset:1664 sc1
    v_mov_b32 v134, 0
    v_mov_b32 v135, 0
    buffer_load_dword v144, v13, s[44:47], s55 offen offset:2560 sc1
    buffer_load_dword v145, v13, s[44:47], s55 offen offset:2688 sc1
    v_mov_b32 v146, 0
    v_mov_b32 v147, 0
    buffer_load_dword v156, v13, s[44:47], s55 offen offset:3584 sc1
    buffer_load_dword v157, v13, s[44:47], s55 offen offset:3712 sc1
    v_mov_b32 v158, 0
    v_mov_b32 v159, 0
    s_waitcnt vmcnt(8)
    v_mfma_f32_32x32x16_bf16 v[176:191], v[80:83], v[16:19], 0
    v_mfma_f32_32x32x16_bf16 v[176:191], v[84:87], v[20:23], v[176:191]
    v_mfma_f32_32x32x16_bf16 v[176:191], v[88:91], v[24:27], v[176:191]
    v_mfma_f32_32x32x16_bf16 v[176:191], v[92:95], v[28:31], v[176:191]
    v_mfma_f32_32x32x16_bf16 v[176:191], v[96:99], v[32:35], v[176:191]
    v_mfma_f32_32x32x16_bf16 v[176:191], v[100:103], v[36:39], v[176:191]
    v_mfma_f32_32x32x16_bf16 v[176:191], v[104:107], v[40:43], v[176:191]
    v_mfma_f32_32x32x16_bf16 v[176:191], v[108:111], v[44:47], v[176:191]
    v_lshlrev_b32 v6, 2, v4
    v_sub_u32 v6, v3, v6
    v_mov_b32 v7, 0xff800000
    v_cmp_gt_i32 vcc, 0, v6
    s_nop 1
    v_cndmask_b32 v160, v160, v7, vcc
    v_cmp_gt_i32 vcc, 1, v6
    s_nop 1
    v_cndmask_b32 v161, v161, v7, vcc
    v_cmp_gt_i32 vcc, 2, v6
    s_nop 1
    v_cndmask_b32 v162, v162, v7, vcc
    v_cmp_gt_i32 vcc, 3, v6
    s_nop 1
    v_cndmask_b32 v163, v163, v7, vcc
    v_cmp_gt_i32 vcc, 16, v6
    s_nop 1
    v_cndmask_b32 v164, v164, v7, vcc
    v_cmp_gt_i32 vcc, 17, v6
    s_nop 1
    v_cndmask_b32 v165, v165, v7, vcc
    v_cmp_gt_i32 vcc, 18, v6
    s_nop 1
    v_cndmask_b32 v166, v166, v7, vcc
    v_cmp_gt_i32 vcc, 19, v6
    s_nop 1
    v_cndmask_b32 v167, v167, v7, vcc
    v_cmp_gt_i32 vcc, 8, v6
    s_nop 1
    v_cndmask_b32 v168, v168, v7, vcc
    v_cmp_gt_i32 vcc, 9, v6
    s_nop 1
    v_cndmask_b32 v169, v169, v7, vcc
    v_cmp_gt_i32 vcc, 10, v6
    s_nop 1
    v_cndmask_b32 v170, v170, v7, vcc
    v_cmp_gt_i32 vcc, 11, v6
    s_nop 1
    v_cndmask_b32 v171, v171, v7, vcc
    v_cmp_gt_i32 vcc, 24, v6
    s_nop 1
    v_cndmask_b32 v172, v172, v7, vcc
    v_cmp_gt_i32 vcc, 25, v6
    s_nop 1
    v_cndmask_b32 v173, v173, v7, vcc
    v_cmp_gt_i32 vcc, 26, v6
    s_nop 1
    v_cndmask_b32 v174, v174, v7, vcc
    v_cmp_gt_i32 vcc, 27, v6
    s_nop 1
    v_cndmask_b32 v175, v175, v7, vcc
    v_max3_f32 v15, v160, v161, v162
    v_max3_f32 v15, v15, v163, v164
    v_max3_f32 v15, v15, v165, v166
    v_max3_f32 v15, v15, v167, v168
    v_max3_f32 v15, v15, v169, v170
    v_max3_f32 v15, v15, v171, v172
    v_max3_f32 v15, v15, v173, v174
    v_max3_f32 v15, v15, v175, v176
    v_max3_f32 v15, v15, v177, v178
    v_max_f32 v15, v15, v179
    v_mov_b32 v6, v15
    s_nop 1
    v_permlane32_swap_b32 v6, v15
    v_max_f32 v15, v15, v6
    v_mul_f32 v15, s57, v15
    v_fma_f32 v160, v160, s57, -v15
    v_fma_f32 v161, v161, s57, -v15
    v_fma_f32 v162, v162, s57, -v15
    v_fma_f32 v163, v163, s57, -v15
    v_fma_f32 v164, v164, s57, -v15
    v_fma_f32 v165, v165, s57, -v15
    v_fma_f32 v166, v166, s57, -v15
    v_fma_f32 v167, v167, s57, -v15
    v_fma_f32 v168, v168, s57, -v15
    v_fma_f32 v169, v169, s57, -v15
    v_fma_f32 v170, v170, s57, -v15
    v_fma_f32 v171, v171, s57, -v15
    v_fma_f32 v172, v172, s57, -v15
    v_fma_f32 v173, v173, s57, -v15
    v_fma_f32 v174, v174, s57, -v15
    v_fma_f32 v175, v175, s57, -v15
    v_fma_f32 v176, v176, s57, -v15
    v_fma_f32 v177, v177, s57, -v15
    v_fma_f32 v178, v178, s57, -v15
    v_fma_f32 v179, v179, s57, -v15
    v_exp_f32 v160, v160
    v_exp_f32 v161, v161
    v_exp_f32 v162, v162
    v_exp_f32 v163, v163
    v_exp_f32 v164, v164
    v_exp_f32 v165, v165
    v_exp_f32 v166, v166
    v_exp_f32 v167, v167
    v_exp_f32 v168, v168
    v_exp_f32 v169, v169
    v_exp_f32 v170, v170
    v_exp_f32 v171, v171
    v_exp_f32 v172, v172
    v_exp_f32 v173, v173
    v_exp_f32 v174, v174
    v_exp_f32 v175, v175
    v_exp_f32 v176, v176
    v_exp_f32 v177, v177
    v_exp_f32 v178, v178
    v_exp_f32 v179, v179
    v_add_f32 v15, v160, v161
    v_add_f32 v15, v15, v162
    v_add_f32 v15, v15, v163
    v_add_f32 v15, v15, v164
    v_add_f32 v15, v15, v165
    v_add_f32 v15, v15, v166
    v_add_f32 v15, v15, v167
    v_add_f32 v15, v15, v168
    v_add_f32 v15, v15, v169
    v_add_f32 v15, v15, v170
    v_add_f32 v15, v15, v171
    v_add_f32 v15, v15, v172
    v_add_f32 v15, v15, v173
    v_add_f32 v15, v15, v174
    v_add_f32 v15, v15, v175
    v_add_f32 v15, v15, v176
    v_add_f32 v15, v15, v177
    v_add_f32 v15, v15, v178
    v_add_f32 v15, v15, v179
    v_mov_b32 v6, v15
    s_nop 1
    v_permlane32_swap_b32 v6, v15
    v_add_f32 v15, v15, v6
    v_rcp_f32 v15, v15
    s_nop 0
    v_mul_f32 v160, v160, v15
    v_mul_f32 v161, v161, v15
    v_mul_f32 v162, v162, v15
    v_mul_f32 v163, v163, v15
    v_mul_f32 v164, v164, v15
    v_mul_f32 v165, v165, v15
    v_mul_f32 v166, v166, v15
    v_mul_f32 v167, v167, v15
    v_mul_f32 v168, v168, v15
    v_mul_f32 v169, v169, v15
    v_mul_f32 v170, v170, v15
    v_mul_f32 v171, v171, v15
    v_mul_f32 v172, v172, v15
    v_mul_f32 v173, v173, v15
    v_mul_f32 v174, v174, v15
    v_mul_f32 v175, v175, v15
    v_mul_f32 v176, v176, v15
    v_mul_f32 v177, v177, v15
    v_mul_f32 v178, v178, v15
    v_mul_f32 v179, v179, v15
    v_cvt_pk_bf16_f32 v16, v160, v161
    v_cvt_pk_bf16_f32 v17, v164, v165
    v_cvt_pk_bf16_f32 v18, v162, v163
    v_cvt_pk_bf16_f32 v19, v166, v167
    v_cvt_pk_bf16_f32 v20, v168, v169
    v_cvt_pk_bf16_f32 v21, v172, v173
    v_cvt_pk_bf16_f32 v22, v170, v171
    v_cvt_pk_bf16_f32 v23, v174, v175
    v_cvt_pk_bf16_f32 v24, v176, v177
    v_cvt_pk_bf16_f32 v25, v178, v179
    v_mov_b32 v26, 0
    v_mov_b32 v27, 0
    s_waitcnt vmcnt(0)
    v_mfma_f32_32x32x16_bf16 v[48:63], v[112:115], v[16:19], 0
    v_mfma_f32_32x32x16_bf16 v[48:63], v[116:119], v[20:23], v[48:63]
    v_mfma_f32_32x32x16_bf16 v[48:63], v[120:123], v[24:27], v[48:63]
    v_mfma_f32_32x32x16_bf16 v[64:79], v[124:127], v[16:19], 0
    v_mfma_f32_32x32x16_bf16 v[64:79], v[128:131], v[20:23], v[64:79]
    v_mfma_f32_32x32x16_bf16 v[64:79], v[132:135], v[24:27], v[64:79]
    v_mfma_f32_32x32x16_bf16 v[80:95], v[136:139], v[16:19], 0
    v_mfma_f32_32x32x16_bf16 v[80:95], v[140:143], v[20:23], v[80:95]
    v_mfma_f32_32x32x16_bf16 v[80:95], v[144:147], v[24:27], v[80:95]
    v_mfma_f32_32x32x16_bf16 v[96:111], v[148:151], v[16:19], 0
    v_mfma_f32_32x32x16_bf16 v[96:111], v[152:155], v[20:23], v[96:111]
    v_mfma_f32_32x32x16_bf16 v[96:111], v[156:159], v[24:27], v[96:111]
    s_nop 2
    v_cvt_pk_bf16_f32 v160, v48, v49
    v_cvt_pk_bf16_f32 v161, v50, v51
    v_cvt_pk_bf16_f32 v162, v52, v53
    v_cvt_pk_bf16_f32 v163, v54, v55
    v_cvt_pk_bf16_f32 v164, v56, v57
    v_cvt_pk_bf16_f32 v165, v58, v59
    v_cvt_pk_bf16_f32 v166, v60, v61
    v_cvt_pk_bf16_f32 v167, v62, v63
    v_cvt_pk_bf16_f32 v168, v64, v65
    v_cvt_pk_bf16_f32 v169, v66, v67
    v_cvt_pk_bf16_f32 v170, v68, v69
    v_cvt_pk_bf16_f32 v171, v70, v71
    v_cvt_pk_bf16_f32 v172, v72, v73
    v_cvt_pk_bf16_f32 v173, v74, v75
    v_cvt_pk_bf16_f32 v174, v76, v77
    v_cvt_pk_bf16_f32 v175, v78, v79
    v_cvt_pk_bf16_f32 v176, v80, v81
    v_cvt_pk_bf16_f32 v177, v82, v83
    v_cvt_pk_bf16_f32 v178, v84, v85
    v_cvt_pk_bf16_f32 v179, v86, v87
    v_cvt_pk_bf16_f32 v180, v88, v89
    v_cvt_pk_bf16_f32 v181, v90, v91
    v_cvt_pk_bf16_f32 v182, v92, v93
    v_cvt_pk_bf16_f32 v183, v94, v95
    v_cvt_pk_bf16_f32 v184, v96, v97
    v_cvt_pk_bf16_f32 v185, v98, v99
    v_cvt_pk_bf16_f32 v186, v100, v101
    v_cvt_pk_bf16_f32 v187, v102, v103
    v_cvt_pk_bf16_f32 v188, v104, v105
    v_cvt_pk_bf16_f32 v189, v106, v107
    v_cvt_pk_bf16_f32 v190, v108, v109
    v_cvt_pk_bf16_f32 v191, v110, v111
    ds_read_b64_tr_b16 v[204:205], v202 offset:0
    ds_read_b64_tr_b16 v[206:207], v202 offset:768
    ds_read_b64_tr_b16 v[208:209], v202 offset:64
    ds_read_b64_tr_b16 v[210:211], v202 offset:832
    ds_read_b64_tr_b16 v[212:213], v202 offset:128
    ds_read_b64_tr_b16 v[214:215], v202 offset:896
    ds_read_b64_tr_b16 v[216:217], v202 offset:3072
    ds_read_b64_tr_b16 v[218:219], v202 offset:3840
    ds_read_b64_tr_b16 v[220:221], v202 offset:3136
    ds_read_b64_tr_b16 v[222:223], v202 offset:3904
    ds_read_b64_tr_b16 v[224:225], v202 offset:3200
    ds_read_b64_tr_b16 v[226:227], v202 offset:3968
    s_waitcnt lgkmcnt(6)
    v_mfma_f32_32x32x16_bf16 a[16:31], v[204:207], v[160:163], a[16:31]
    v_mfma_f32_32x32x16_bf16 a[48:63], v[208:211], v[160:163], a[48:63]
    v_mfma_f32_32x32x16_bf16 a[80:95], v[212:215], v[160:163], a[80:95]
    ds_read_b64_tr_b16 v[204:205], v202 offset:6144
    ds_read_b64_tr_b16 v[206:207], v202 offset:6912
    ds_read_b64_tr_b16 v[208:209], v202 offset:6208
    ds_read_b64_tr_b16 v[210:211], v202 offset:6976
    ds_read_b64_tr_b16 v[212:213], v202 offset:6272
    ds_read_b64_tr_b16 v[214:215], v202 offset:7040
    s_waitcnt lgkmcnt(6)
    v_mfma_f32_32x32x16_bf16 a[16:31], v[216:219], v[164:167], a[16:31]
    v_mfma_f32_32x32x16_bf16 a[48:63], v[220:223], v[164:167], a[48:63]
    v_mfma_f32_32x32x16_bf16 a[80:95], v[224:227], v[164:167], a[80:95]
    ds_read_b64_tr_b16 v[216:217], v202 offset:9216
    ds_read_b64_tr_b16 v[218:219], v202 offset:9984
    ds_read_b64_tr_b16 v[220:221], v202 offset:9280
    ds_read_b64_tr_b16 v[222:223], v202 offset:10048
    ds_read_b64_tr_b16 v[224:225], v202 offset:9344
    ds_read_b64_tr_b16 v[226:227], v202 offset:10112
    s_waitcnt lgkmcnt(6)
    v_mfma_f32_32x32x16_bf16 a[16:31], v[204:207], v[168:171], a[16:31]
    v_mfma_f32_32x32x16_bf16 a[48:63], v[208:211], v[168:171], a[48:63]
    v_mfma_f32_32x32x16_bf16 a[80:95], v[212:215], v[168:171], a[80:95]
    ds_read_b64_tr_b16 v[204:205], v202 offset:20480
    ds_read_b64_tr_b16 v[206:207], v202 offset:21248
    ds_read_b64_tr_b16 v[208:209], v202 offset:20544
    ds_read_b64_tr_b16 v[210:211], v202 offset:21312
    ds_read_b64_tr_b16 v[212:213], v202 offset:20608
    ds_read_b64_tr_b16 v[214:215], v202 offset:21376
    s_waitcnt lgkmcnt(6)
    v_mfma_f32_32x32x16_bf16 a[16:31], v[216:219], v[172:175], a[16:31]
    v_mfma_f32_32x32x16_bf16 a[48:63], v[220:223], v[172:175], a[48:63]
    v_mfma_f32_32x32x16_bf16 a[80:95], v[224:227], v[172:175], a[80:95]
    ds_read_b64_tr_b16 v[216:217], v202 offset:23552
    ds_read_b64_tr_b16 v[218:219], v202 offset:24320
    ds_read_b64_tr_b16 v[220:221], v202 offset:23616
    ds_read_b64_tr_b16 v[222:223], v202 offset:24384
    ds_read_b64_tr_b16 v[224:225], v202 offset:23680
    ds_read_b64_tr_b16 v[226:227], v202 offset:24448
    s_waitcnt lgkmcnt(6)
    v_mfma_f32_32x32x16_bf16 a[16:31], v[204:207], v[176:179], a[16:31]
    v_mfma_f32_32x32x16_bf16 a[48:63], v[208:211], v[176:179], a[48:63]
    v_mfma_f32_32x32x16_bf16 a[80:95], v[212:215], v[176:179], a[80:95]
    ds_read_b64_tr_b16 v[204:205], v202 offset:26624
    ds_read_b64_tr_b16 v[206:207], v202 offset:27392
    ds_read_b64_tr_b16 v[208:209], v202 offset:26688
    ds_read_b64_tr_b16 v[210:211], v202 offset:27456
    ds_read_b64_tr_b16 v[212:213], v202 offset:26752
    ds_read_b64_tr_b16 v[214:215], v202 offset:27520
    s_waitcnt lgkmcnt(6)
    v_mfma_f32_32x32x16_bf16 a[16:31], v[216:219], v[180:183], a[16:31]
    v_mfma_f32_32x32x16_bf16 a[48:63], v[220:223], v[180:183], a[48:63]
    v_mfma_f32_32x32x16_bf16 a[80:95], v[224:227], v[180:183], a[80:95]
    ds_read_b64_tr_b16 v[216:217], v202 offset:29696
    ds_read_b64_tr_b16 v[218:219], v202 offset:30464
    ds_read_b64_tr_b16 v[220:221], v202 offset:29760
    ds_read_b64_tr_b16 v[222:223], v202 offset:30528
    ds_read_b64_tr_b16 v[224:225], v202 offset:29824
    ds_read_b64_tr_b16 v[226:227], v202 offset:30592
    s_waitcnt lgkmcnt(6)
    v_mfma_f32_32x32x16_bf16 a[16:31], v[204:207], v[184:187], a[16:31]
    v_mfma_f32_32x32x16_bf16 a[48:63], v[208:211], v[184:187], a[48:63]
    v_mfma_f32_32x32x16_bf16 a[80:95], v[212:215], v[184:187], a[80:95]
    s_waitcnt lgkmcnt(0)
    v_mfma_f32_32x32x16_bf16 a[16:31], v[216:219], v[188:191], a[16:31]
    v_mfma_f32_32x32x16_bf16 a[48:63], v[220:223], v[188:191], a[48:63]
    v_mfma_f32_32x32x16_bf16 a[80:95], v[224:227], v[188:191], a[80:95]
    v_and_b32 v2, 63, v0
    v_and_b32 v14, 31, v2
    v_lshrrev_b32 v12, 5, v2
    s_nop 7
    s_nop 7
    s_barrier
    v_lshlrev_b32 v7, 4, v2
    s_mul_i32 s77, s76, 24576
    v_add_u32 v13, s77, v7
    ds_write_b128 v13, a[0:3] offset:0
    ds_write_b128 v13, a[4:7] offset:1024
    ds_write_b128 v13, a[8:11] offset:2048
    ds_write_b128 v13, a[12:15] offset:3072
    ds_write_b128 v13, a[16:19] offset:4096
    ds_write_b128 v13, a[20:23] offset:5120
    ds_write_b128 v13, a[24:27] offset:6144
    ds_write_b128 v13, a[28:31] offset:7168
    ds_write_b128 v13, a[32:35] offset:8192
    ds_write_b128 v13, a[36:39] offset:9216
    ds_write_b128 v13, a[40:43] offset:10240
    ds_write_b128 v13, a[44:47] offset:11264
    ds_write_b128 v13, a[48:51] offset:12288
    ds_write_b128 v13, a[52:55] offset:13312
    ds_write_b128 v13, a[56:59] offset:14336
    ds_write_b128 v13, a[60:63] offset:15360
    ds_write_b128 v13, a[64:67] offset:16384
    ds_write_b128 v13, a[68:71] offset:17408
    ds_write_b128 v13, a[72:75] offset:18432
    ds_write_b128 v13, a[76:79] offset:19456
    ds_write_b128 v13, a[80:83] offset:20480
    ds_write_b128 v13, a[84:87] offset:21504
    ds_write_b128 v13, a[88:91] offset:22528
    ds_write_b128 v13, a[92:95] offset:23552
    s_mul_i32 s77, s76, 6144
    v_add_u32 v13, s77, v7
    v_add_u32 v7, 49152, v13
    s_waitcnt lgkmcnt(0)
    s_barrier
    ds_read_b128 v[64:67], v13 offset:0
    ds_read_b128 v[68:71], v13 offset:1024
    ds_read_b128 v[72:75], v13 offset:2048
    ds_read_b128 v[76:79], v13 offset:3072
    ds_read_b128 v[80:83], v13 offset:4096
    ds_read_b128 v[84:87], v13 offset:5120
    ds_read_b128 v[88:91], v13 offset:24576
    ds_read_b128 v[92:95], v13 offset:25600
    ds_read_b128 v[96:99], v13 offset:26624
    ds_read_b128 v[100:103], v13 offset:27648
    ds_read_b128 v[104:107], v13 offset:28672
    ds_read_b128 v[108:111], v13 offset:29696
    ds_read_b128 v[112:115], v7 offset:0
    ds_read_b128 v[116:119], v7 offset:1024
    ds_read_b128 v[120:123], v7 offset:2048
    ds_read_b128 v[124:127], v7 offset:3072
    ds_read_b128 v[128:131], v7 offset:4096
    ds_read_b128 v[132:135], v7 offset:5120
    ds_read_b128 v[136:139], v7 offset:24576
    ds_read_b128 v[140:143], v7 offset:25600
    ds_read_b128 v[144:147], v7 offset:26624
    ds_read_b128 v[148:151], v7 offset:27648
    ds_read_b128 v[152:155], v7 offset:28672
    ds_read_b128 v[156:159], v7 offset:29696
    s_mul_i32 s77, s76, 3
    s_add_u32 s77, s77, 0
    s_lshr_b32 s78, s77, 1
    s_and_b32 s79, s78, 1
    s_lshr_b32 s78, s78, 1
    s_and_b32 s77, s77, 1
    s_lshl_b32 s78, s78, 6
    s_lshl_b32 s77, s77, 5
    s_add_u32 s77, s77, s78
    s_mul_i32 s78, s16, 192
    s_add_u32 s77, s77, s78
    s_lshl_b32 s79, s79, 5
    s_lshl_b32 s78, s15, 6
    s_add_u32 s79, s79, s78
    v_add_u32 v16, s79, v14
    v_lshlrev_b32 v17, 2, v16
    v_mul_u32_u24 v16, 1152, v16
    v_lshl_add_u32 v16, v12, 4, v16
    v_add_u32 v20, s77, v16
    s_mov_b32 s77, 83886080
    s_mov_b32 s78, 88080384
    buffer_load_dwordx4 v[28:31], v20, s[68:71], s77 offen sc1
    buffer_load_dword v24, v17, s[68:71], s78 offen sc1
    s_mul_i32 s77, s76, 3
    s_add_u32 s77, s77, 1
    s_lshr_b32 s78, s77, 1
    s_and_b32 s79, s78, 1
    s_lshr_b32 s78, s78, 1
    s_and_b32 s77, s77, 1
    s_lshl_b32 s78, s78, 6
    s_lshl_b32 s77, s77, 5
    s_add_u32 s77, s77, s78
    s_mul_i32 s78, s16, 192
    s_add_u32 s77, s77, s78
    s_lshl_b32 s79, s79, 5
    s_lshl_b32 s78, s15, 6
    s_add_u32 s79, s79, s78
    v_add_u32 v16, s79, v14
    v_lshlrev_b32 v17, 2, v16
    v_mul_u32_u24 v16, 1152, v16
    v_lshl_add_u32 v16, v12, 4, v16
    v_add_u32 v21, s77, v16
    s_mov_b32 s77, 83886080
    s_mov_b32 s78, 88080384
    buffer_load_dwordx4 v[32:35], v21, s[68:71], s77 offen sc1
    buffer_load_dword v25, v17, s[68:71], s78 offen sc1
    s_mul_i32 s77, s76, 3
    s_add_u32 s77, s77, 2
    s_lshr_b32 s78, s77, 1
    s_and_b32 s79, s78, 1
    s_lshr_b32 s78, s78, 1
    s_and_b32 s77, s77, 1
    s_lshl_b32 s78, s78, 6
    s_lshl_b32 s77, s77, 5
    s_add_u32 s77, s77, s78
    s_mul_i32 s78, s16, 192
    s_add_u32 s77, s77, s78
    s_lshl_b32 s79, s79, 5
    s_lshl_b32 s78, s15, 6
    s_add_u32 s79, s79, s78
    v_add_u32 v16, s79, v14
    v_lshlrev_b32 v17, 2, v16
    v_mul_u32_u24 v16, 1152, v16
    v_lshl_add_u32 v16, v12, 4, v16
    v_add_u32 v22, s77, v16
    s_mov_b32 s77, 83886080
    s_mov_b32 s78, 88080384
    buffer_load_dwordx4 v[36:39], v22, s[68:71], s77 offen sc1
    buffer_load_dword v26, v17, s[68:71], s78 offen sc1
    s_waitcnt lgkmcnt(0)
    v_add_f32 v64, v64, v88
    v_add_f32 v112, v112, v136
    v_add_f32 v65, v65, v89
    v_add_f32 v113, v113, v137
    v_add_f32 v66, v66, v90
    v_add_f32 v114, v114, v138
    v_add_f32 v67, v67, v91
    v_add_f32 v115, v115, v139
    v_add_f32 v68, v68, v92
    v_add_f32 v116, v116, v140
    v_add_f32 v69, v69, v93
    v_add_f32 v117, v117, v141
    v_add_f32 v70, v70, v94
    v_add_f32 v118, v118, v142
    v_add_f32 v71, v71, v95
    v_add_f32 v119, v119, v143
    v_add_f32 v64, v64, v112
    v_add_f32 v65, v65, v113
    v_add_f32 v66, v66, v114
    v_add_f32 v67, v67, v115
    v_add_f32 v68, v68, v116
    v_add_f32 v69, v69, v117
    v_add_f32 v70, v70, v118
    v_add_f32 v71, v71, v119
    v_add_f32 v72, v72, v96
    v_add_f32 v120, v120, v144
    v_add_f32 v73, v73, v97
    v_add_f32 v121, v121, v145
    v_add_f32 v74, v74, v98
    v_add_f32 v122, v122, v146
    v_add_f32 v75, v75, v99
    v_add_f32 v123, v123, v147
    v_add_f32 v76, v76, v100
    v_add_f32 v124, v124, v148
    v_add_f32 v77, v77, v101
    v_add_f32 v125, v125, v149
    v_add_f32 v78, v78, v102
    v_add_f32 v126, v126, v150
    v_add_f32 v79, v79, v103
    v_add_f32 v127, v127, v151
    v_add_f32 v72, v72, v120
    v_add_f32 v73, v73, v121
    v_add_f32 v74, v74, v122
    v_add_f32 v75, v75, v123
    v_add_f32 v76, v76, v124
    v_add_f32 v77, v77, v125
    v_add_f32 v78, v78, v126
    v_add_f32 v79, v79, v127
    v_add_f32 v80, v80, v104
    v_add_f32 v128, v128, v152
    v_add_f32 v81, v81, v105
    v_add_f32 v129, v129, v153
    v_add_f32 v82, v82, v106
    v_add_f32 v130, v130, v154
    v_add_f32 v83, v83, v107
    v_add_f32 v131, v131, v155
    v_add_f32 v84, v84, v108
    v_add_f32 v132, v132, v156
    v_add_f32 v85, v85, v109
    v_add_f32 v133, v133, v157
    v_add_f32 v86, v86, v110
    v_add_f32 v134, v134, v158
    v_add_f32 v87, v87, v111
    v_add_f32 v135, v135, v159
    v_add_f32 v80, v80, v128
    v_add_f32 v81, v81, v129
    v_add_f32 v82, v82, v130
    v_add_f32 v83, v83, v131
    v_add_f32 v84, v84, v132
    v_add_f32 v85, v85, v133
    v_add_f32 v86, v86, v134
    v_add_f32 v87, v87, v135
    s_mul_i32 s77, s18, 196608
    s_mul_i32 s78, s76, 6144
    s_add_u32 s77, s77, s78
    s_add_u32 s77, s77, 92274688
    s_mul_i32 s78, s17, 24576
    s_add_u32 s78, s78, s77
    s_add_u32 s79, s78, 4096
    v_lshlrev_b32 v7, 4, v2
    buffer_store_dwordx4 v[64:67], v7, s[68:71], s78 offen offset:0 sc1
    buffer_store_dwordx4 v[68:71], v7, s[68:71], s78 offen offset:1024 sc1
    buffer_store_dwordx4 v[72:75], v7, s[68:71], s78 offen offset:2048 sc1
    buffer_store_dwordx4 v[76:79], v7, s[68:71], s78 offen offset:3072 sc1
    buffer_store_dwordx4 v[80:83], v7, s[68:71], s79 offen offset:0 sc1
    buffer_store_dwordx4 v[84:87], v7, s[68:71], s79 offen offset:1024 sc1
    s_waitcnt vmcnt(0)
    s_barrier
    s_lshl_b32 s12, s18, 7
    s_add_u32 s12, s12, 4096
    v_mov_b32 v200, s12
    v_mov_b32 v201, 1
    v_mov_b32 v203, 0
    v_cmp_eq_u32 vcc, 0, v0
    s_nop 0
    s_and_saveexec_b64 s[6:7], vcc
    s_cbranch_execz arv_12
    global_atomic_add v202, v200, v201, s[26:27] sc0
    s_waitcnt vmcnt(0)
    ds_write_b32 v203, v202
    s_waitcnt lgkmcnt(0)
arv_12:
    s_mov_b64 exec, -1
    s_barrier
    ds_read_b32 v202, v203
    s_waitcnt lgkmcnt(0)
    v_readfirstlane_b32 s12, v202
    s_nop 0
    s_cmp_lg_u32 s12, 7
    s_cbranch_scc1 L_fetch
    s_add_u32 s79, s77, 4096
    buffer_load_dwordx4 v[64:67], v7, s[68:71], s77 offen offset:0 sc1
    buffer_load_dwordx4 v[68:71], v7, s[68:71], s77 offen offset:1024 sc1
    buffer_load_dwordx4 v[72:75], v7, s[68:71], s77 offen offset:2048 sc1
    buffer_load_dwordx4 v[76:79], v7, s[68:71], s77 offen offset:3072 sc1
    buffer_load_dwordx4 v[80:83], v7, s[68:71], s79 offen offset:0 sc1
    buffer_load_dwordx4 v[84:87], v7, s[68:71], s79 offen offset:1024 sc1
    s_add_u32 s77, s77, 24576
    s_add_u32 s79, s77, 4096
    buffer_load_dwordx4 v[88:91], v7, s[68:71], s77 offen offset:0 sc1
    buffer_load_dwordx4 v[92:95], v7, s[68:71], s77 offen offset:1024 sc1
    buffer_load_dwordx4 v[96:99], v7, s[68:71], s77 offen offset:2048 sc1
    buffer_load_dwordx4 v[100:103], v7, s[68:71], s77 offen offset:3072 sc1
    buffer_load_dwordx4 v[104:107], v7, s[68:71], s79 offen offset:0 sc1
    buffer_load_dwordx4 v[108:111], v7, s[68:71], s79 offen offset:1024 sc1
    s_add_u32 s77, s77, 24576
    s_add_u32 s79, s77, 4096
    buffer_load_dwordx4 v[112:115], v7, s[68:71], s77 offen offset:0 sc1
    buffer_load_dwordx4 v[116:119], v7, s[68:71], s77 offen offset:1024 sc1
    buffer_load_dwordx4 v[120:123], v7, s[68:71], s77 offen offset:2048 sc1
    buffer_load_dwordx4 v[124:127], v7, s[68:71], s77 offen offset:3072 sc1
    buffer_load_dwordx4 v[128:131], v7, s[68:71], s79 offen offset:0 sc1
    buffer_load_dwordx4 v[132:135], v7, s[68:71], s79 offen offset:1024 sc1
    s_add_u32 s77, s77, 24576
    s_add_u32 s79, s77, 4096
    buffer_load_dwordx4 v[136:139], v7, s[68:71], s77 offen offset:0 sc1
    buffer_load_dwordx4 v[140:143], v7, s[68:71], s77 offen offset:1024 sc1
    buffer_load_dwordx4 v[144:147], v7, s[68:71], s77 offen offset:2048 sc1
    buffer_load_dwordx4 v[148:151], v7, s[68:71], s77 offen offset:3072 sc1
    buffer_load_dwordx4 v[152:155], v7, s[68:71], s79 offen offset:0 sc1
    buffer_load_dwordx4 v[156:159], v7, s[68:71], s79 offen offset:1024 sc1
    s_add_u32 s77, s77, 24576
    s_add_u32 s79, s77, 4096
    buffer_load_dwordx4 v[160:163], v7, s[68:71], s77 offen offset:0 sc1
    buffer_load_dwordx4 v[164:167], v7, s[68:71], s77 offen offset:1024 sc1
    buffer_load_dwordx4 v[168:171], v7, s[68:71], s77 offen offset:2048 sc1
    buffer_load_dwordx4 v[172:175], v7, s[68:71], s77 offen offset:3072 sc1
    buffer_load_dwordx4 v[176:179], v7, s[68:71], s79 offen offset:0 sc1
    buffer_load_dwordx4 v[180:183], v7, s[68:71], s79 offen offset:1024 sc1
    s_add_u32 s77, s77, 24576
    s_add_u32 s79, s77, 4096
    buffer_load_dwordx4 v[184:187], v7, s[68:71], s77 offen offset:0 sc1
    buffer_load_dwordx4 v[188:191], v7, s[68:71], s77 offen offset:1024 sc1
    buffer_load_dwordx4 v[192:195], v7, s[68:71], s77 offen offset:2048 sc1
    buffer_load_dwordx4 v[196:199], v7, s[68:71], s77 offen offset:3072 sc1
    buffer_load_dwordx4 v[200:203], v7, s[68:71], s79 offen offset:0 sc1
    buffer_load_dwordx4 v[204:207], v7, s[68:71], s79 offen offset:1024 sc1
    s_add_u32 s77, s77, 24576
    s_add_u32 s79, s77, 4096
    buffer_load_dwordx4 v[208:211], v7, s[68:71], s77 offen offset:0 sc1
    buffer_load_dwordx4 v[212:215], v7, s[68:71], s77 offen offset:1024 sc1
    buffer_load_dwordx4 v[216:219], v7, s[68:71], s77 offen offset:2048 sc1
    buffer_load_dwordx4 v[220:223], v7, s[68:71], s77 offen offset:3072 sc1
    buffer_load_dwordx4 v[224:227], v7, s[68:71], s79 offen offset:0 sc1
    buffer_load_dwordx4 v[228:231], v7, s[68:71], s79 offen offset:1024 sc1
    s_add_u32 s77, s77, 24576
    s_add_u32 s79, s77, 4096
    buffer_load_dwordx4 v[232:235], v7, s[68:71], s77 offen offset:0 sc1
    buffer_load_dwordx4 v[236:239], v7, s[68:71], s77 offen offset:1024 sc1
    buffer_load_dwordx4 v[240:243], v7, s[68:71], s77 offen offset:2048 sc1
    buffer_load_dwordx4 v[244:247], v7, s[68:71], s77 offen offset:3072 sc1
    buffer_load_dwordx4 v[248:251], v7, s[68:71], s79 offen offset:0 sc1
    buffer_load_dwordx4 v[252:255], v7, s[68:71], s79 offen offset:1024 sc1
    s_add_u32 s77, s77, 24576
    s_waitcnt vmcnt(0)
    v_add_f32 v64, v64, v88
    v_add_f32 v65, v65, v89
    v_add_f32 v66, v66, v90
    v_add_f32 v67, v67, v91
    v_add_f32 v68, v68, v92
    v_add_f32 v69, v69, v93
    v_add_f32 v70, v70, v94
    v_add_f32 v71, v71, v95
    v_add_f32 v72, v72, v96
    v_add_f32 v73, v73, v97
    v_add_f32 v74, v74, v98
    v_add_f32 v75, v75, v99
    v_add_f32 v76, v76, v100
    v_add_f32 v77, v77, v101
    v_add_f32 v78, v78, v102
    v_add_f32 v79, v79, v103
    v_add_f32 v80, v80, v104
    v_add_f32 v81, v81, v105
    v_add_f32 v82, v82, v106
    v_add_f32 v83, v83, v107
    v_add_f32 v84, v84, v108
    v_add_f32 v85, v85, v109
    v_add_f32 v86, v86, v110
    v_add_f32 v87, v87, v111
    v_add_f32 v64, v64, v112
    v_add_f32 v65, v65, v113
    v_add_f32 v66, v66, v114
    v_add_f32 v67, v67, v115
    v_add_f32 v68, v68, v116
    v_add_f32 v69, v69, v117
    v_add_f32 v70, v70, v118
    v_add_f32 v71, v71, v119
    v_add_f32 v72, v72, v120
    v_add_f32 v73, v73, v121
    v_add_f32 v74, v74, v122
    v_add_f32 v75, v75, v123
    v_add_f32 v76, v76, v124
    v_add_f32 v77, v77, v125
    v_add_f32 v78, v78, v126
    v_add_f32 v79, v79, v127
    v_add_f32 v80, v80, v128
    v_add_f32 v81, v81, v129
    v_add_f32 v82, v82, v130
    v_add_f32 v83, v83, v131
    v_add_f32 v84, v84, v132
    v_add_f32 v85, v85, v133
    v_add_f32 v86, v86, v134
    v_add_f32 v87, v87, v135
    v_add_f32 v64, v64, v136
    v_add_f32 v65, v65, v137
    v_add_f32 v66, v66, v138
    v_add_f32 v67, v67, v139
    v_add_f32 v68, v68, v140
    v_add_f32 v69, v69, v141
    v_add_f32 v70, v70, v142
    v_add_f32 v71, v71, v143
    v_add_f32 v72, v72, v144
    v_add_f32 v73, v73, v145
    v_add_f32 v74, v74, v146
    v_add_f32 v75, v75, v147
    v_add_f32 v76, v76, v148
    v_add_f32 v77, v77, v149
    v_add_f32 v78, v78, v150
    v_add_f32 v79, v79, v151
    v_add_f32 v80, v80, v152
    v_add_f32 v81, v81, v153
    v_add_f32 v82, v82, v154
    v_add_f32 v83, v83, v155
    v_add_f32 v84, v84, v156
    v_add_f32 v85, v85, v157
    v_add_f32 v86, v86, v158
    v_add_f32 v87, v87, v159
    v_add_f32 v64, v64, v160
    v_add_f32 v65, v65, v161
    v_add_f32 v66, v66, v162
    v_add_f32 v67, v67, v163
    v_add_f32 v68, v68, v164
    v_add_f32 v69, v69, v165
    v_add_f32 v70, v70, v166
    v_add_f32 v71, v71, v167
    v_add_f32 v72, v72, v168
    v_add_f32 v73, v73, v169
    v_add_f32 v74, v74, v170
    v_add_f32 v75, v75, v171
    v_add_f32 v76, v76, v172
    v_add_f32 v77, v77, v173
    v_add_f32 v78, v78, v174
    v_add_f32 v79, v79, v175
    v_add_f32 v80, v80, v176
    v_add_f32 v81, v81, v177
    v_add_f32 v82, v82, v178
    v_add_f32 v83, v83, v179
    v_add_f32 v84, v84, v180
    v_add_f32 v85, v85, v181
    v_add_f32 v86, v86, v182
    v_add_f32 v87, v87, v183
    v_add_f32 v64, v64, v184
    v_add_f32 v65, v65, v185
    v_add_f32 v66, v66, v186
    v_add_f32 v67, v67, v187
    v_add_f32 v68, v68, v188
    v_add_f32 v69, v69, v189
    v_add_f32 v70, v70, v190
    v_add_f32 v71, v71, v191
    v_add_f32 v72, v72, v192
    v_add_f32 v73, v73, v193
    v_add_f32 v74, v74, v194
    v_add_f32 v75, v75, v195
    v_add_f32 v76, v76, v196
    v_add_f32 v77, v77, v197
    v_add_f32 v78, v78, v198
    v_add_f32 v79, v79, v199
    v_add_f32 v80, v80, v200
    v_add_f32 v81, v81, v201
    v_add_f32 v82, v82, v202
    v_add_f32 v83, v83, v203
    v_add_f32 v84, v84, v204
    v_add_f32 v85, v85, v205
    v_add_f32 v86, v86, v206
    v_add_f32 v87, v87, v207
    v_add_f32 v64, v64, v208
    v_add_f32 v65, v65, v209
    v_add_f32 v66, v66, v210
    v_add_f32 v67, v67, v211
    v_add_f32 v68, v68, v212
    v_add_f32 v69, v69, v213
    v_add_f32 v70, v70, v214
    v_add_f32 v71, v71, v215
    v_add_f32 v72, v72, v216
    v_add_f32 v73, v73, v217
    v_add_f32 v74, v74, v218
    v_add_f32 v75, v75, v219
    v_add_f32 v76, v76, v220
    v_add_f32 v77, v77, v221
    v_add_f32 v78, v78, v222
    v_add_f32 v79, v79, v223
    v_add_f32 v80, v80, v224
    v_add_f32 v81, v81, v225
    v_add_f32 v82, v82, v226
    v_add_f32 v83, v83, v227
    v_add_f32 v84, v84, v228
    v_add_f32 v85, v85, v229
    v_add_f32 v86, v86, v230
    v_add_f32 v87, v87, v231
    v_add_f32 v64, v64, v232
    v_add_f32 v65, v65, v233
    v_add_f32 v66, v66, v234
    v_add_f32 v67, v67, v235
    v_add_f32 v68, v68, v236
    v_add_f32 v69, v69, v237
    v_add_f32 v70, v70, v238
    v_add_f32 v71, v71, v239
    v_add_f32 v72, v72, v240
    v_add_f32 v73, v73, v241
    v_add_f32 v74, v74, v242
    v_add_f32 v75, v75, v243
    v_add_f32 v76, v76, v244
    v_add_f32 v77, v77, v245
    v_add_f32 v78, v78, v246
    v_add_f32 v79, v79, v247
    v_add_f32 v80, v80, v248
    v_add_f32 v81, v81, v249
    v_add_f32 v82, v82, v250
    v_add_f32 v83, v83, v251
    v_add_f32 v84, v84, v252
    v_add_f32 v85, v85, v253
    v_add_f32 v86, v86, v254
    v_add_f32 v87, v87, v255
    s_waitcnt vmcnt(0)
    v_sub_f32 v27, 1.0, v24
    v_cvt_pk_bf16_f32 v27, v27, v27
    v_lshlrev_b32 v27, 16, v27
    v_cvt_pk_bf16_f32 v40, v64, v65
    v_lshlrev_b32 v41, 16, v40
    v_and_b32 v42, 0xffff0000, v40
    v_mul_f32 v41, v41, v27
    v_mul_f32 v42, v42, v27
    v_cvt_pk_bf16_f32 v40, v41, v42
    v_lshlrev_b32 v43, 16, v28
    v_and_b32 v44, 0xffff0000, v28
    v_mul_f32 v43, v43, v24
    v_mul_f32 v44, v44, v24
    v_cvt_pk_bf16_f32 v45, v43, v44
    v_lshlrev_b32 v41, 16, v40
    v_and_b32 v42, 0xffff0000, v40
    v_lshlrev_b32 v43, 16, v45
    v_and_b32 v44, 0xffff0000, v45
    v_add_f32 v41, v41, v43
    v_add_f32 v42, v42, v44
    v_cvt_pk_bf16_f32 v48, v41, v42
    v_cvt_pk_bf16_f32 v40, v66, v67
    v_lshlrev_b32 v41, 16, v40
    v_and_b32 v42, 0xffff0000, v40
    v_mul_f32 v41, v41, v27
    v_mul_f32 v42, v42, v27
    v_cvt_pk_bf16_f32 v40, v41, v42
    v_lshlrev_b32 v43, 16, v29
    v_and_b32 v44, 0xffff0000, v29
    v_mul_f32 v43, v43, v24
    v_mul_f32 v44, v44, v24
    v_cvt_pk_bf16_f32 v45, v43, v44
    v_lshlrev_b32 v41, 16, v40
    v_and_b32 v42, 0xffff0000, v40
    v_lshlrev_b32 v43, 16, v45
    v_and_b32 v44, 0xffff0000, v45
    v_add_f32 v41, v41, v43
    v_add_f32 v42, v42, v44
    v_cvt_pk_bf16_f32 v49, v41, v42
    v_cvt_pk_bf16_f32 v40, v68, v69
    v_lshlrev_b32 v41, 16, v40
    v_and_b32 v42, 0xffff0000, v40
    v_mul_f32 v41, v41, v27
    v_mul_f32 v42, v42, v27
    v_cvt_pk_bf16_f32 v40, v41, v42
    v_lshlrev_b32 v43, 16, v30
    v_and_b32 v44, 0xffff0000, v30
    v_mul_f32 v43, v43, v24
    v_mul_f32 v44, v44, v24
    v_cvt_pk_bf16_f32 v45, v43, v44
    v_lshlrev_b32 v41, 16, v40
    v_and_b32 v42, 0xffff0000, v40
    v_lshlrev_b32 v43, 16, v45
    v_and_b32 v44, 0xffff0000, v45
    v_add_f32 v41, v41, v43
    v_add_f32 v42, v42, v44
    v_cvt_pk_bf16_f32 v50, v41, v42
    v_cvt_pk_bf16_f32 v40, v70, v71
    v_lshlrev_b32 v41, 16, v40
    v_and_b32 v42, 0xffff0000, v40
    v_mul_f32 v41, v41, v27
    v_mul_f32 v42, v42, v27
    v_cvt_pk_bf16_f32 v40, v41, v42
    v_lshlrev_b32 v43, 16, v31
    v_and_b32 v44, 0xffff0000, v31
    v_mul_f32 v43, v43, v24
    v_mul_f32 v44, v44, v24
    v_cvt_pk_bf16_f32 v45, v43, v44
    v_lshlrev_b32 v41, 16, v40
    v_and_b32 v42, 0xffff0000, v40
    v_lshlrev_b32 v43, 16, v45
    v_and_b32 v44, 0xffff0000, v45
    v_add_f32 v41, v41, v43
    v_add_f32 v42, v42, v44
    v_cvt_pk_bf16_f32 v51, v41, v42
    buffer_store_dwordx4 v[48:51], v20, s[72:75], 0 offen
    v_sub_f32 v27, 1.0, v25
    v_cvt_pk_bf16_f32 v27, v27, v27
    v_lshlrev_b32 v27, 16, v27
    v_cvt_pk_bf16_f32 v40, v72, v73
    v_lshlrev_b32 v41, 16, v40
    v_and_b32 v42, 0xffff0000, v40
    v_mul_f32 v41, v41, v27
    v_mul_f32 v42, v42, v27
    v_cvt_pk_bf16_f32 v40, v41, v42
    v_lshlrev_b32 v43, 16, v32
    v_and_b32 v44, 0xffff0000, v32
    v_mul_f32 v43, v43, v25
    v_mul_f32 v44, v44, v25
    v_cvt_pk_bf16_f32 v45, v43, v44
    v_lshlrev_b32 v41, 16, v40
    v_and_b32 v42, 0xffff0000, v40
    v_lshlrev_b32 v43, 16, v45
    v_and_b32 v44, 0xffff0000, v45
    v_add_f32 v41, v41, v43
    v_add_f32 v42, v42, v44
    v_cvt_pk_bf16_f32 v52, v41, v42
    v_cvt_pk_bf16_f32 v40, v74, v75
    v_lshlrev_b32 v41, 16, v40
    v_and_b32 v42, 0xffff0000, v40
    v_mul_f32 v41, v41, v27
    v_mul_f32 v42, v42, v27
    v_cvt_pk_bf16_f32 v40, v41, v42
    v_lshlrev_b32 v43, 16, v33
    v_and_b32 v44, 0xffff0000, v33
    v_mul_f32 v43, v43, v25
    v_mul_f32 v44, v44, v25
    v_cvt_pk_bf16_f32 v45, v43, v44
    v_lshlrev_b32 v41, 16, v40
    v_and_b32 v42, 0xffff0000, v40
    v_lshlrev_b32 v43, 16, v45
    v_and_b32 v44, 0xffff0000, v45
    v_add_f32 v41, v41, v43
    v_add_f32 v42, v42, v44
    v_cvt_pk_bf16_f32 v53, v41, v42
    v_cvt_pk_bf16_f32 v40, v76, v77
    v_lshlrev_b32 v41, 16, v40
    v_and_b32 v42, 0xffff0000, v40
    v_mul_f32 v41, v41, v27
    v_mul_f32 v42, v42, v27
    v_cvt_pk_bf16_f32 v40, v41, v42
    v_lshlrev_b32 v43, 16, v34
    v_and_b32 v44, 0xffff0000, v34
    v_mul_f32 v43, v43, v25
    v_mul_f32 v44, v44, v25
    v_cvt_pk_bf16_f32 v45, v43, v44
    v_lshlrev_b32 v41, 16, v40
    v_and_b32 v42, 0xffff0000, v40
    v_lshlrev_b32 v43, 16, v45
    v_and_b32 v44, 0xffff0000, v45
    v_add_f32 v41, v41, v43
    v_add_f32 v42, v42, v44
    v_cvt_pk_bf16_f32 v54, v41, v42
    v_cvt_pk_bf16_f32 v40, v78, v79
    v_lshlrev_b32 v41, 16, v40
    v_and_b32 v42, 0xffff0000, v40
    v_mul_f32 v41, v41, v27
    v_mul_f32 v42, v42, v27
    v_cvt_pk_bf16_f32 v40, v41, v42
    v_lshlrev_b32 v43, 16, v35
    v_and_b32 v44, 0xffff0000, v35
    v_mul_f32 v43, v43, v25
    v_mul_f32 v44, v44, v25
    v_cvt_pk_bf16_f32 v45, v43, v44
    v_lshlrev_b32 v41, 16, v40
    v_and_b32 v42, 0xffff0000, v40
    v_lshlrev_b32 v43, 16, v45
    v_and_b32 v44, 0xffff0000, v45
    v_add_f32 v41, v41, v43
    v_add_f32 v42, v42, v44
    v_cvt_pk_bf16_f32 v55, v41, v42
    buffer_store_dwordx4 v[52:55], v21, s[72:75], 0 offen
    v_sub_f32 v27, 1.0, v26
    v_cvt_pk_bf16_f32 v27, v27, v27
    v_lshlrev_b32 v27, 16, v27
    v_cvt_pk_bf16_f32 v40, v80, v81
    v_lshlrev_b32 v41, 16, v40
    v_and_b32 v42, 0xffff0000, v40
    v_mul_f32 v41, v41, v27
    v_mul_f32 v42, v42, v27
    v_cvt_pk_bf16_f32 v40, v41, v42
    v_lshlrev_b32 v43, 16, v36
    v_and_b32 v44, 0xffff0000, v36
    v_mul_f32 v43, v43, v26
    v_mul_f32 v44, v44, v26
    v_cvt_pk_bf16_f32 v45, v43, v44
    v_lshlrev_b32 v41, 16, v40
    v_and_b32 v42, 0xffff0000, v40
    v_lshlrev_b32 v43, 16, v45
    v_and_b32 v44, 0xffff0000, v45
    v_add_f32 v41, v41, v43
    v_add_f32 v42, v42, v44
    v_cvt_pk_bf16_f32 v56, v41, v42
    v_cvt_pk_bf16_f32 v40, v82, v83
    v_lshlrev_b32 v41, 16, v40
    v_and_b32 v42, 0xffff0000, v40
    v_mul_f32 v41, v41, v27
    v_mul_f32 v42, v42, v27
    v_cvt_pk_bf16_f32 v40, v41, v42
    v_lshlrev_b32 v43, 16, v37
    v_and_b32 v44, 0xffff0000, v37
    v_mul_f32 v43, v43, v26
    v_mul_f32 v44, v44, v26
    v_cvt_pk_bf16_f32 v45, v43, v44
    v_lshlrev_b32 v41, 16, v40
    v_and_b32 v42, 0xffff0000, v40
    v_lshlrev_b32 v43, 16, v45
    v_and_b32 v44, 0xffff0000, v45
    v_add_f32 v41, v41, v43
    v_add_f32 v42, v42, v44
    v_cvt_pk_bf16_f32 v57, v41, v42
    v_cvt_pk_bf16_f32 v40, v84, v85
    v_lshlrev_b32 v41, 16, v40
    v_and_b32 v42, 0xffff0000, v40
    v_mul_f32 v41, v41, v27
    v_mul_f32 v42, v42, v27
    v_cvt_pk_bf16_f32 v40, v41, v42
    v_lshlrev_b32 v43, 16, v38
    v_and_b32 v44, 0xffff0000, v38
    v_mul_f32 v43, v43, v26
    v_mul_f32 v44, v44, v26
    v_cvt_pk_bf16_f32 v45, v43, v44
    v_lshlrev_b32 v41, 16, v40
    v_and_b32 v42, 0xffff0000, v40
    v_lshlrev_b32 v43, 16, v45
    v_and_b32 v44, 0xffff0000, v45
    v_add_f32 v41, v41, v43
    v_add_f32 v42, v42, v44
    v_cvt_pk_bf16_f32 v58, v41, v42
    v_cvt_pk_bf16_f32 v40, v86, v87
    v_lshlrev_b32 v41, 16, v40
    v_and_b32 v42, 0xffff0000, v40
    v_mul_f32 v41, v41, v27
    v_mul_f32 v42, v42, v27
    v_cvt_pk_bf16_f32 v40, v41, v42
    v_lshlrev_b32 v43, 16, v39
    v_and_b32 v44, 0xffff0000, v39
    v_mul_f32 v43, v43, v26
    v_mul_f32 v44, v44, v26
    v_cvt_pk_bf16_f32 v45, v43, v44
    v_lshlrev_b32 v41, 16, v40
    v_and_b32 v42, 0xffff0000, v40
    v_lshlrev_b32 v43, 16, v45
    v_and_b32 v44, 0xffff0000, v45
    v_add_f32 v41, v41, v43
    v_add_f32 v42, v42, v44
    v_cvt_pk_bf16_f32 v59, v41, v42
    buffer_store_dwordx4 v[56:59], v22, s[72:75], 0 offen
    s_branch L_fetch
L_chain:
    s_mov_b32 s21, s23
    s_load_dwordx2 s[4:5], s[0:1], 88
    s_load_dwordx2 s[6:7], s[0:1], 96
    s_load_dwordx2 s[8:9], s[0:1], 104
    s_load_dwordx2 s[10:11], s[0:1], 112
    s_load_dwordx2 s[12:13], s[0:1], 80
    s_load_dwordx2 s[14:15], s[0:1], 152
    s_load_dwordx2 s[16:17], s[0:1], 144
    v_lshrrev_b32 v13, 6, v0
    v_and_b32 v14, 63, v0
    v_readfirstlane_b32 s19, v13
    s_waitcnt lgkmcnt(0)
    s_mov_b32 s24, s14
    s_mov_b32 s25, s15
    s_mov_b32 s26, 268435456
    s_mov_b32 s27, 0x00020000
    v_and_b32 v20, 15, v14
    v_lshrrev_b32 v21, 4, v14
    v_lshlrev_b32 v0, 4, v14
    v_lshlrev_b32 v6, 3, v14
    s_lshl_b32 s48, s19, 10
    v_add_u32 v1, s48, v0
    v_lshlrev_b32 v22, 7, v21
    v_lshl_add_u32 v3, v20, 2, v22
    s_mul_i32 s73, s19, 1536
    s_add_u32 s73, s73, 9216
    s_lshl_b32 s74, s19, 9
    s_add_u32 s74, s74, 6144
    v_lshrrev_b32 v23, 1, v20
    v_lshlrev_b32 v22, 6, v23
    v_lshl_add_u32 v4, v21, 4, v22
    v_and_b32 v25, 7, v20
    v_lshlrev_b32 v22, 6, v25
    v_lshl_add_u32 v22, v21, 4, v22
    v_add_u32 v5, s73, v22
    s_lshl_b32 s48, s19, 13
    s_add_u32 s48, s48, 16384
    s_mov_b32 s41, s48
    v_lshrrev_b32 v2, 2, v1
    s_lshl_b32 s49, s18, 6
    v_lshrrev_b32 v22, 3, v14
    v_lshlrev_b32 v22, 11, v22
    v_and_b32 v25, 7, v14
    v_lshl_add_u32 v22, v25, 3, v22
    v_add_u32 v7, s49, v22
    s_lshl_b32 s48, s18, 13
    s_lshl_b32 s49, s19, 11
    s_add_u32 s48, s48, s49
    v_add_u32 v9, s48, v0
    s_mov_b32 s44, s48
    v_lshrrev_b32 v25, 1, v21
    v_lshl_add_u32 v22, v25, 4, v20
    v_lshlrev_b32 v22, 4, v22
    v_add_u32 v10, s48, v22
    v_and_b32 v22, 1, v14
    v_cmp_eq_u32 s[28:29], 1, v22
    v_and_b32 v22, 1, v21
    v_cmp_eq_u32 s[30:31], 1, v22
    v_mov_b32 v22, 0x4444
    v_mov_b32 v23, 0xeeee
    v_cndmask_b32 v11, v22, v23, s[28:29]
    v_cmp_lt_u32 s[32:33], 1, v21
    v_mov_b32 v22, 0x40000000
    v_cndmask_b32 v10, v10, v22, s[30:31]
    s_cmp_lt_u32 s18, 8
    s_cselect_b32 s53, 1, 0
    s_cmp_ge_u32 s19, 2
    s_cselect_b32 s71, s53, 0
    s_lshl_b32 s51, s18, 2
    s_add_u32 s51, s51, s19
    s_add_u32 s51, s51, 16
    s_lshl_b32 s54, s18, 1
    s_add_u32 s54, s54, s19
    s_add_u32 s55, s54, 32
    s_cmp_lt_u32 s18, 8
    s_cselect_b32 s51, s55, s51
    s_sub_u32 s55, s54, 2
    s_cmp_lg_u32 s71, 0
    s_cselect_b32 s51, s55, s51
    s_lshr_b32 s48, s51, 3
    s_and_b32 s49, s51, 6
    s_and_b32 s50, s51, 1
    s_lshl_b32 s50, s50, 3
    s_lshl_b32 s52, s48, 9
    s_lshl_b32 s53, s49, 6
    s_add_u32 s52, s52, s53
    s_lshl_b32 s53, s50, 2
    s_add_u32 s52, s52, s53
    v_and_b32 v22, 1, v21
    v_lshlrev_b32 v22, 6, v22
    v_and_b32 v23, 3, v14
    v_lshrrev_b32 v25, 1, v21
    v_lshl_add_u32 v39, v23, 1, v25
    v_lshl_add_u32 v22, v39, 2, v22
    v_mov_b32 v8, v22
    s_mov_b32 s69, s52
    s_lshl_b32 s45, s51, 11
    s_add_u32 s45, s45, 59768832
    s_add_u32 s56, s51, 16
    s_lshl_b32 s46, s56, 11
    s_add_u32 s46, s46, 59768832
    s_lshr_b32 s57, s56, 3
    s_and_b32 s58, s56, 6
    s_and_b32 s59, s56, 1
    s_lshl_b32 s59, s59, 3
    s_lshl_b32 s70, s57, 9
    s_lshl_b32 s53, s58, 6
    s_add_u32 s70, s70, s53
    s_lshl_b32 s53, s59, 2
    s_add_u32 s70, s70, s53
    s_mov_b32 s35, 0x3e0293ee
    s_lshl_b32 s53, s19, 14
    s_add_u32 s64, s53, 59768832
    s_add_u32 s65, s64, 65536
    s_add_u32 s66, s64, 131072
    s_add_u32 s67, s64, 196608
    s_add_u32 s68, s64, 262144
    s_mul_i32 s60, s18, 147456
    s_add_u32 s62, s10, s60
    s_addc_u32 s63, s11, 0
    s_lshl_b32 s61, s19, 10
    s_add_u32 s61, s61, 16384
    v_mov_b32 v28, v1
    v_and_b32 v22, 1, v21
    v_add_u32 v22, s49, v22
    v_mul_u32_u24 v22, 1152, v22
    v_add_u32 v23, s50, v39
    v_lshl_add_u32 v22, v23, 1, v22
    s_lshl_b32 s52, s48, 6
    v_add_u32 v22, s52, v22
    global_load_ushort v33, v22, s[12:13]
    global_load_ushort v35, v22, s[12:13] offset:32
    s_min_u32 s57, s57, 17
    v_and_b32 v24, 1, v21
    v_add_u32 v24, s58, v24
    v_mul_u32_u24 v24, 1152, v24
    v_add_u32 v23, s59, v39
    v_lshl_add_u32 v24, v23, 1, v24
    s_lshl_b32 s52, s57, 6
    v_add_u32 v24, s52, v24
    global_load_ushort v34, v24, s[12:13]
    global_load_ushort v36, v24, s[12:13] offset:32
    v_mov_b32 v40, 1
    v_mov_b32 v41, 1
    v_mov_b32 v42, 1
    v_mov_b32 v43, 1
    v_mov_b32 v44, -1
    v_mov_b32 v45, -1
    v_mov_b32 v46, -1
    v_mov_b32 v47, -1
    s_lshl_b32 s53, s18, 2
    s_add_u32 s53, s53, s19
    s_mul_i32 s53, s53, 4608
    s_add_u32 s53, s53, 58729472
    s_add_u32 s54, s53, 3584
    buffer_store_dwordx4 v[40:43], v0, s[24:27], s45 offen offset:0 sc1
    buffer_store_dwordx4 v[44:47], v0, s[24:27], s53 offen offset:0 sc1
    buffer_store_dwordx4 v[40:43], v0, s[24:27], s45 offen offset:1024 sc1
    buffer_store_dwordx4 v[44:47], v0, s[24:27], s53 offen offset:1024 sc1
    buffer_store_dwordx4 v[40:43], v0, s[24:27], s45 offen offset:0 sc1
    buffer_store_dwordx4 v[44:47], v0, s[24:27], s53 offen offset:2048 sc1
    buffer_store_dwordx4 v[40:43], v0, s[24:27], s45 offen offset:1024 sc1
    buffer_store_dwordx4 v[44:47], v0, s[24:27], s53 offen offset:3072 sc1
    buffer_store_dwordx4 v[44:47], v0, s[24:27], s54 offen sc1
    s_cmp_eq_u32 s71, 0
    s_cbranch_scc1 no2_13
    buffer_store_dwordx4 v[40:43], v0, s[24:27], s46 offen offset:0 sc1
    buffer_store_dwordx4 v[40:43], v0, s[24:27], s46 offen offset:1024 sc1
    buffer_store_dwordx4 v[40:43], v0, s[24:27], s46 offen offset:0 sc1
    buffer_store_dwordx4 v[40:43], v0, s[24:27], s46 offen offset:1024 sc1
    s_waitcnt vmcnt(13)
    v_lshl_or_b32 v34, v36, 16, v34
    v_min_u32 v34, 0xfffffffe, v34
    s_add_u32 s53, s70, 58720256
    buffer_store_dword v34, v8, s[24:27], s53 offen sc1
no2_13:
    s_waitcnt vmcnt(9)
    v_lshl_or_b32 v33, v35, 16, v33
    v_min_u32 v33, 0xfffffffe, v33
    s_add_u32 s53, s69, 58720256
    buffer_store_dword v33, v8, s[24:27], s53 offen sc1
    s_mov_b32 m0, s61
    s_add_u32 s61, s61, 4096
    global_load_lds_dwordx4 v28, s[62:63]
    v_add_u32 v28, 4096, v28
    s_mov_b32 m0, s61
    s_add_u32 s61, s61, 4096
    global_load_lds_dwordx4 v28, s[62:63]
    v_add_u32 v28, 4096, v28
    s_mov_b32 m0, s61
    s_add_u32 s61, s61, 4096
    global_load_lds_dwordx4 v28, s[62:63]
    v_add_u32 v28, 4096, v28
    s_mov_b32 m0, s61
    s_add_u32 s61, s61, 4096
    global_load_lds_dwordx4 v28, s[62:63]
    v_add_u32 v28, 4096, v28
    s_mov_b32 m0, s61
    s_add_u32 s61, s61, 4096
    global_load_lds_dwordx4 v28, s[62:63]
    v_add_u32 v28, 4096, v28
    s_mov_b32 m0, s61
    s_add_u32 s61, s61, 4096
    global_load_lds_dwordx4 v28, s[62:63]
    v_add_u32 v28, 4096, v28
    s_mov_b32 m0, s61
    s_add_u32 s61, s61, 4096
    global_load_lds_dwordx4 v28, s[62:63]
    v_add_u32 v28, 4096, v28
    s_mov_b32 m0, s61
    s_add_u32 s61, s61, 4096
    global_load_lds_dwordx4 v28, s[62:63]
    v_add_u32 v28, 4096, v28
    s_mov_b32 m0, s61
    s_add_u32 s61, s61, 4096
    global_load_lds_dwordx4 v28, s[62:63]
    v_add_u32 v28, 4096, v28
    s_mov_b32 m0, s61
    s_add_u32 s61, s61, 4096
    global_load_lds_dwordx4 v28, s[62:63]
    v_add_u32 v28, 4096, v28
    s_mov_b32 m0, s61
    s_add_u32 s61, s61, 4096
    global_load_lds_dwordx4 v28, s[62:63]
    v_add_u32 v28, 4096, v28
    s_mov_b32 m0, s61
    s_add_u32 s61, s61, 4096
    global_load_lds_dwordx4 v28, s[62:63]
    v_add_u32 v28, 4096, v28
    s_mov_b32 m0, s61
    s_add_u32 s61, s61, 4096
    global_load_lds_dwordx4 v28, s[62:63]
    v_add_u32 v28, 4096, v28
    s_mov_b32 m0, s61
    s_add_u32 s61, s61, 4096
    global_load_lds_dwordx4 v28, s[62:63]
    v_add_u32 v28, 4096, v28
    s_mov_b32 m0, s61
    s_add_u32 s61, s61, 4096
    global_load_lds_dwordx4 v28, s[62:63]
    v_add_u32 v28, 4096, v28
    s_mov_b32 m0, s61
    s_add_u32 s61, s61, 4096
    global_load_lds_dwordx4 v28, s[62:63]
    v_add_u32 v28, 4096, v28
    s_mov_b32 m0, s61
    s_add_u32 s61, s61, 4096
    global_load_lds_dwordx4 v28, s[62:63]
    v_add_u32 v28, 4096, v28
    s_mov_b32 m0, s61
    s_add_u32 s61, s61, 4096
    global_load_lds_dwordx4 v28, s[62:63]
    v_add_u32 v28, 4096, v28
    s_mov_b32 m0, s61
    s_add_u32 s61, s61, 4096
    global_load_lds_dwordx4 v28, s[62:63]
    v_add_u32 v28, 4096, v28
    s_mov_b32 m0, s61
    s_add_u32 s61, s61, 4096
    global_load_lds_dwordx4 v28, s[62:63]
    v_add_u32 v28, 4096, v28
    s_mov_b32 m0, s61
    s_add_u32 s61, s61, 4096
    global_load_lds_dwordx4 v28, s[62:63]
    v_add_u32 v28, 4096, v28
    s_mov_b32 m0, s61
    s_add_u32 s61, s61, 4096
    global_load_lds_dwordx4 v28, s[62:63]
    v_add_u32 v28, 4096, v28
    s_mov_b32 m0, s61
    s_add_u32 s61, s61, 4096
    global_load_lds_dwordx4 v28, s[62:63]
    v_add_u32 v28, 4096, v28
    s_mov_b32 m0, s61
    s_add_u32 s61, s61, 4096
    global_load_lds_dwordx4 v28, s[62:63]
    v_add_u32 v28, 4096, v28
    s_mov_b32 m0, s61
    s_add_u32 s61, s61, 4096
    global_load_lds_dwordx4 v28, s[62:63]
    v_add_u32 v28, 4096, v28
    s_mov_b32 m0, s61
    s_add_u32 s61, s61, 4096
    global_load_lds_dwordx4 v28, s[62:63]
    v_add_u32 v28, 4096, v28
    s_mov_b32 m0, s61
    s_add_u32 s61, s61, 4096
    global_load_lds_dwordx4 v28, s[62:63]
    v_add_u32 v28, 4096, v28
    s_mov_b32 m0, s61
    s_add_u32 s61, s61, 4096
    global_load_lds_dwordx4 v28, s[62:63]
    v_add_u32 v28, 4096, v28
    s_mov_b32 m0, s61
    s_add_u32 s61, s61, 4096
    global_load_lds_dwordx4 v28, s[62:63]
    v_add_u32 v28, 4096, v28
    s_mov_b32 m0, s61
    s_add_u32 s61, s61, 4096
    global_load_lds_dwordx4 v28, s[62:63]
    v_add_u32 v28, 4096, v28
    s_mov_b32 m0, s61
    s_add_u32 s61, s61, 4096
    global_load_lds_dwordx4 v28, s[62:63]
    v_add_u32 v28, 4096, v28
    s_mov_b32 m0, s61
    s_add_u32 s61, s61, 4096
    global_load_lds_dwordx4 v28, s[62:63]
    v_add_u32 v28, 4096, v28
    s_mov_b32 m0, s61
    s_add_u32 s61, s61, 4096
    global_load_lds_dwordx4 v28, s[62:63]
    v_add_u32 v28, 4096, v28
    s_mov_b32 m0, s61
    s_add_u32 s61, s61, 4096
    global_load_lds_dwordx4 v28, s[62:63]
    v_add_u32 v28, 4096, v28
    s_mov_b32 m0, s61
    s_add_u32 s61, s61, 4096
    global_load_lds_dwordx4 v28, s[62:63]
    v_add_u32 v28, 4096, v28
    s_mov_b32 m0, s61
    s_add_u32 s61, s61, 4096
    global_load_lds_dwordx4 v28, s[62:63]
    v_add_u32 v28, 4096, v28
    s_lshl_b32 s48, s19, 6
    s_lshl_b32 s49, s18, 8
    s_add_u32 s48, s48, s49
    v_lshrrev_b32 v26, 2, v14
    v_lshlrev_b32 v26, 13, v26
    v_and_b32 v25, 3, v14
    v_lshl_add_u32 v26, v25, 4, v26
    v_add_u32 v26, s48, v26
    v_mov_b32 v38, v26
    global_load_dwordx4 a[0:3], v38, s[4:5]
    v_add_u32 v38, 131072, v38
    global_load_dwordx4 a[4:7], v38, s[4:5]
    v_add_u32 v38, 131072, v38
    global_load_dwordx4 a[8:11], v38, s[4:5]
    v_add_u32 v38, 131072, v38
    global_load_dwordx4 a[12:15], v38, s[4:5]
    v_add_u32 v38, 131072, v38
    global_load_dwordx4 a[16:19], v38, s[4:5]
    v_add_u32 v38, 131072, v38
    global_load_dwordx4 a[20:23], v38, s[4:5]
    v_add_u32 v38, 131072, v38
    global_load_dwordx4 a[24:27], v38, s[4:5]
    v_add_u32 v38, 131072, v38
    global_load_dwordx4 a[28:31], v38, s[4:5]
    v_add_u32 v38, 131072, v38
    global_load_dwordx4 a[32:35], v38, s[4:5]
    v_add_u32 v38, 131072, v38
    global_load_dwordx4 a[36:39], v38, s[4:5]
    v_add_u32 v38, 131072, v38
    global_load_dwordx4 a[40:43], v38, s[4:5]
    v_add_u32 v38, 131072, v38
    global_load_dwordx4 a[44:47], v38, s[4:5]
    v_add_u32 v38, 131072, v38
    global_load_dwordx4 a[48:51], v38, s[4:5]
    v_add_u32 v38, 131072, v38
    global_load_dwordx4 a[52:55], v38, s[4:5]
    v_add_u32 v38, 131072, v38
    global_load_dwordx4 a[56:59], v38, s[4:5]
    v_add_u32 v38, 131072, v38
    global_load_dwordx4 a[60:63], v38, s[4:5]
    v_add_u32 v38, 131072, v38
    global_load_dwordx4 a[64:67], v38, s[4:5]
    v_add_u32 v38, 131072, v38
    global_load_dwordx4 a[68:71], v38, s[4:5]
    v_add_u32 v38, 131072, v38
    global_load_dwordx4 a[72:75], v38, s[4:5]
    v_add_u32 v38, 131072, v38
    global_load_dwordx4 a[76:79], v38, s[4:5]
    v_add_u32 v38, 131072, v38
    global_load_dwordx4 a[80:83], v38, s[4:5]
    v_add_u32 v38, 131072, v38
    global_load_dwordx4 a[84:87], v38, s[4:5]
    v_add_u32 v38, 131072, v38
    global_load_dwordx4 a[88:91], v38, s[4:5]
    v_add_u32 v38, 131072, v38
    global_load_dwordx4 a[92:95], v38, s[4:5]
    v_add_u32 v38, 131072, v38
    v_bfe_u32 v28, v14, 2, 2
    v_and_b32 v30, 1, v28
    v_lshlrev_b32 v29, 4, v30
    v_lshl_add_u32 v29, v21, 1, v29
    v_lshrrev_b32 v30, 1, v28
    v_lshlrev_b32 v30, 5, v30
    v_and_b32 v31, 3, v14
    v_lshl_add_u32 v30, v31, 3, v30
    v_mul_u32_u24 v31, 1152, v29
    v_add_u32 v31, v31, v30
    v_lshl_add_u32 v27, v29, 6, v30
    s_mul_i32 s48, s19, 36864
    s_add_u32 s48, s48, 16384
    v_add_u32 v31, s48, v31
    s_waitcnt vmcnt(24)
    s_barrier
    s_cmp_lg_u32 s19, 0
    s_cbranch_scc1 arr_14
    v_mov_b32 v28, 0
    v_mov_b32 v29, s21
    s_mov_b64 exec, 1
    global_atomic_add v28, v29, s[16:17] offset:16
    s_mov_b64 exec, -1
arr_14:
    ds_read_b64_tr_b16 v[112:113], v31 offset:0
    ds_read_b64_tr_b16 v[114:115], v31 offset:1152
    ds_read_b64_tr_b16 v[116:117], v31 offset:9216
    ds_read_b64_tr_b16 v[118:119], v31 offset:10368
    ds_read_b64_tr_b16 v[120:121], v31 offset:64
    ds_read_b64_tr_b16 v[122:123], v31 offset:1216
    ds_read_b64_tr_b16 v[124:125], v31 offset:9280
    ds_read_b64_tr_b16 v[126:127], v31 offset:10432
    ds_read_b64_tr_b16 v[128:129], v31 offset:128
    ds_read_b64_tr_b16 v[130:131], v31 offset:1280
    ds_read_b64_tr_b16 v[132:133], v31 offset:9344
    ds_read_b64_tr_b16 v[134:135], v31 offset:10496
    ds_read_b64_tr_b16 v[136:137], v31 offset:192
    ds_read_b64_tr_b16 v[138:139], v31 offset:1344
    ds_read_b64_tr_b16 v[140:141], v31 offset:9408
    ds_read_b64_tr_b16 v[142:143], v31 offset:10560
    global_load_dwordx4 a[96:99], v38, s[4:5]
    v_add_u32 v38, 131072, v38
    global_load_dwordx4 a[100:103], v38, s[4:5]
    v_add_u32 v38, 131072, v38
    global_load_dwordx4 a[104:107], v38, s[4:5]
    v_add_u32 v38, 131072, v38
    global_load_dwordx4 a[108:111], v38, s[4:5]
    v_add_u32 v38, 131072, v38
    ds_read_b64_tr_b16 v[144:145], v31 offset:256
    ds_read_b64_tr_b16 v[146:147], v31 offset:1408
    ds_read_b64_tr_b16 v[148:149], v31 offset:9472
    ds_read_b64_tr_b16 v[150:151], v31 offset:10624
    ds_read_b64_tr_b16 v[152:153], v31 offset:320
    ds_read_b64_tr_b16 v[154:155], v31 offset:1472
    ds_read_b64_tr_b16 v[156:157], v31 offset:9536
    ds_read_b64_tr_b16 v[158:159], v31 offset:10688
    ds_read_b64_tr_b16 v[160:161], v31 offset:384
    ds_read_b64_tr_b16 v[162:163], v31 offset:1536
    ds_read_b64_tr_b16 v[164:165], v31 offset:9600
    ds_read_b64_tr_b16 v[166:167], v31 offset:10752
    ds_read_b64_tr_b16 v[168:169], v31 offset:448
    ds_read_b64_tr_b16 v[170:171], v31 offset:1600
    ds_read_b64_tr_b16 v[172:173], v31 offset:9664
    ds_read_b64_tr_b16 v[174:175], v31 offset:10816
    global_load_dwordx4 a[112:115], v38, s[4:5]
    v_add_u32 v38, 131072, v38
    global_load_dwordx4 a[116:119], v38, s[4:5]
    v_add_u32 v38, 131072, v38
    global_load_dwordx4 a[120:123], v38, s[4:5]
    v_add_u32 v38, 131072, v38
    global_load_dwordx4 a[124:127], v38, s[4:5]
    v_add_u32 v38, 131072, v38
    ds_read_b64_tr_b16 v[176:177], v31 offset:512
    ds_read_b64_tr_b16 v[178:179], v31 offset:1664
    ds_read_b64_tr_b16 v[180:181], v31 offset:9728
    ds_read_b64_tr_b16 v[182:183], v31 offset:10880
    ds_read_b64_tr_b16 v[184:185], v31 offset:576
    ds_read_b64_tr_b16 v[186:187], v31 offset:1728
    ds_read_b64_tr_b16 v[188:189], v31 offset:9792
    ds_read_b64_tr_b16 v[190:191], v31 offset:10944
    ds_read_b64_tr_b16 v[192:193], v31 offset:640
    ds_read_b64_tr_b16 v[194:195], v31 offset:1792
    ds_read_b64_tr_b16 v[196:197], v31 offset:9856
    ds_read_b64_tr_b16 v[198:199], v31 offset:11008
    ds_read_b64_tr_b16 v[200:201], v31 offset:704
    ds_read_b64_tr_b16 v[202:203], v31 offset:1856
    ds_read_b64_tr_b16 v[204:205], v31 offset:9920
    ds_read_b64_tr_b16 v[206:207], v31 offset:11072
    global_load_dwordx4 a[128:131], v38, s[4:5]
    v_add_u32 v38, 131072, v38
    global_load_dwordx4 a[132:135], v38, s[4:5]
    v_add_u32 v38, 131072, v38
    global_load_dwordx4 a[136:139], v38, s[4:5]
    v_add_u32 v38, 131072, v38
    global_load_dwordx4 a[140:143], v38, s[4:5]
    v_add_u32 v38, 131072, v38
    ds_read_b64_tr_b16 v[208:209], v31 offset:768
    ds_read_b64_tr_b16 v[210:211], v31 offset:1920
    ds_read_b64_tr_b16 v[212:213], v31 offset:9984
    ds_read_b64_tr_b16 v[214:215], v31 offset:11136
    ds_read_b64_tr_b16 v[216:217], v31 offset:832
    ds_read_b64_tr_b16 v[218:219], v31 offset:1984
    ds_read_b64_tr_b16 v[220:221], v31 offset:10048
    ds_read_b64_tr_b16 v[222:223], v31 offset:11200
    ds_read_b64_tr_b16 v[224:225], v31 offset:896
    ds_read_b64_tr_b16 v[226:227], v31 offset:2048
    ds_read_b64_tr_b16 v[228:229], v31 offset:10112
    ds_read_b64_tr_b16 v[230:231], v31 offset:11264
    ds_read_b64_tr_b16 v[232:233], v31 offset:960
    ds_read_b64_tr_b16 v[234:235], v31 offset:2112
    ds_read_b64_tr_b16 v[236:237], v31 offset:10176
    ds_read_b64_tr_b16 v[238:239], v31 offset:11328
    v_mov_b32 v38, v26
    global_load_dwordx4 a[144:147], v38, s[6:7]
    v_add_u32 v38, 131072, v38
    global_load_dwordx4 a[148:151], v38, s[6:7]
    v_add_u32 v38, 131072, v38
    global_load_dwordx4 a[152:155], v38, s[6:7]
    v_add_u32 v38, 131072, v38
    global_load_dwordx4 a[156:159], v38, s[6:7]
    v_add_u32 v38, 131072, v38
    ds_read_b64_tr_b16 v[240:241], v31 offset:1024
    ds_read_b64_tr_b16 v[242:243], v31 offset:2176
    ds_read_b64_tr_b16 v[244:245], v31 offset:10240
    ds_read_b64_tr_b16 v[246:247], v31 offset:11392
    ds_read_b64_tr_b16 v[248:249], v31 offset:1088
    ds_read_b64_tr_b16 v[250:251], v31 offset:2240
    ds_read_b64_tr_b16 v[252:253], v31 offset:10304
    ds_read_b64_tr_b16 v[254:255], v31 offset:11456
    s_waitcnt lgkmcnt(0)
    s_barrier
    s_lshl_b32 s48, s19, 11
    s_add_u32 s48, s48, 16384
    v_add_u32 v28, s48, v0
    ds_write_b128 v28, v[112:115] offset:0
    ds_write_b128 v28, v[116:119] offset:1024
    ds_write_b128 v28, v[120:123] offset:8192
    ds_write_b128 v28, v[124:127] offset:9216
    ds_write_b128 v28, v[128:131] offset:16384
    ds_write_b128 v28, v[132:135] offset:17408
    ds_write_b128 v28, v[136:139] offset:24576
    ds_write_b128 v28, v[140:143] offset:25600
    global_load_dwordx4 a[160:163], v38, s[6:7]
    v_add_u32 v38, 131072, v38
    global_load_dwordx4 a[164:167], v38, s[6:7]
    v_add_u32 v38, 131072, v38
    global_load_dwordx4 a[168:171], v38, s[6:7]
    v_add_u32 v38, 131072, v38
    global_load_dwordx4 a[172:175], v38, s[6:7]
    v_add_u32 v38, 131072, v38
    ds_write_b128 v28, v[144:147] offset:32768
    ds_write_b128 v28, v[148:151] offset:33792
    ds_write_b128 v28, v[152:155] offset:40960
    ds_write_b128 v28, v[156:159] offset:41984
    ds_write_b128 v28, v[160:163] offset:49152
    ds_write_b128 v28, v[164:167] offset:50176
    ds_write_b128 v28, v[168:171] offset:57344
    ds_write_b128 v28, v[172:175] offset:58368
    global_load_dwordx4 a[176:179], v38, s[6:7]
    v_add_u32 v38, 131072, v38
    global_load_dwordx4 a[180:183], v38, s[6:7]
    v_add_u32 v38, 131072, v38
    global_load_dwordx4 a[184:187], v38, s[6:7]
    v_add_u32 v38, 131072, v38
    global_load_dwordx4 a[188:191], v38, s[6:7]
    v_add_u32 v38, 131072, v38
    v_add_u32 v28, 65536, v28
    ds_write_b128 v28, v[176:179] offset:0
    ds_write_b128 v28, v[180:183] offset:1024
    ds_write_b128 v28, v[184:187] offset:8192
    ds_write_b128 v28, v[188:191] offset:9216
    ds_write_b128 v28, v[192:195] offset:16384
    ds_write_b128 v28, v[196:199] offset:17408
    ds_write_b128 v28, v[200:203] offset:24576
    ds_write_b128 v28, v[204:207] offset:25600
    global_load_dwordx4 a[192:195], v38, s[6:7]
    v_add_u32 v38, 131072, v38
    global_load_dwordx4 a[196:199], v38, s[6:7]
    v_add_u32 v38, 131072, v38
    global_load_dwordx4 a[200:203], v38, s[6:7]
    v_add_u32 v38, 131072, v38
    global_load_dwordx4 a[204:207], v38, s[6:7]
    v_add_u32 v38, 131072, v38
    ds_write_b128 v28, v[208:211] offset:32768
    ds_write_b128 v28, v[212:215] offset:33792
    ds_write_b128 v28, v[216:219] offset:40960
    ds_write_b128 v28, v[220:223] offset:41984
    ds_write_b128 v28, v[224:227] offset:49152
    ds_write_b128 v28, v[228:231] offset:50176
    ds_write_b128 v28, v[232:235] offset:57344
    ds_write_b128 v28, v[236:239] offset:58368
    global_load_dwordx4 a[208:211], v38, s[6:7]
    v_add_u32 v38, 131072, v38
    global_load_dwordx4 a[212:215], v38, s[6:7]
    v_add_u32 v38, 131072, v38
    global_load_dwordx4 a[216:219], v38, s[6:7]
    v_add_u32 v38, 131072, v38
    global_load_dwordx4 a[220:223], v38, s[6:7]
    v_add_u32 v38, 131072, v38
    v_add_u32 v28, 65536, v28
    ds_write_b128 v28, v[240:243] offset:0
    ds_write_b128 v28, v[244:247] offset:1024
    ds_write_b128 v28, v[248:251] offset:8192
    ds_write_b128 v28, v[252:255] offset:9216
    s_waitcnt lgkmcnt(0)
    s_lshl_b32 s48, s19, 12
    v_add_u32 v28, s48, v0
    v_add_u32 v29, s48, v27
    global_load_dwordx4 a[224:227], v38, s[6:7]
    v_add_u32 v38, 131072, v38
    global_load_dwordx4 a[228:231], v38, s[6:7]
    v_add_u32 v38, 131072, v38
    global_load_dwordx4 a[232:235], v38, s[6:7]
    v_add_u32 v38, 131072, v38
    global_load_dwordx4 a[236:239], v38, s[6:7]
    v_add_u32 v38, 131072, v38
    s_waitcnt vmcnt(56)
    ds_write_b128 v28, a[0:3] offset:0
    ds_write_b128 v28, a[4:7] offset:1024
    ds_write_b128 v28, a[8:11] offset:2048
    ds_write_b128 v28, a[12:15] offset:3072
    ds_read_b64_tr_b16 a[0:1], v29 offset:0
    ds_read_b64_tr_b16 a[2:3], v29 offset:64
    ds_read_b64_tr_b16 a[4:5], v29 offset:512
    ds_read_b64_tr_b16 a[6:7], v29 offset:576
    ds_read_b64_tr_b16 a[8:9], v29 offset:2048
    ds_read_b64_tr_b16 a[10:11], v29 offset:2112
    ds_read_b64_tr_b16 a[12:13], v29 offset:2560
    ds_read_b64_tr_b16 a[14:15], v29 offset:2624
    global_load_dwordx4 a[240:243], v38, s[6:7]
    v_add_u32 v38, 131072, v38
    global_load_dwordx4 a[244:247], v38, s[6:7]
    v_add_u32 v38, 131072, v38
    global_load_dwordx4 a[248:251], v38, s[6:7]
    v_add_u32 v38, 131072, v38
    global_load_dwordx4 a[252:255], v38, s[6:7]
    v_add_u32 v38, 131072, v38
    s_waitcnt vmcnt(56)
    ds_write_b128 v28, a[16:19] offset:0
    ds_write_b128 v28, a[20:23] offset:1024
    ds_write_b128 v28, a[24:27] offset:2048
    ds_write_b128 v28, a[28:31] offset:3072
    ds_read_b64_tr_b16 a[16:17], v29 offset:0
    ds_read_b64_tr_b16 a[18:19], v29 offset:64
    ds_read_b64_tr_b16 a[20:21], v29 offset:512
    ds_read_b64_tr_b16 a[22:23], v29 offset:576
    ds_read_b64_tr_b16 a[24:25], v29 offset:2048
    ds_read_b64_tr_b16 a[26:27], v29 offset:2112
    ds_read_b64_tr_b16 a[28:29], v29 offset:2560
    ds_read_b64_tr_b16 a[30:31], v29 offset:2624
    global_load_dwordx4 v[80:83], v38, s[6:7]
    v_add_u32 v38, 131072, v38
    global_load_dwordx4 v[84:87], v38, s[6:7]
    v_add_u32 v38, 131072, v38
    global_load_dwordx4 v[88:91], v38, s[6:7]
    v_add_u32 v38, 131072, v38
    global_load_dwordx4 v[92:95], v38, s[6:7]
    v_add_u32 v38, 131072, v38
    s_waitcnt vmcnt(56)
    ds_write_b128 v28, a[32:35] offset:0
    ds_write_b128 v28, a[36:39] offset:1024
    ds_write_b128 v28, a[40:43] offset:2048
    ds_write_b128 v28, a[44:47] offset:3072
    ds_read_b64_tr_b16 a[32:33], v29 offset:0
    ds_read_b64_tr_b16 a[34:35], v29 offset:64
    ds_read_b64_tr_b16 a[36:37], v29 offset:512
    ds_read_b64_tr_b16 a[38:39], v29 offset:576
    ds_read_b64_tr_b16 a[40:41], v29 offset:2048
    ds_read_b64_tr_b16 a[42:43], v29 offset:2112
    ds_read_b64_tr_b16 a[44:45], v29 offset:2560
    ds_read_b64_tr_b16 a[46:47], v29 offset:2624
    global_load_dwordx4 v[96:99], v38, s[6:7]
    v_add_u32 v38, 131072, v38
    global_load_dwordx4 v[100:103], v38, s[6:7]
    v_add_u32 v38, 131072, v38
    global_load_dwordx4 v[104:107], v38, s[6:7]
    v_add_u32 v38, 131072, v38
    global_load_dwordx4 v[108:111], v38, s[6:7]
    v_add_u32 v38, 131072, v38
    s_waitcnt vmcnt(56)
    ds_write_b128 v28, a[48:51] offset:0
    ds_write_b128 v28, a[52:55] offset:1024
    ds_write_b128 v28, a[56:59] offset:2048
    ds_write_b128 v28, a[60:63] offset:3072
    ds_read_b64_tr_b16 a[48:49], v29 offset:0
    ds_read_b64_tr_b16 a[50:51], v29 offset:64
    ds_read_b64_tr_b16 a[52:53], v29 offset:512
    ds_read_b64_tr_b16 a[54:55], v29 offset:576
    ds_read_b64_tr_b16 a[56:57], v29 offset:2048
    ds_read_b64_tr_b16 a[58:59], v29 offset:2112
    ds_read_b64_tr_b16 a[60:61], v29 offset:2560
    ds_read_b64_tr_b16 a[62:63], v29 offset:2624
    v_mov_b32 v38, v26
    global_load_dwordx4 v[112:115], v38, s[8:9]
    v_add_u32 v38, 131072, v38
    global_load_dwordx4 v[116:119], v38, s[8:9]
    v_add_u32 v38, 131072, v38
    global_load_dwordx4 v[120:123], v38, s[8:9]
    v_add_u32 v38, 131072, v38
    global_load_dwordx4 v[124:127], v38, s[8:9]
    v_add_u32 v38, 131072, v38
    s_waitcnt vmcnt(56)
    ds_write_b128 v28, a[64:67] offset:0
    ds_write_b128 v28, a[68:71] offset:1024
    ds_write_b128 v28, a[72:75] offset:2048
    ds_write_b128 v28, a[76:79] offset:3072
    ds_read_b64_tr_b16 a[64:65], v29 offset:0
    ds_read_b64_tr_b16 a[66:67], v29 offset:64
    ds_read_b64_tr_b16 a[68:69], v29 offset:512
    ds_read_b64_tr_b16 a[70:71], v29 offset:576
    ds_read_b64_tr_b16 a[72:73], v29 offset:2048
    ds_read_b64_tr_b16 a[74:75], v29 offset:2112
    ds_read_b64_tr_b16 a[76:77], v29 offset:2560
    ds_read_b64_tr_b16 a[78:79], v29 offset:2624
    global_load_dwordx4 v[128:131], v38, s[8:9]
    v_add_u32 v38, 131072, v38
    global_load_dwordx4 v[132:135], v38, s[8:9]
    v_add_u32 v38, 131072, v38
    global_load_dwordx4 v[136:139], v38, s[8:9]
    v_add_u32 v38, 131072, v38
    global_load_dwordx4 v[140:143], v38, s[8:9]
    v_add_u32 v38, 131072, v38
    s_waitcnt vmcnt(56)
    ds_write_b128 v28, a[80:83] offset:0
    ds_write_b128 v28, a[84:87] offset:1024
    ds_write_b128 v28, a[88:91] offset:2048
    ds_write_b128 v28, a[92:95] offset:3072
    ds_read_b64_tr_b16 a[80:81], v29 offset:0
    ds_read_b64_tr_b16 a[82:83], v29 offset:64
    ds_read_b64_tr_b16 a[84:85], v29 offset:512
    ds_read_b64_tr_b16 a[86:87], v29 offset:576
    ds_read_b64_tr_b16 a[88:89], v29 offset:2048
    ds_read_b64_tr_b16 a[90:91], v29 offset:2112
    ds_read_b64_tr_b16 a[92:93], v29 offset:2560
    ds_read_b64_tr_b16 a[94:95], v29 offset:2624
    global_load_dwordx4 v[144:147], v38, s[8:9]
    v_add_u32 v38, 131072, v38
    global_load_dwordx4 v[148:151], v38, s[8:9]
    v_add_u32 v38, 131072, v38
    global_load_dwordx4 v[152:155], v38, s[8:9]
    v_add_u32 v38, 131072, v38
    global_load_dwordx4 v[156:159], v38, s[8:9]
    v_add_u32 v38, 131072, v38
    s_waitcnt vmcnt(56)
    ds_write_b128 v28, a[96:99] offset:0
    ds_write_b128 v28, a[100:103] offset:1024
    ds_write_b128 v28, a[104:107] offset:2048
    ds_write_b128 v28, a[108:111] offset:3072
    ds_read_b64_tr_b16 a[96:97], v29 offset:0
    ds_read_b64_tr_b16 a[98:99], v29 offset:64
    ds_read_b64_tr_b16 a[100:101], v29 offset:512
    ds_read_b64_tr_b16 a[102:103], v29 offset:576
    ds_read_b64_tr_b16 a[104:105], v29 offset:2048
    ds_read_b64_tr_b16 a[106:107], v29 offset:2112
    ds_read_b64_tr_b16 a[108:109], v29 offset:2560
    ds_read_b64_tr_b16 a[110:111], v29 offset:2624
    global_load_dwordx4 v[160:163], v38, s[8:9]
    v_add_u32 v38, 131072, v38
    global_load_dwordx4 v[164:167], v38, s[8:9]
    v_add_u32 v38, 131072, v38
    global_load_dwordx4 v[168:171], v38, s[8:9]
    v_add_u32 v38, 131072, v38
    global_load_dwordx4 v[172:175], v38, s[8:9]
    v_add_u32 v38, 131072, v38
    s_waitcnt vmcnt(56)
    ds_write_b128 v28, a[112:115] offset:0
    ds_write_b128 v28, a[116:119] offset:1024
    ds_write_b128 v28, a[120:123] offset:2048
    ds_write_b128 v28, a[124:127] offset:3072
    ds_read_b64_tr_b16 a[112:113], v29 offset:0
    ds_read_b64_tr_b16 a[114:115], v29 offset:64
    ds_read_b64_tr_b16 a[116:117], v29 offset:512
    ds_read_b64_tr_b16 a[118:119], v29 offset:576
    ds_read_b64_tr_b16 a[120:121], v29 offset:2048
    ds_read_b64_tr_b16 a[122:123], v29 offset:2112
    ds_read_b64_tr_b16 a[124:125], v29 offset:2560
    ds_read_b64_tr_b16 a[126:127], v29 offset:2624
    global_load_dwordx4 v[176:179], v38, s[8:9]
    v_add_u32 v38, 131072, v38
    global_load_dwordx4 v[180:183], v38, s[8:9]
    v_add_u32 v38, 131072, v38
    global_load_dwordx4 v[184:187], v38, s[8:9]
    v_add_u32 v38, 131072, v38
    global_load_dwordx4 v[188:191], v38, s[8:9]
    v_add_u32 v38, 131072, v38
    s_waitcnt vmcnt(56)
    ds_write_b128 v28, a[128:131] offset:0
    ds_write_b128 v28, a[132:135] offset:1024
    ds_write_b128 v28, a[136:139] offset:2048
    ds_write_b128 v28, a[140:143] offset:3072
    ds_read_b64_tr_b16 a[128:129], v29 offset:0
    ds_read_b64_tr_b16 a[130:131], v29 offset:64
    ds_read_b64_tr_b16 a[132:133], v29 offset:512
    ds_read_b64_tr_b16 a[134:135], v29 offset:576
    ds_read_b64_tr_b16 a[136:137], v29 offset:2048
    ds_read_b64_tr_b16 a[138:139], v29 offset:2112
    ds_read_b64_tr_b16 a[140:141], v29 offset:2560
    ds_read_b64_tr_b16 a[142:143], v29 offset:2624
    global_load_dwordx4 v[192:195], v38, s[8:9]
    v_add_u32 v38, 131072, v38
    global_load_dwordx4 v[196:199], v38, s[8:9]
    v_add_u32 v38, 131072, v38
    global_load_dwordx4 v[200:203], v38, s[8:9]
    v_add_u32 v38, 131072, v38
    global_load_dwordx4 v[204:207], v38, s[8:9]
    v_add_u32 v38, 131072, v38
    s_waitcnt vmcnt(56)
    ds_write_b128 v28, a[144:147] offset:0
    ds_write_b128 v28, a[148:151] offset:1024
    ds_write_b128 v28, a[152:155] offset:2048
    ds_write_b128 v28, a[156:159] offset:3072
    ds_read_b64_tr_b16 a[144:145], v29 offset:0
    ds_read_b64_tr_b16 a[146:147], v29 offset:64
    ds_read_b64_tr_b16 a[148:149], v29 offset:512
    ds_read_b64_tr_b16 a[150:151], v29 offset:576
    ds_read_b64_tr_b16 a[152:153], v29 offset:2048
    ds_read_b64_tr_b16 a[154:155], v29 offset:2112
    ds_read_b64_tr_b16 a[156:157], v29 offset:2560
    ds_read_b64_tr_b16 a[158:159], v29 offset:2624
    global_load_dwordx4 v[208:211], v38, s[8:9]
    v_add_u32 v38, 131072, v38
    global_load_dwordx4 v[212:215], v38, s[8:9]
    v_add_u32 v38, 131072, v38
    global_load_dwordx4 v[216:219], v38, s[8:9]
    v_add_u32 v38, 131072, v38
    global_load_dwordx4 v[220:223], v38, s[8:9]
    v_add_u32 v38, 131072, v38
    s_waitcnt vmcnt(56)
    ds_write_b128 v28, a[160:163] offset:0
    ds_write_b128 v28, a[164:167] offset:1024
    ds_write_b128 v28, a[168:171] offset:2048
    ds_write_b128 v28, a[172:175] offset:3072
    ds_read_b64_tr_b16 a[160:161], v29 offset:0
    ds_read_b64_tr_b16 a[162:163], v29 offset:64
    ds_read_b64_tr_b16 a[164:165], v29 offset:512
    ds_read_b64_tr_b16 a[166:167], v29 offset:576
    ds_read_b64_tr_b16 a[168:169], v29 offset:2048
    ds_read_b64_tr_b16 a[170:171], v29 offset:2112
    ds_read_b64_tr_b16 a[172:173], v29 offset:2560
    ds_read_b64_tr_b16 a[174:175], v29 offset:2624
    global_load_dwordx4 v[224:227], v38, s[8:9]
    v_add_u32 v38, 131072, v38
    global_load_dwordx4 v[228:231], v38, s[8:9]
    v_add_u32 v38, 131072, v38
    global_load_dwordx4 v[232:235], v38, s[8:9]
    v_add_u32 v38, 131072, v38
    global_load_dwordx4 v[236:239], v38, s[8:9]
    v_add_u32 v38, 131072, v38
    s_waitcnt vmcnt(56)
    ds_write_b128 v28, a[176:179] offset:0
    ds_write_b128 v28, a[180:183] offset:1024
    ds_write_b128 v28, a[184:187] offset:2048
    ds_write_b128 v28, a[188:191] offset:3072
    ds_read_b64_tr_b16 a[176:177], v29 offset:0
    ds_read_b64_tr_b16 a[178:179], v29 offset:64
    ds_read_b64_tr_b16 a[180:181], v29 offset:512
    ds_read_b64_tr_b16 a[182:183], v29 offset:576
    ds_read_b64_tr_b16 a[184:185], v29 offset:2048
    ds_read_b64_tr_b16 a[186:187], v29 offset:2112
    ds_read_b64_tr_b16 a[188:189], v29 offset:2560
    ds_read_b64_tr_b16 a[190:191], v29 offset:2624
    global_load_dwordx4 v[240:243], v38, s[8:9]
    v_add_u32 v38, 131072, v38
    global_load_dwordx4 v[244:247], v38, s[8:9]
    v_add_u32 v38, 131072, v38
    global_load_dwordx4 v[248:251], v38, s[8:9]
    v_add_u32 v38, 131072, v38
    global_load_dwordx4 v[252:255], v38, s[8:9]
    v_add_u32 v38, 131072, v38
    s_waitcnt vmcnt(56)
    ds_write_b128 v28, a[192:195] offset:0
    ds_write_b128 v28, a[196:199] offset:1024
    ds_write_b128 v28, a[200:203] offset:2048
    ds_write_b128 v28, a[204:207] offset:3072
    ds_read_b64_tr_b16 a[192:193], v29 offset:0
    ds_read_b64_tr_b16 a[194:195], v29 offset:64
    ds_read_b64_tr_b16 a[196:197], v29 offset:512
    ds_read_b64_tr_b16 a[198:199], v29 offset:576
    ds_read_b64_tr_b16 a[200:201], v29 offset:2048
    ds_read_b64_tr_b16 a[202:203], v29 offset:2112
    ds_read_b64_tr_b16 a[204:205], v29 offset:2560
    ds_read_b64_tr_b16 a[206:207], v29 offset:2624
    s_waitcnt vmcnt(52)
    ds_write_b128 v28, a[208:211] offset:0
    ds_write_b128 v28, a[212:215] offset:1024
    ds_write_b128 v28, a[216:219] offset:2048
    ds_write_b128 v28, a[220:223] offset:3072
    ds_read_b64_tr_b16 a[208:209], v29 offset:0
    ds_read_b64_tr_b16 a[210:211], v29 offset:64
    ds_read_b64_tr_b16 a[212:213], v29 offset:512
    ds_read_b64_tr_b16 a[214:215], v29 offset:576
    ds_read_b64_tr_b16 a[216:217], v29 offset:2048
    ds_read_b64_tr_b16 a[218:219], v29 offset:2112
    ds_read_b64_tr_b16 a[220:221], v29 offset:2560
    ds_read_b64_tr_b16 a[222:223], v29 offset:2624
    s_waitcnt vmcnt(48)
    ds_write_b128 v28, a[224:227] offset:0
    ds_write_b128 v28, a[228:231] offset:1024
    ds_write_b128 v28, a[232:235] offset:2048
    ds_write_b128 v28, a[236:239] offset:3072
    ds_read_b64_tr_b16 a[224:225], v29 offset:0
    ds_read_b64_tr_b16 a[226:227], v29 offset:64
    ds_read_b64_tr_b16 a[228:229], v29 offset:512
    ds_read_b64_tr_b16 a[230:231], v29 offset:576
    ds_read_b64_tr_b16 a[232:233], v29 offset:2048
    ds_read_b64_tr_b16 a[234:235], v29 offset:2112
    ds_read_b64_tr_b16 a[236:237], v29 offset:2560
    ds_read_b64_tr_b16 a[238:239], v29 offset:2624
    s_waitcnt vmcnt(44)
    ds_write_b128 v28, a[240:243] offset:0
    ds_write_b128 v28, a[244:247] offset:1024
    ds_write_b128 v28, a[248:251] offset:2048
    ds_write_b128 v28, a[252:255] offset:3072
    ds_read_b64_tr_b16 a[240:241], v29 offset:0
    ds_read_b64_tr_b16 a[242:243], v29 offset:64
    ds_read_b64_tr_b16 a[244:245], v29 offset:512
    ds_read_b64_tr_b16 a[246:247], v29 offset:576
    ds_read_b64_tr_b16 a[248:249], v29 offset:2048
    ds_read_b64_tr_b16 a[250:251], v29 offset:2112
    ds_read_b64_tr_b16 a[252:253], v29 offset:2560
    ds_read_b64_tr_b16 a[254:255], v29 offset:2624
    s_waitcnt vmcnt(40)
    ds_write_b128 v28, v[80:83] offset:0
    ds_write_b128 v28, v[84:87] offset:1024
    ds_write_b128 v28, v[88:91] offset:2048
    ds_write_b128 v28, v[92:95] offset:3072
    ds_read_b64_tr_b16 v[80:81], v29 offset:0
    ds_read_b64_tr_b16 v[82:83], v29 offset:64
    ds_read_b64_tr_b16 v[84:85], v29 offset:512
    ds_read_b64_tr_b16 v[86:87], v29 offset:576
    ds_read_b64_tr_b16 v[88:89], v29 offset:2048
    ds_read_b64_tr_b16 v[90:91], v29 offset:2112
    ds_read_b64_tr_b16 v[92:93], v29 offset:2560
    ds_read_b64_tr_b16 v[94:95], v29 offset:2624
    s_waitcnt vmcnt(36)
    ds_write_b128 v28, v[96:99] offset:0
    ds_write_b128 v28, v[100:103] offset:1024
    ds_write_b128 v28, v[104:107] offset:2048
    ds_write_b128 v28, v[108:111] offset:3072
    ds_read_b64_tr_b16 v[96:97], v29 offset:0
    ds_read_b64_tr_b16 v[98:99], v29 offset:64
    ds_read_b64_tr_b16 v[100:101], v29 offset:512
    ds_read_b64_tr_b16 v[102:103], v29 offset:576
    ds_read_b64_tr_b16 v[104:105], v29 offset:2048
    ds_read_b64_tr_b16 v[106:107], v29 offset:2112
    ds_read_b64_tr_b16 v[108:109], v29 offset:2560
    ds_read_b64_tr_b16 v[110:111], v29 offset:2624
    s_waitcnt vmcnt(32)
    ds_write_b128 v28, v[112:115] offset:0
    ds_write_b128 v28, v[116:119] offset:1024
    ds_write_b128 v28, v[120:123] offset:2048
    ds_write_b128 v28, v[124:127] offset:3072
    ds_read_b64_tr_b16 v[112:113], v29 offset:0
    ds_read_b64_tr_b16 v[114:115], v29 offset:64
    ds_read_b64_tr_b16 v[116:117], v29 offset:512
    ds_read_b64_tr_b16 v[118:119], v29 offset:576
    ds_read_b64_tr_b16 v[120:121], v29 offset:2048
    ds_read_b64_tr_b16 v[122:123], v29 offset:2112
    ds_read_b64_tr_b16 v[124:125], v29 offset:2560
    ds_read_b64_tr_b16 v[126:127], v29 offset:2624
    s_waitcnt vmcnt(28)
    ds_write_b128 v28, v[128:131] offset:0
    ds_write_b128 v28, v[132:135] offset:1024
    ds_write_b128 v28, v[136:139] offset:2048
    ds_write_b128 v28, v[140:143] offset:3072
    ds_read_b64_tr_b16 v[128:129], v29 offset:0
    ds_read_b64_tr_b16 v[130:131], v29 offset:64
    ds_read_b64_tr_b16 v[132:133], v29 offset:512
    ds_read_b64_tr_b16 v[134:135], v29 offset:576
    ds_read_b64_tr_b16 v[136:137], v29 offset:2048
    ds_read_b64_tr_b16 v[138:139], v29 offset:2112
    ds_read_b64_tr_b16 v[140:141], v29 offset:2560
    ds_read_b64_tr_b16 v[142:143], v29 offset:2624
    s_waitcnt vmcnt(24)
    ds_write_b128 v28, v[144:147] offset:0
    ds_write_b128 v28, v[148:151] offset:1024
    ds_write_b128 v28, v[152:155] offset:2048
    ds_write_b128 v28, v[156:159] offset:3072
    ds_read_b64_tr_b16 v[144:145], v29 offset:0
    ds_read_b64_tr_b16 v[146:147], v29 offset:64
    ds_read_b64_tr_b16 v[148:149], v29 offset:512
    ds_read_b64_tr_b16 v[150:151], v29 offset:576
    ds_read_b64_tr_b16 v[152:153], v29 offset:2048
    ds_read_b64_tr_b16 v[154:155], v29 offset:2112
    ds_read_b64_tr_b16 v[156:157], v29 offset:2560
    ds_read_b64_tr_b16 v[158:159], v29 offset:2624
    s_waitcnt vmcnt(20)
    ds_write_b128 v28, v[160:163] offset:0
    ds_write_b128 v28, v[164:167] offset:1024
    ds_write_b128 v28, v[168:171] offset:2048
    ds_write_b128 v28, v[172:175] offset:3072
    ds_read_b64_tr_b16 v[160:161], v29 offset:0
    ds_read_b64_tr_b16 v[162:163], v29 offset:64
    ds_read_b64_tr_b16 v[164:165], v29 offset:512
    ds_read_b64_tr_b16 v[166:167], v29 offset:576
    ds_read_b64_tr_b16 v[168:169], v29 offset:2048
    ds_read_b64_tr_b16 v[170:171], v29 offset:2112
    ds_read_b64_tr_b16 v[172:173], v29 offset:2560
    ds_read_b64_tr_b16 v[174:175], v29 offset:2624
    s_waitcnt vmcnt(16)
    ds_write_b128 v28, v[176:179] offset:0
    ds_write_b128 v28, v[180:183] offset:1024
    ds_write_b128 v28, v[184:187] offset:2048
    ds_write_b128 v28, v[188:191] offset:3072
    ds_read_b64_tr_b16 v[176:177], v29 offset:0
    ds_read_b64_tr_b16 v[178:179], v29 offset:64
    ds_read_b64_tr_b16 v[180:181], v29 offset:512
    ds_read_b64_tr_b16 v[182:183], v29 offset:576
    ds_read_b64_tr_b16 v[184:185], v29 offset:2048
    ds_read_b64_tr_b16 v[186:187], v29 offset:2112
    ds_read_b64_tr_b16 v[188:189], v29 offset:2560
    ds_read_b64_tr_b16 v[190:191], v29 offset:2624
    s_waitcnt vmcnt(12)
    ds_write_b128 v28, v[192:195] offset:0
    ds_write_b128 v28, v[196:199] offset:1024
    ds_write_b128 v28, v[200:203] offset:2048
    ds_write_b128 v28, v[204:207] offset:3072
    ds_read_b64_tr_b16 v[192:193], v29 offset:0
    ds_read_b64_tr_b16 v[194:195], v29 offset:64
    ds_read_b64_tr_b16 v[196:197], v29 offset:512
    ds_read_b64_tr_b16 v[198:199], v29 offset:576
    ds_read_b64_tr_b16 v[200:201], v29 offset:2048
    ds_read_b64_tr_b16 v[202:203], v29 offset:2112
    ds_read_b64_tr_b16 v[204:205], v29 offset:2560
    ds_read_b64_tr_b16 v[206:207], v29 offset:2624
    s_waitcnt vmcnt(8)
    ds_write_b128 v28, v[208:211] offset:0
    ds_write_b128 v28, v[212:215] offset:1024
    ds_write_b128 v28, v[216:219] offset:2048
    ds_write_b128 v28, v[220:223] offset:3072
    ds_read_b64_tr_b16 v[208:209], v29 offset:0
    ds_read_b64_tr_b16 v[210:211], v29 offset:64
    ds_read_b64_tr_b16 v[212:213], v29 offset:512
    ds_read_b64_tr_b16 v[214:215], v29 offset:576
    ds_read_b64_tr_b16 v[216:217], v29 offset:2048
    ds_read_b64_tr_b16 v[218:219], v29 offset:2112
    ds_read_b64_tr_b16 v[220:221], v29 offset:2560
    ds_read_b64_tr_b16 v[222:223], v29 offset:2624
    s_waitcnt vmcnt(4)
    ds_write_b128 v28, v[224:227] offset:0
    ds_write_b128 v28, v[228:231] offset:1024
    ds_write_b128 v28, v[232:235] offset:2048
    ds_write_b128 v28, v[236:239] offset:3072
    ds_read_b64_tr_b16 v[224:225], v29 offset:0
    ds_read_b64_tr_b16 v[226:227], v29 offset:64
    ds_read_b64_tr_b16 v[228:229], v29 offset:512
    ds_read_b64_tr_b16 v[230:231], v29 offset:576
    ds_read_b64_tr_b16 v[232:233], v29 offset:2048
    ds_read_b64_tr_b16 v[234:235], v29 offset:2112
    ds_read_b64_tr_b16 v[236:237], v29 offset:2560
    ds_read_b64_tr_b16 v[238:239], v29 offset:2624
    s_waitcnt vmcnt(0)
    ds_write_b128 v28, v[240:243] offset:0
    ds_write_b128 v28, v[244:247] offset:1024
    ds_write_b128 v28, v[248:251] offset:2048
    ds_write_b128 v28, v[252:255] offset:3072
    ds_read_b64_tr_b16 v[240:241], v29 offset:0
    ds_read_b64_tr_b16 v[242:243], v29 offset:64
    ds_read_b64_tr_b16 v[244:245], v29 offset:512
    ds_read_b64_tr_b16 v[246:247], v29 offset:576
    ds_read_b64_tr_b16 v[248:249], v29 offset:2048
    ds_read_b64_tr_b16 v[250:251], v29 offset:2112
    ds_read_b64_tr_b16 v[252:253], v29 offset:2560
    ds_read_b64_tr_b16 v[254:255], v29 offset:2624
    s_waitcnt lgkmcnt(0)
    s_barrier
    v_mov_b32 v28, 0
    v_mov_b32 v29, 0
    ds_write_b64 v6, v[28:29] offset:15360
    s_mov_b32 s20, 0
    s_mov_b32 s34, 0
    s_mov_b32 s36, 58720256
    s_mov_b32 s37, 58724352
    s_mov_b32 s38, 58728448
    s_mov_b32 s39, 58729472
    s_mov_b32 s40, 0
    s_mov_b32 s42, 16777216
    s_lshl_b32 s48, s18, 12
    s_add_u32 s43, s48, 50331648
    s_lshl_b32 s48, s19, 10
    s_add_u32 s43, s43, s48
    v_mov_b32 v28, 0
sbar_15:
    global_load_dwordx2 v[30:31], v28, s[16:17] offset:16 sc1
    s_waitcnt vmcnt(0)
    v_readfirstlane_b32 s48, v30
    v_readfirstlane_b32 s49, v31
    s_nop 0
    s_cmp_lt_u32 s49, 1
    s_cbranch_scc1 sbar_15
    s_lshr_b32 s47, s48, 8
    s_and_b32 s48, s48, 0xff
    s_cmp_lt_u32 s48, 32
    s_cbranch_scc1 sbar_15
    s_waitcnt lgkmcnt(0)
    s_barrier
    s_mov_b32 s72, 0
    s_mov_b32 s55, 0
    s_cmp_lg_u32 s72, 0
    s_cbranch_scc1 wqd_17
    v_mov_b32 v13, 0
wq_16:
    global_load_dwordx4 v[28:31], v13, s[16:17] offset:32 sc1
    s_waitcnt vmcnt(0)
    v_readfirstlane_b32 s56, v28
    v_readfirstlane_b32 s57, v29
    v_readfirstlane_b32 s58, v30
    v_readfirstlane_b32 s59, v31
    s_and_b32 s60, s56, s57
    s_and_b32 s61, s58, s59
    s_and_b32 s60, s60, s61
    s_cmp_eq_u32 s60, 0x20202020
    s_cselect_b32 s72, 1, 0
    s_bitcmp1_b32 s55, 2
    s_cselect_b32 s56, s57, s56
    s_cselect_b32 s58, s59, s58
    s_bitcmp1_b32 s55, 3
    s_cselect_b32 s56, s58, s56
    s_and_b32 s57, s55, 3
    s_lshl_b32 s57, s57, 3
    s_lshr_b32 s56, s56, s57
    s_and_b32 s56, s56, 0xff
    s_cmp_lt_u32 s56, 32
    s_cbranch_scc1 wq_16
wqd_17:
    buffer_load_dwordx4 v[56:59], v1, s[24:27], s36 offen sc1
    buffer_load_dwordx4 v[60:63], v1, s[24:27], s37 offen sc1
    buffer_load_dword v79, v2, s[24:27], s38 offen sc1
    s_waitcnt vmcnt(0)
    s_mov_b32 s75, 0
    s_cmp_lg_u32 s47, 0
    s_cbranch_scc1 step_18_s
step_18:
    ds_read_b128 v[16:19], v4 offset:15360
    ds_read_b128 v[20:23], v4 offset:15360
    ds_read_b128 v[24:27], v4 offset:15360
    v_mov_b32 v15, 16777216
    v_and_b32 v13, 0xf0, v0
    v_lshlrev_b32 v13, 3, v13
    v_cndmask_b32 v14, 0, v15, s[30:31]
    v_add3_u32 v12, v13, v14, s44
    s_mul_i32 s48, s19, 2304
    s_add_u32 s48, s48, s39
    s_add_u32 s48, s48, 0
    s_sub_u32 s48, s48, s40
    s_sub_u32 s48, s48, 262144
    v_and_b32 v13, 0x1f0, v0
    v_min_u32 v13, 272, v13
    v_lshl_add_u32 v13, v13, 3, s48
    v_cndmask_b32 v12, v12, v13, s[32:33]
    s_waitcnt vmcnt(1)
    v_max3_u32 v13, v56, v57, v58
    v_max3_u32 v14, v59, v60, v61
    v_max3_u32 v13, v13, v62, v63
    v_max3_u32 v13, v13, v14, v79
    v_cmp_eq_u32 vcc, -1, v13
    s_cbranch_vccz p0ok_20
p0_19:
    buffer_load_dwordx4 v[56:59], v1, s[24:27], s36 offen sc1
    buffer_load_dwordx4 v[60:63], v1, s[24:27], s37 offen sc1
    buffer_load_dword v79, v2, s[24:27], s38 offen sc1
    s_waitcnt vmcnt(0)
    v_max3_u32 v13, v56, v57, v58
    v_max3_u32 v14, v59, v60, v61
    v_max3_u32 v13, v13, v62, v63
    v_max3_u32 v13, v13, v14, v79
    v_cmp_eq_u32 vcc, -1, v13
    s_cbranch_vccnz p0_19
p0ok_20:
    ds_write_b128 v1, v[56:59] offset:0
    ds_write_b128 v1, v[60:63] offset:4096
    ds_write_b32 v2, v79 offset:8192
    s_waitcnt lgkmcnt(0)
    s_barrier
    ds_read_b128 v[44:47], v4 offset:0
    ds_read_b128 v[48:51], v4 offset:512
    ds_read_b128 v[28:31], v4 offset:1024
    ds_read_b128 v[32:35], v4 offset:1536
    ds_read_b128 v[36:39], v4 offset:2048
    ds_read_b128 v[40:43], v4 offset:2560
    s_waitcnt lgkmcnt(5)
    v_smfmac_f32_16x16x64_bf16 v[16:19], v[44:47], a[0:7], v11
    v_smfmac_f32_16x16x64_bf16 v[20:23], v[44:47], a[144:151], v11
    ds_read_b128 v[44:47], v4 offset:3072
    s_waitcnt lgkmcnt(5)
    v_smfmac_f32_16x16x64_bf16 v[16:19], v[48:51], a[8:15], v11
    v_smfmac_f32_16x16x64_bf16 v[20:23], v[48:51], a[152:159], v11
    ds_read_b128 v[48:51], v4 offset:3584
    s_waitcnt lgkmcnt(5)
    v_smfmac_f32_16x16x64_bf16 v[16:19], v[28:31], a[16:23], v11
    v_smfmac_f32_16x16x64_bf16 v[20:23], v[28:31], a[160:167], v11
    ds_read_b128 v[28:31], v4 offset:4096
    buffer_load_dwordx4 v[56:59], v9, s[24:27], s40 offen
    buffer_load_dwordx4 v[60:63], v9, s[24:27], s40 offen offset:1024
    s_waitcnt lgkmcnt(5)
    v_smfmac_f32_16x16x64_bf16 v[16:19], v[32:35], a[24:31], v11
    v_smfmac_f32_16x16x64_bf16 v[20:23], v[32:35], a[168:175], v11
    ds_read_b128 v[32:35], v4 offset:4608
    buffer_load_dwordx4 v[64:67], v10, s[24:27], s42 offen
    buffer_load_dwordx4 v[68:71], v10, s[24:27], s42 offen offset:512
    s_waitcnt lgkmcnt(5)
    v_smfmac_f32_16x16x64_bf16 v[16:19], v[36:39], a[32:39], v11
    v_smfmac_f32_16x16x64_bf16 v[20:23], v[36:39], a[176:183], v11
    ds_read_b128 v[36:39], v4 offset:5120
    buffer_load_dwordx4 v[72:75], v10, s[24:27], s42 offen offset:1024
    buffer_load_dwordx4 v[76:79], v10, s[24:27], s42 offen offset:1536
    s_waitcnt lgkmcnt(5)
    v_smfmac_f32_16x16x64_bf16 v[16:19], v[40:43], a[40:47], v11
    v_smfmac_f32_16x16x64_bf16 v[20:23], v[40:43], a[184:191], v11
    ds_read_b128 v[40:43], v4 offset:5632
    s_waitcnt lgkmcnt(5)
    v_smfmac_f32_16x16x64_bf16 v[16:19], v[44:47], a[48:55], v11
    v_smfmac_f32_16x16x64_bf16 v[20:23], v[44:47], a[192:199], v11
    ds_read_b128 v[44:47], v4 offset:6144
    s_waitcnt lgkmcnt(5)
    v_smfmac_f32_16x16x64_bf16 v[16:19], v[48:51], a[56:63], v11
    v_smfmac_f32_16x16x64_bf16 v[20:23], v[48:51], a[200:207], v11
    ds_read_b128 v[48:51], v4 offset:6656
    s_waitcnt lgkmcnt(5)
    v_smfmac_f32_16x16x64_bf16 v[16:19], v[28:31], a[64:71], v11
    v_smfmac_f32_16x16x64_bf16 v[20:23], v[28:31], a[208:215], v11
    ds_read_b128 v[28:31], v4 offset:7168
    s_waitcnt lgkmcnt(5)
    v_smfmac_f32_16x16x64_bf16 v[16:19], v[32:35], a[72:79], v11
    v_smfmac_f32_16x16x64_bf16 v[20:23], v[32:35], a[216:223], v11
    ds_read_b128 v[32:35], v4 offset:7680
    s_waitcnt lgkmcnt(5)
    v_smfmac_f32_16x16x64_bf16 v[16:19], v[36:39], a[80:87], v11
    v_smfmac_f32_16x16x64_bf16 v[20:23], v[36:39], a[224:231], v11
    ds_read_b128 v[36:39], v4 offset:8192
    s_waitcnt lgkmcnt(5)
    v_smfmac_f32_16x16x64_bf16 v[16:19], v[40:43], a[88:95], v11
    v_smfmac_f32_16x16x64_bf16 v[20:23], v[40:43], a[232:239], v11
    ds_read_b128 v[40:43], v4 offset:8704
    s_waitcnt lgkmcnt(5)
    v_smfmac_f32_16x16x64_bf16 v[16:19], v[44:47], a[96:103], v11
    v_smfmac_f32_16x16x64_bf16 v[20:23], v[44:47], a[240:247], v11
    s_waitcnt lgkmcnt(4)
    v_smfmac_f32_16x16x64_bf16 v[16:19], v[48:51], a[104:111], v11
    v_smfmac_f32_16x16x64_bf16 v[20:23], v[48:51], a[248:255], v11
    s_waitcnt lgkmcnt(3)
    v_smfmac_f32_16x16x64_bf16 v[16:19], v[28:31], a[112:119], v11
    v_smfmac_f32_16x16x64_bf16 v[20:23], v[28:31], v[80:87], v11
    s_waitcnt lgkmcnt(2)
    v_smfmac_f32_16x16x64_bf16 v[16:19], v[32:35], a[120:127], v11
    v_smfmac_f32_16x16x64_bf16 v[20:23], v[32:35], v[88:95], v11
    s_waitcnt lgkmcnt(1)
    v_smfmac_f32_16x16x64_bf16 v[16:19], v[36:39], a[128:135], v11
    v_smfmac_f32_16x16x64_bf16 v[20:23], v[36:39], v[96:103], v11
    s_waitcnt lgkmcnt(0)
    v_smfmac_f32_16x16x64_bf16 v[16:19], v[40:43], a[136:143], v11
    v_smfmac_f32_16x16x64_bf16 v[20:23], v[40:43], v[104:111], v11
    s_add_u32 s55, s20, 1
    s_and_b32 s54, s55, 3
    s_cmp_lg_u32 s54, 0
    s_cbranch_scc1 nq_21
    s_cmp_ge_u32 s55, 64
    s_cbranch_scc1 nq_21
    s_lshr_b32 s55, s55, 2
    s_cmp_lg_u32 s72, 0
    s_cbranch_scc1 wqd_24
    v_mov_b32 v13, 0
wq_23:
    global_load_dwordx4 v[52:55], v13, s[16:17] offset:32 sc1
    s_waitcnt vmcnt(0)
    v_readfirstlane_b32 s56, v52
    v_readfirstlane_b32 s57, v53
    v_readfirstlane_b32 s58, v54
    v_readfirstlane_b32 s59, v55
    s_and_b32 s60, s56, s57
    s_and_b32 s61, s58, s59
    s_and_b32 s60, s60, s61
    s_cmp_eq_u32 s60, 0x20202020
    s_cselect_b32 s72, 1, 0
    s_bitcmp1_b32 s55, 2
    s_cselect_b32 s56, s57, s56
    s_cselect_b32 s58, s59, s58
    s_bitcmp1_b32 s55, 3
    s_cselect_b32 s56, s58, s56
    s_and_b32 s57, s55, 3
    s_lshl_b32 s57, s57, 3
    s_lshr_b32 s56, s56, s57
    s_and_b32 s56, s56, 0xff
    s_cmp_lt_u32 s56, 32
    s_cbranch_scc1 wq_23
wqd_24:
nq_21:
    s_add_u32 s48, s40, 262144
    buffer_load_dword v12, v12, s[24:27], s48 offen
    v_smfmac_f32_16x16x64_bf16 v[24:27], v[40:43], v[248:255], v11
    ds_read_b128 v[40:43], v4 offset:5632
    v_smfmac_f32_16x16x64_bf16 v[24:27], v[36:39], v[240:247], v11
    ds_read_b128 v[36:39], v4 offset:5120
    v_cvt_pk_bf16_f32 v16, v16, v17
    v_cvt_pk_bf16_f32 v17, v18, v19
    v_cvt_pk_bf16_f32 v20, v20, v21
    v_cvt_pk_bf16_f32 v21, v22, v23
    v_add_u32 v13, s73, v4
    v_add_u32 v14, s73, v3
    ds_write2_b32 v14, v16, v17 offset0:0 offset1:16
    ds_write2_b32 v14, v20, v21 offset0:128 offset1:144
    ds_read_b128 v[52:55], v13
    buffer_store_dword v20, v3, s[24:27], s43 offen sc1
    buffer_store_dword v21, v3, s[24:27], s43 offen offset:64 sc1
    ds_read_b128 v[16:19], v5 offset:512
    v_smfmac_f32_16x16x64_bf16 v[24:27], v[32:35], v[232:239], v11
    ds_read_b128 v[32:35], v4 offset:4608
    v_smfmac_f32_16x16x64_bf16 v[24:27], v[28:31], v[224:231], v11
    ds_read_b128 v[28:31], v4 offset:4096
    v_smfmac_f32_16x16x64_bf16 v[24:27], v[48:51], v[216:223], v11
    ds_read_b128 v[48:51], v4 offset:3584
    v_smfmac_f32_16x16x64_bf16 v[24:27], v[44:47], v[208:215], v11
    ds_read_b128 v[44:47], v4 offset:3072
    s_waitcnt lgkmcnt(9)
    v_smfmac_f32_16x16x64_bf16 v[24:27], v[40:43], v[200:207], v11
    ds_read_b128 v[40:43], v4 offset:2560
    s_waitcnt vmcnt(3)
    s_waitcnt lgkmcnt(5)
    v_mfma_f32_16x16x32_bf16 v[20:23], v[56:59], v[52:55], 0
    v_mfma_f32_16x16x32_bf16 v[56:59], v[60:63], v[52:55], 0
    v_mfma_f32_16x16x32_bf16 v[60:63], v[16:19], v[52:55], 0
    v_smfmac_f32_16x16x64_bf16 v[24:27], v[36:39], v[192:199], v11
    ds_read_b128 v[36:39], v4 offset:2048
    s_waitcnt lgkmcnt(5)
    v_smfmac_f32_16x16x64_bf16 v[24:27], v[32:35], v[184:191], v11
    ds_read_b128 v[32:35], v4 offset:1536
    s_cmp_eq_u32 s20, 0
    s_cbranch_scc1 ns_25
    s_and_b32 s55, s20, 3
    s_cmp_gt_u32 s20, 56
    s_cselect_b32 s55, 0, s55
    s_cmp_lg_u32 s55, 0
    s_cbranch_scc1 ns_25
    s_sub_u32 s55, s20, 1
    s_cmp_lg_u32 s19, 0
    s_cbranch_scc1 sg_26
    s_lshl_b32 s57, s55, 7
    s_add_u32 s57, s57, 61874176
    v_mov_b32 v13, 0
    v_mov_b32 v14, 1
    s_mov_b64 exec, 1
    buffer_atomic_add v14, v13, s[24:27], s57 offen
    s_mov_b64 exec, -1
sg_26:
ns_25:
    v_add_u32 v13, s73, v0
    v_add_u32 v14, s73, v6
    v_cndmask_b32 v20, v20, v56, s[28:29]
    v_cndmask_b32 v21, v21, v57, s[28:29]
    v_cndmask_b32 v22, v22, v58, s[28:29]
    v_cndmask_b32 v23, v23, v59, s[28:29]
    ds_write_b128 v13, v[20:23]
    v_cndmask_b32 v60, v60, v62, s[28:29]
    v_cndmask_b32 v61, v61, v63, s[28:29]
    ds_write_b64 v14, v[60:61] offset:1024
    s_waitcnt lgkmcnt(7)
    v_smfmac_f32_16x16x64_bf16 v[24:27], v[28:31], v[176:183], v11
    ds_read_b128 v[28:31], v4 offset:1024
    s_waitcnt lgkmcnt(7)
    v_smfmac_f32_16x16x64_bf16 v[24:27], v[48:51], v[168:175], v11
    ds_read_b128 v[48:51], v4 offset:512
    s_waitcnt lgkmcnt(7)
    v_smfmac_f32_16x16x64_bf16 v[24:27], v[44:47], v[160:167], v11
    ds_read_b128 v[44:47], v4 offset:0
    s_waitcnt lgkmcnt(7)
    v_smfmac_f32_16x16x64_bf16 v[24:27], v[40:43], v[152:159], v11
    s_waitcnt lgkmcnt(3)
    s_barrier
    ds_read_b128 v[16:19], v0 offset:9216
    ds_read_b128 v[20:23], v0 offset:10752
    ds_read_b128 v[52:55], v0 offset:12288
    ds_read_b128 v[56:59], v0 offset:13824
    ds_read2st64_b64 v[60:63], v6 offset0:20 offset1:23
    ds_read_b64 v[14:15], v6 offset:13312
    v_smfmac_f32_16x16x64_bf16 v[24:27], v[36:39], v[144:151], v11
    v_smfmac_f32_16x16x64_bf16 v[24:27], v[32:35], v[136:143], v11
    s_waitcnt lgkmcnt(8)
    v_smfmac_f32_16x16x64_bf16 v[24:27], v[28:31], v[128:135], v11
    s_waitcnt lgkmcnt(7)
    v_smfmac_f32_16x16x64_bf16 v[24:27], v[48:51], v[120:127], v11
    s_waitcnt lgkmcnt(6)
    v_smfmac_f32_16x16x64_bf16 v[24:27], v[44:47], v[112:119], v11
    s_waitcnt lgkmcnt(0)
    v_add_f32 v16, v16, v20
    v_add_f32 v17, v17, v21
    v_add_f32 v18, v18, v22
    v_add_f32 v19, v19, v23
    ds_read_b64 v[22:23], v6 offset:14848
    v_add_f32 v52, v52, v56
    v_add_f32 v53, v53, v57
    v_add_f32 v54, v54, v58
    v_add_f32 v55, v55, v59
    v_add_f32 v20, v60, v62
    v_add_f32 v20, v20, v14
    v_add_f32 v21, v61, v63
    v_add_f32 v21, v21, v15
    v_add_f32 v16, v16, v52
    v_add_f32 v17, v17, v53
    v_add_f32 v18, v18, v54
    v_add_f32 v19, v19, v55
    ds_read_b128 v[56:59], v4 offset:15360
    ds_read_b128 v[60:63], v4 offset:15360
    s_waitcnt lgkmcnt(2)
    v_add_f32 v20, v20, v22
    v_add_f32 v21, v21, v23
    v_add_u32 v15, s41, v0
    ds_read_b128 v[36:39], v15 offset:0
    ds_read_b128 v[40:43], v15 offset:1024
    ds_read_b128 v[44:47], v15 offset:2048
    ds_read_b128 v[48:51], v15 offset:3072
    v_max3_f32 v13, v16, v17, v18
    v_max3_f32 v13, v13, v19, v20
    v_max_f32 v13, v13, v21
    v_cvt_pk_bf16_f32 v28, v24, v26
    v_cvt_pk_bf16_f32 v29, v24, v26
    v_max_f32_dpp v13, v13, v13 quad_perm:[1,0,3,2] row_mask:0xf bank_mask:0xf
    v_mov_b32 v14, v13
    v_cvt_pk_bf16_f32 v30, v24, v26
    buffer_store_dword v30, v3, s[24:27], s43 offen offset:512 sc1
    v_permlane16_swap_b32 v14, v13
    v_max_f32 v13, v13, v14
    v_mov_b32 v14, v13
    v_cvt_pk_bf16_f32 v32, v25, v27
    v_cvt_pk_bf16_f32 v33, v25, v27
    v_permlane32_swap_b32 v14, v13
    v_max_f32 v13, v13, v14
    v_mul_f32 v13, s35, v13
    v_fma_f32 v16, v16, s35, -v13
    v_fma_f32 v17, v17, s35, -v13
    v_fma_f32 v18, v18, s35, -v13
    v_fma_f32 v19, v19, s35, -v13
    v_fma_f32 v20, v20, s35, -v13
    v_fma_f32 v21, v21, s35, -v13
    v_exp_f32 v16, v16
    v_exp_f32 v17, v17
    v_exp_f32 v18, v18
    v_exp_f32 v19, v19
    v_exp_f32 v20, v20
    v_exp_f32 v21, v21
    v_add_f32 v13, v16, v17
    v_add_f32 v14, v18, v19
    v_cndmask_b32 v20, v20, 0, s[32:33]
    v_cndmask_b32 v21, v21, 0, s[32:33]
    v_add_f32 v13, v13, v20
    v_add_f32 v14, v14, v21
    v_add_f32 v13, v13, v14
    v_cvt_pk_bf16_f32 v34, v25, v27
    buffer_store_dword v34, v3, s[24:27], s43 offen offset:576 sc1
    v_add_f32_dpp v13, v13, v13 quad_perm:[1,0,3,2] row_mask:0xf bank_mask:0xf
    v_mov_b32 v14, v13
    v_permlane16_swap_b32 v28, v29
    v_permlane16_swap_b32 v32, v33
    v_permlane16_swap_b32 v14, v13
    v_add_f32 v13, v13, v14
    v_mov_b32 v14, v13
    v_cndmask_b32 v64, v64, v28, s[30:31]
    v_cndmask_b32 v65, v65, v29, s[30:31]
    v_permlane32_swap_b32 v14, v13
    v_add_f32 v13, v13, v14
    v_rcp_f32 v13, v13
    v_cndmask_b32 v72, v72, v32, s[30:31]
    v_cndmask_b32 v73, v73, v33, s[30:31]
    v_mul_f32 v16, v16, v13
    v_mul_f32 v17, v17, v13
    v_mul_f32 v18, v18, v13
    v_mul_f32 v19, v19, v13
    v_mul_f32 v20, v20, v13
    v_mul_f32 v21, v21, v13
    v_cvt_pk_bf16_f32 v52, v16, v17
    v_cvt_pk_bf16_f32 v53, v18, v19
    v_cvt_pk_bf16_f32 v54, v20, v21
    v_mov_b32 v55, 0
    s_cmp_eq_u32 s20, 63
    s_cbranch_scc1 chain_done_27
    s_waitcnt lgkmcnt(4)
    v_smfmac_f32_16x16x64_bf16 v[56:59], v[52:55], v[64:71], v11
    v_smfmac_f32_16x16x64_bf16 v[60:63], v[52:55], v[72:79], v11
    ds_read_b128 v[28:31], v15 offset:4096
    ds_read_b128 v[32:35], v15 offset:5120
    ds_read_b128 v[64:67], v15 offset:6144
    ds_read_b128 v[68:71], v15 offset:7168
    v_add_u32 v14, s74, v3
    s_nop 1
    v_add_f32 v56, v56, v57
    v_add_f32 v57, v58, v59
    v_add_f32 v60, v60, v61
    v_add_f32 v61, v62, v63
    v_cvt_pk_bf16_f32 v58, v56, v60
    v_cvt_pk_bf16_f32 v59, v57, v61
    ds_write2_b32 v14, v58, v59 offset0:0 offset1:16
    ds_read_b128 v[56:59], v4 offset:15360
    ds_read_b128 v[60:63], v4 offset:15360
    ds_read_b128 v[72:75], v4 offset:15360
    ds_read_b128 v[76:79], v4 offset:15360
    s_waitcnt lgkmcnt(4)
    s_barrier
    ds_read_b128 v[16:19], v4 offset:6144
    ds_read_b128 v[20:23], v4 offset:6656
    ds_read_b128 v[24:27], v4 offset:7168
    ds_read_b128 v[52:55], v4 offset:7680
    s_waitcnt lgkmcnt(3)
    v_smfmac_f32_16x16x64_bf16 v[56:59], v[16:19], v[36:43], v11
    ds_read_b128 v[36:39], v15 offset:32768
    ds_read_b128 v[40:43], v15 offset:33792
    s_waitcnt lgkmcnt(4)
    v_smfmac_f32_16x16x64_bf16 v[56:59], v[20:23], v[44:51], v11
    ds_read_b128 v[44:47], v15 offset:34816
    ds_read_b128 v[48:51], v15 offset:35840
    s_waitcnt lgkmcnt(5)
    v_smfmac_f32_16x16x64_bf16 v[56:59], v[24:27], v[28:35], v11
    ds_read_b128 v[28:31], v15 offset:36864
    ds_read_b128 v[32:35], v15 offset:37888
    s_waitcnt lgkmcnt(6)
    v_smfmac_f32_16x16x64_bf16 v[56:59], v[52:55], v[64:71], v11
    ds_read_b128 v[64:67], v15 offset:38912
    ds_read_b128 v[68:71], v15 offset:39936
    s_waitcnt lgkmcnt(6)
    v_smfmac_f32_16x16x64_bf16 v[60:63], v[16:19], v[36:43], v11
    v_add_u32 v15, 65536, v15
    ds_read_b128 v[36:39], v15 offset:0
    ds_read_b128 v[40:43], v15 offset:1024
    s_waitcnt lgkmcnt(6)
    v_smfmac_f32_16x16x64_bf16 v[60:63], v[20:23], v[44:51], v11
    ds_read_b128 v[44:47], v15 offset:2048
    ds_read_b128 v[48:51], v15 offset:3072
    v_cvt_pk_bf16_f32 v56, v56, v57
    v_cvt_pk_bf16_f32 v57, v58, v59
    v_and_or_b32 v56, v56, -2, s34
    buffer_store_dwordx2 v[56:57], v7, s[24:27], s64 offen
    s_nop 0
    ds_read_b128 v[56:59], v4 offset:15360
    s_waitcnt lgkmcnt(7)
    v_smfmac_f32_16x16x64_bf16 v[60:63], v[24:27], v[28:35], v11
    ds_read_b128 v[28:31], v15 offset:4096
    ds_read_b128 v[32:35], v15 offset:5120
    s_waitcnt lgkmcnt(7)
    v_smfmac_f32_16x16x64_bf16 v[60:63], v[52:55], v[64:71], v11
    ds_read_b128 v[64:67], v15 offset:6144
    ds_read_b128 v[68:71], v15 offset:7168
    s_waitcnt lgkmcnt(7)
    v_smfmac_f32_16x16x64_bf16 v[72:75], v[16:19], v[36:43], v11
    ds_read_b128 v[36:39], v15 offset:32768
    ds_read_b128 v[40:43], v15 offset:33792
    s_waitcnt lgkmcnt(7)
    v_smfmac_f32_16x16x64_bf16 v[72:75], v[20:23], v[44:51], v11
    ds_read_b128 v[44:47], v15 offset:34816
    ds_read_b128 v[48:51], v15 offset:35840
    v_cvt_pk_bf16_f32 v60, v60, v61
    v_cvt_pk_bf16_f32 v61, v62, v63
    v_and_or_b32 v60, v60, -2, s34
    buffer_store_dwordx2 v[60:61], v7, s[24:27], s65 offen
    s_waitcnt lgkmcnt(6)
    v_smfmac_f32_16x16x64_bf16 v[72:75], v[24:27], v[28:35], v11
    ds_read_b128 v[28:31], v15 offset:36864
    ds_read_b128 v[32:35], v15 offset:37888
    s_waitcnt lgkmcnt(6)
    v_smfmac_f32_16x16x64_bf16 v[72:75], v[52:55], v[64:71], v11
    ds_read_b128 v[64:67], v15 offset:38912
    ds_read_b128 v[68:71], v15 offset:39936
    s_waitcnt lgkmcnt(6)
    v_smfmac_f32_16x16x64_bf16 v[76:79], v[16:19], v[36:43], v11
    v_add_u32 v15, 65536, v15
    ds_read_b128 v[36:39], v15 offset:0
    ds_read_b128 v[40:43], v15 offset:1024
    s_waitcnt lgkmcnt(6)
    v_smfmac_f32_16x16x64_bf16 v[76:79], v[20:23], v[44:51], v11
    ds_read_b128 v[44:47], v15 offset:2048
    ds_read_b128 v[48:51], v15 offset:3072
    v_cvt_pk_bf16_f32 v72, v72, v73
    v_cvt_pk_bf16_f32 v73, v74, v75
    v_and_or_b32 v72, v72, -2, s34
    buffer_store_dwordx2 v[72:73], v7, s[24:27], s66 offen
    s_waitcnt lgkmcnt(6)
    v_smfmac_f32_16x16x64_bf16 v[76:79], v[24:27], v[28:35], v11
    ds_read_b128 v[28:31], v15 offset:4096
    ds_read_b128 v[32:35], v15 offset:5120
    s_waitcnt lgkmcnt(6)
    v_smfmac_f32_16x16x64_bf16 v[76:79], v[52:55], v[64:71], v11
    ds_read_b128 v[64:67], v15 offset:6144
    ds_read_b128 v[68:71], v15 offset:7168
    s_nop 5
    v_cvt_pk_bf16_f32 v76, v76, v77
    v_cvt_pk_bf16_f32 v77, v78, v79
    v_and_or_b32 v76, v76, -2, s34
    buffer_store_dwordx2 v[76:77], v7, s[24:27], s67 offen
    s_waitcnt lgkmcnt(0)
    s_cmp_ge_u32 s19, 2
    s_cbranch_scc1 wo_last_28
    v_smfmac_f32_16x16x64_bf16 v[56:59], v[16:19], v[36:43], v11
    v_smfmac_f32_16x16x64_bf16 v[56:59], v[20:23], v[44:51], v11
    v_smfmac_f32_16x16x64_bf16 v[56:59], v[24:27], v[28:35], v11
    v_smfmac_f32_16x16x64_bf16 v[56:59], v[52:55], v[64:71], v11
    s_nop 7
    v_cvt_pk_bf16_f32 v56, v56, v57
    v_cvt_pk_bf16_f32 v57, v58, v59
    v_and_or_b32 v56, v56, -2, s34
    buffer_store_dwordx2 v[56:57], v7, s[24:27], s68 offen
wo_last_28:
    s_add_u32 s40, s40, 262144
    s_add_u32 s42, s42, 262144
    s_add_u32 s43, s43, 131072
    s_add_u32 s52, s39, s69
    s_add_u32 s53, s39, s70
    s_cmp_eq_u32 s71, 0
    s_cbranch_scc1 poll1_30
unit2_31:
    buffer_load_dwordx4 v[64:67], v0, s[24:27], s45 offen offset:0 sc1
    buffer_load_dwordx4 v[68:71], v0, s[24:27], s45 offen offset:1024 sc1
    buffer_load_dwordx4 v[28:31], v0, s[24:27], s46 offen offset:0 sc1
    buffer_load_dwordx4 v[32:35], v0, s[24:27], s46 offen offset:1024 sc1
    s_waitcnt vmcnt(2)
    v_bitop3_b32 v13, v64, v66, s34 bitop3:0x7e
    v_bitop3_b32 v14, v68, v70, s34 bitop3:0x7e
    v_bitop3_b32 v13, v13, v14, 1 bitop3:0xa8
    v_cmp_ne_u32 vcc, 0, v13
    v_lshlrev_b32 v72, 16, v64
    v_lshlrev_b32 v76, 16, v68
    v_lshlrev_b32 v73, 16, v65
    v_lshlrev_b32 v77, 16, v69
    v_lshlrev_b32 v74, 16, v66
    v_lshlrev_b32 v78, 16, v70
    v_lshlrev_b32 v75, 16, v67
    v_lshlrev_b32 v79, 16, v71
    s_mov_b64 s[56:57], vcc
    s_waitcnt vmcnt(0)
    v_bitop3_b32 v13, v28, v30, s34 bitop3:0x7e
    v_bitop3_b32 v14, v32, v34, s34 bitop3:0x7e
    v_bitop3_b32 v13, v13, v14, 1 bitop3:0xa8
    v_cmp_ne_u32 vcc, 0, v13
    v_lshlrev_b32 v36, 16, v28
    v_lshlrev_b32 v40, 16, v32
    v_lshlrev_b32 v37, 16, v29
    v_lshlrev_b32 v41, 16, v33
    v_lshlrev_b32 v38, 16, v30
    v_lshlrev_b32 v42, 16, v34
    v_lshlrev_b32 v39, 16, v31
    v_lshlrev_b32 v43, 16, v35
    s_or_b64 vcc, vcc, s[56:57]
    s_cbranch_vccnz unit2_31
    v_add_f32 v72, v72, v76
    v_add_f32 v73, v73, v77
    v_add_f32 v74, v74, v78
    v_add_f32 v75, v75, v79
    v_and_b32 v64, 0xffff0000, v64
    v_and_b32 v68, 0xffff0000, v68
    v_and_b32 v65, 0xffff0000, v65
    v_and_b32 v69, 0xffff0000, v69
    v_and_b32 v66, 0xffff0000, v66
    v_and_b32 v70, 0xffff0000, v70
    v_and_b32 v67, 0xffff0000, v67
    v_and_b32 v71, 0xffff0000, v71
    v_permlane32_swap_b32 v72, v74
    v_permlane32_swap_b32 v73, v75
    v_add_f32 v64, v64, v68
    v_add_f32 v65, v65, v69
    v_add_f32 v66, v66, v70
    v_add_f32 v67, v67, v71
    v_add_f32 v72, v72, v74
    v_add_f32 v73, v73, v75
    v_permlane32_swap_b32 v64, v66
    v_permlane32_swap_b32 v65, v67
    v_permlane16_swap_b32 v72, v73
    v_add_f32 v64, v64, v66
    v_add_f32 v65, v65, v67
    v_add_f32 v72, v72, v73
    s_nop 0
    v_permlane16_swap_b32 v64, v65
    v_add_f32_dpp v72, v72, v72 row_ror:8 row_mask:0xf bank_mask:0xf
    v_add_f32 v64, v64, v65
    s_nop 0
    v_add_f32_dpp v72, v72, v72 row_ror:4 row_mask:0xf bank_mask:0xf
    v_add_f32_dpp v64, v64, v64 row_ror:8 row_mask:0xf bank_mask:0xf
    s_nop 1
    v_add_f32_dpp v64, v64, v64 row_ror:4 row_mask:0xf bank_mask:0xf
    v_cvt_pk_bf16_f32 v66, v72, v64
    v_min_u32 v66, 0xfffffffe, v66
    buffer_store_dword v66, v8, s[24:27], s52 offen
    v_add_f32 v36, v36, v40
    v_add_f32 v37, v37, v41
    v_add_f32 v38, v38, v42
    v_add_f32 v39, v39, v43
    s_add_u32 s54, s39, 4096
    s_add_u32 s55, s39, 8192
    buffer_load_dwordx4 v[56:59], v1, s[24:27], s39 offen sc1
    buffer_load_dwordx4 v[60:63], v1, s[24:27], s54 offen sc1
    buffer_load_dword v79, v2, s[24:27], s55 offen sc1
    v_and_b32 v28, 0xffff0000, v28
    v_and_b32 v32, 0xffff0000, v32
    v_and_b32 v29, 0xffff0000, v29
    v_and_b32 v33, 0xffff0000, v33
    v_and_b32 v30, 0xffff0000, v30
    v_and_b32 v34, 0xffff0000, v34
    v_and_b32 v31, 0xffff0000, v31
    v_and_b32 v35, 0xffff0000, v35
    v_permlane32_swap_b32 v36, v38
    v_permlane32_swap_b32 v37, v39
    v_add_f32 v28, v28, v32
    v_add_f32 v29, v29, v33
    v_add_f32 v30, v30, v34
    v_add_f32 v31, v31, v35
    v_add_f32 v36, v36, v38
    v_add_f32 v37, v37, v39
    v_permlane32_swap_b32 v28, v30
    v_permlane32_swap_b32 v29, v31
    v_permlane16_swap_b32 v36, v37
    v_add_f32 v28, v28, v30
    v_add_f32 v29, v29, v31
    v_add_f32 v36, v36, v37
    s_nop 0
    v_permlane16_swap_b32 v28, v29
    v_add_f32_dpp v36, v36, v36 row_ror:8 row_mask:0xf bank_mask:0xf
    v_add_f32 v28, v28, v29
    s_nop 0
    v_add_f32_dpp v36, v36, v36 row_ror:4 row_mask:0xf bank_mask:0xf
    v_add_f32_dpp v28, v28, v28 row_ror:8 row_mask:0xf bank_mask:0xf
    s_nop 1
    v_add_f32_dpp v28, v28, v28 row_ror:4 row_mask:0xf bank_mask:0xf
    v_cvt_pk_bf16_f32 v30, v36, v28
    v_min_u32 v30, 0xfffffffe, v30
    buffer_store_dword v30, v8, s[24:27], s53 offen
    s_branch red_end_29
poll1_30:
    s_branch okA_35
pr_34:
okA_35:
    buffer_load_dwordx4 v[64:67], v0, s[24:27], s45 offen offset:0 sc1
    buffer_load_dwordx4 v[68:71], v0, s[24:27], s45 offen offset:1024 sc1
    s_waitcnt vmcnt(0)
    v_bitop3_b32 v13, v64, v66, s34 bitop3:0x7e
    v_bitop3_b32 v14, v68, v70, s34 bitop3:0x7e
    v_bitop3_b32 v13, v13, v14, 1 bitop3:0xa8
    v_cmp_ne_u32 vcc, 0, v13
    v_lshlrev_b32 v72, 16, v64
    v_lshlrev_b32 v76, 16, v68
    v_lshlrev_b32 v73, 16, v65
    v_lshlrev_b32 v77, 16, v69
    v_lshlrev_b32 v74, 16, v66
    v_lshlrev_b32 v78, 16, v70
    v_lshlrev_b32 v75, 16, v67
    v_lshlrev_b32 v79, 16, v71
    s_cbranch_vccnz pr_34
    v_add_f32 v72, v72, v76
    v_add_f32 v73, v73, v77
    v_add_f32 v74, v74, v78
    v_add_f32 v75, v75, v79
    s_add_u32 s54, s39, 4096
    s_add_u32 s55, s39, 8192
    buffer_load_dwordx4 v[56:59], v1, s[24:27], s39 offen sc1
    buffer_load_dwordx4 v[60:63], v1, s[24:27], s54 offen sc1
    buffer_load_dword v79, v2, s[24:27], s55 offen sc1
    v_and_b32 v64, 0xffff0000, v64
    v_and_b32 v68, 0xffff0000, v68
    v_and_b32 v65, 0xffff0000, v65
    v_and_b32 v69, 0xffff0000, v69
    v_and_b32 v66, 0xffff0000, v66
    v_and_b32 v70, 0xffff0000, v70
    v_and_b32 v67, 0xffff0000, v67
    v_and_b32 v71, 0xffff0000, v71
    v_permlane32_swap_b32 v72, v74
    v_permlane32_swap_b32 v73, v75
    v_add_f32 v64, v64, v68
    v_add_f32 v65, v65, v69
    v_add_f32 v66, v66, v70
    v_add_f32 v67, v67, v71
    v_add_f32 v72, v72, v74
    v_add_f32 v73, v73, v75
    v_permlane32_swap_b32 v64, v66
    v_permlane32_swap_b32 v65, v67
    v_permlane16_swap_b32 v72, v73
    v_add_f32 v64, v64, v66
    v_add_f32 v65, v65, v67
    v_add_f32 v72, v72, v73
    s_nop 0
    v_permlane16_swap_b32 v64, v65
    v_add_f32_dpp v72, v72, v72 row_ror:8 row_mask:0xf bank_mask:0xf
    v_add_f32 v64, v64, v65
    s_nop 0
    v_add_f32_dpp v72, v72, v72 row_ror:4 row_mask:0xf bank_mask:0xf
    v_add_f32_dpp v64, v64, v64 row_ror:8 row_mask:0xf bank_mask:0xf
    s_nop 1
    v_add_f32_dpp v64, v64, v64 row_ror:4 row_mask:0xf bank_mask:0xf
    v_cvt_pk_bf16_f32 v66, v72, v64
    v_min_u32 v66, 0xfffffffe, v66
    buffer_store_dword v66, v8, s[24:27], s52 offen
    s_branch red_end_29
red_end_29:
nd_37:
    s_add_u32 s36, s36, 9216
    s_add_u32 s37, s37, 9216
    s_add_u32 s38, s38, 9216
    s_add_u32 s39, s39, 9216
    s_xor_b32 s34, s34, 1
    s_add_u32 s20, s20, 1
    s_waitcnt lgkmcnt(0)
    s_branch step_18
step_18_s:
    ds_read_b128 v[16:19], v4 offset:15360
    ds_read_b128 v[20:23], v4 offset:15360
    ds_read_b128 v[24:27], v4 offset:15360
    v_mov_b32 v15, 16777216
    v_and_b32 v13, 0xf0, v0
    v_lshlrev_b32 v13, 3, v13
    v_cndmask_b32 v14, 0, v15, s[30:31]
    v_add3_u32 v12, v13, v14, s44
    s_mul_i32 s48, s19, 2304
    s_add_u32 s48, s48, s39
    s_add_u32 s48, s48, 0
    s_sub_u32 s48, s48, s40
    s_sub_u32 s48, s48, 262144
    v_and_b32 v13, 0x1f0, v0
    v_min_u32 v13, 272, v13
    v_lshl_add_u32 v13, v13, 3, s48
    v_cndmask_b32 v12, v12, v13, s[32:33]
    s_waitcnt vmcnt(1)
    v_max3_u32 v13, v56, v57, v58
    v_max3_u32 v14, v59, v60, v61
    v_max3_u32 v13, v13, v62, v63
    v_max3_u32 v13, v13, v14, v79
    v_cmp_eq_u32 vcc, -1, v13
    s_cbranch_vccz p0ok_20_s
p0_19_s:
    buffer_load_dwordx4 v[56:59], v1, s[24:27], s36 offen sc1
    buffer_load_dwordx4 v[60:63], v1, s[24:27], s37 offen sc1
    buffer_load_dword v79, v2, s[24:27], s38 offen sc1
    s_waitcnt vmcnt(0)
    v_max3_u32 v13, v56, v57, v58
    v_max3_u32 v14, v59, v60, v61
    v_max3_u32 v13, v13, v62, v63
    v_max3_u32 v13, v13, v14, v79
    v_cmp_eq_u32 vcc, -1, v13
    s_cbranch_vccnz p0_19_s
p0ok_20_s:
    ds_write_b128 v1, v[56:59] offset:0
    ds_write_b128 v1, v[60:63] offset:4096
    ds_write_b32 v2, v79 offset:8192
    s_waitcnt lgkmcnt(0)
    s_barrier
    ds_read_b128 v[44:47], v4 offset:0
    ds_read_b128 v[48:51], v4 offset:512
    ds_read_b128 v[28:31], v4 offset:1024
    ds_read_b128 v[32:35], v4 offset:1536
    ds_read_b128 v[36:39], v4 offset:2048
    ds_read_b128 v[40:43], v4 offset:2560
    s_waitcnt lgkmcnt(5)
    v_smfmac_f32_16x16x64_bf16 v[16:19], v[44:47], a[0:7], v11
    v_smfmac_f32_16x16x64_bf16 v[20:23], v[44:47], a[144:151], v11
    ds_read_b128 v[44:47], v4 offset:3072
    s_waitcnt lgkmcnt(5)
    v_smfmac_f32_16x16x64_bf16 v[16:19], v[48:51], a[8:15], v11
    v_smfmac_f32_16x16x64_bf16 v[20:23], v[48:51], a[152:159], v11
    ds_read_b128 v[48:51], v4 offset:3584
    s_waitcnt lgkmcnt(5)
    v_smfmac_f32_16x16x64_bf16 v[16:19], v[28:31], a[16:23], v11
    v_smfmac_f32_16x16x64_bf16 v[20:23], v[28:31], a[160:167], v11
    ds_read_b128 v[28:31], v4 offset:4096
    buffer_load_dwordx4 v[56:59], v9, s[24:27], s40 offen
    buffer_load_dwordx4 v[60:63], v9, s[24:27], s40 offen offset:1024
    s_waitcnt lgkmcnt(5)
    v_smfmac_f32_16x16x64_bf16 v[16:19], v[32:35], a[24:31], v11
    v_smfmac_f32_16x16x64_bf16 v[20:23], v[32:35], a[168:175], v11
    ds_read_b128 v[32:35], v4 offset:4608
    buffer_load_dwordx4 v[64:67], v10, s[24:27], s42 offen
    buffer_load_dwordx4 v[68:71], v10, s[24:27], s42 offen offset:512
    s_waitcnt lgkmcnt(5)
    v_smfmac_f32_16x16x64_bf16 v[16:19], v[36:39], a[32:39], v11
    v_smfmac_f32_16x16x64_bf16 v[20:23], v[36:39], a[176:183], v11
    ds_read_b128 v[36:39], v4 offset:5120
    buffer_load_dwordx4 v[72:75], v10, s[24:27], s42 offen offset:1024
    buffer_load_dwordx4 v[76:79], v10, s[24:27], s42 offen offset:1536
    s_waitcnt lgkmcnt(5)
    v_smfmac_f32_16x16x64_bf16 v[16:19], v[40:43], a[40:47], v11
    v_smfmac_f32_16x16x64_bf16 v[20:23], v[40:43], a[184:191], v11
    ds_read_b128 v[40:43], v4 offset:5632
    s_waitcnt lgkmcnt(5)
    v_smfmac_f32_16x16x64_bf16 v[16:19], v[44:47], a[48:55], v11
    v_smfmac_f32_16x16x64_bf16 v[20:23], v[44:47], a[192:199], v11
    ds_read_b128 v[44:47], v4 offset:6144
    s_waitcnt lgkmcnt(5)
    v_smfmac_f32_16x16x64_bf16 v[16:19], v[48:51], a[56:63], v11
    v_smfmac_f32_16x16x64_bf16 v[20:23], v[48:51], a[200:207], v11
    ds_read_b128 v[48:51], v4 offset:6656
    s_waitcnt lgkmcnt(5)
    v_smfmac_f32_16x16x64_bf16 v[16:19], v[28:31], a[64:71], v11
    v_smfmac_f32_16x16x64_bf16 v[20:23], v[28:31], a[208:215], v11
    ds_read_b128 v[28:31], v4 offset:7168
    s_waitcnt lgkmcnt(5)
    v_smfmac_f32_16x16x64_bf16 v[16:19], v[32:35], a[72:79], v11
    v_smfmac_f32_16x16x64_bf16 v[20:23], v[32:35], a[216:223], v11
    ds_read_b128 v[32:35], v4 offset:7680
    s_waitcnt lgkmcnt(5)
    v_smfmac_f32_16x16x64_bf16 v[16:19], v[36:39], a[80:87], v11
    v_smfmac_f32_16x16x64_bf16 v[20:23], v[36:39], a[224:231], v11
    ds_read_b128 v[36:39], v4 offset:8192
    s_waitcnt lgkmcnt(5)
    v_smfmac_f32_16x16x64_bf16 v[16:19], v[40:43], a[88:95], v11
    v_smfmac_f32_16x16x64_bf16 v[20:23], v[40:43], a[232:239], v11
    ds_read_b128 v[40:43], v4 offset:8704
    s_waitcnt lgkmcnt(5)
    v_smfmac_f32_16x16x64_bf16 v[16:19], v[44:47], a[96:103], v11
    v_smfmac_f32_16x16x64_bf16 v[20:23], v[44:47], a[240:247], v11
    s_waitcnt lgkmcnt(4)
    v_smfmac_f32_16x16x64_bf16 v[16:19], v[48:51], a[104:111], v11
    v_smfmac_f32_16x16x64_bf16 v[20:23], v[48:51], a[248:255], v11
    s_waitcnt lgkmcnt(3)
    v_smfmac_f32_16x16x64_bf16 v[16:19], v[28:31], a[112:119], v11
    v_smfmac_f32_16x16x64_bf16 v[20:23], v[28:31], v[80:87], v11
    s_waitcnt lgkmcnt(2)
    v_smfmac_f32_16x16x64_bf16 v[16:19], v[32:35], a[120:127], v11
    v_smfmac_f32_16x16x64_bf16 v[20:23], v[32:35], v[88:95], v11
    s_waitcnt lgkmcnt(1)
    v_smfmac_f32_16x16x64_bf16 v[16:19], v[36:39], a[128:135], v11
    v_smfmac_f32_16x16x64_bf16 v[20:23], v[36:39], v[96:103], v11
    s_waitcnt lgkmcnt(0)
    v_smfmac_f32_16x16x64_bf16 v[16:19], v[40:43], a[136:143], v11
    v_smfmac_f32_16x16x64_bf16 v[20:23], v[40:43], v[104:111], v11
    s_add_u32 s55, s20, 1
    s_and_b32 s54, s55, 3
    s_cmp_lg_u32 s54, 0
    s_cbranch_scc1 nq_21_s
    s_cmp_ge_u32 s55, 64
    s_cbranch_scc1 nq_21_s
    s_lshr_b32 s55, s55, 2
    s_cmp_lg_u32 s72, 0
    s_cbranch_scc1 wqd_24_s
    v_mov_b32 v13, 0
wq_23_s:
    global_load_dwordx4 v[52:55], v13, s[16:17] offset:32 sc1
    s_waitcnt vmcnt(0)
    v_readfirstlane_b32 s56, v52
    v_readfirstlane_b32 s57, v53
    v_readfirstlane_b32 s58, v54
    v_readfirstlane_b32 s59, v55
    s_and_b32 s60, s56, s57
    s_and_b32 s61, s58, s59
    s_and_b32 s60, s60, s61
    s_cmp_eq_u32 s60, 0x20202020
    s_cselect_b32 s72, 1, 0
    s_bitcmp1_b32 s55, 2
    s_cselect_b32 s56, s57, s56
    s_cselect_b32 s58, s59, s58
    s_bitcmp1_b32 s55, 3
    s_cselect_b32 s56, s58, s56
    s_and_b32 s57, s55, 3
    s_lshl_b32 s57, s57, 3
    s_lshr_b32 s56, s56, s57
    s_and_b32 s56, s56, 0xff
    s_cmp_lt_u32 s56, 32
    s_cbranch_scc1 wq_23_s
wqd_24_s:
nq_21_s:
    s_add_u32 s48, s40, 262144
    buffer_load_dword v12, v12, s[24:27], s48 offen
    v_smfmac_f32_16x16x64_bf16 v[24:27], v[40:43], v[248:255], v11
    ds_read_b128 v[40:43], v4 offset:5632
    v_smfmac_f32_16x16x64_bf16 v[24:27], v[36:39], v[240:247], v11
    ds_read_b128 v[36:39], v4 offset:5120
    v_cvt_pk_bf16_f32 v16, v16, v17
    v_cvt_pk_bf16_f32 v17, v18, v19
    v_cvt_pk_bf16_f32 v20, v20, v21
    v_cvt_pk_bf16_f32 v21, v22, v23
    v_add_u32 v13, s73, v4
    v_add_u32 v14, s73, v3
    ds_write2_b32 v14, v16, v17 offset0:0 offset1:16
    ds_write2_b32 v14, v20, v21 offset0:128 offset1:144
    ds_read_b128 v[52:55], v13
    buffer_store_dword v20, v3, s[24:27], s43 offen sc1
    buffer_store_dword v21, v3, s[24:27], s43 offen offset:64 sc1
    ds_read_b128 v[16:19], v5 offset:512
    v_smfmac_f32_16x16x64_bf16 v[24:27], v[32:35], v[232:239], v11
    ds_read_b128 v[32:35], v4 offset:4608
    v_smfmac_f32_16x16x64_bf16 v[24:27], v[28:31], v[224:231], v11
    ds_read_b128 v[28:31], v4 offset:4096
    v_smfmac_f32_16x16x64_bf16 v[24:27], v[48:51], v[216:223], v11
    ds_read_b128 v[48:51], v4 offset:3584
    v_smfmac_f32_16x16x64_bf16 v[24:27], v[44:47], v[208:215], v11
    ds_read_b128 v[44:47], v4 offset:3072
    s_waitcnt lgkmcnt(9)
    v_smfmac_f32_16x16x64_bf16 v[24:27], v[40:43], v[200:207], v11
    ds_read_b128 v[40:43], v4 offset:2560
    s_waitcnt vmcnt(3)
    s_waitcnt lgkmcnt(5)
    v_mfma_f32_16x16x32_bf16 v[20:23], v[56:59], v[52:55], 0
    v_mfma_f32_16x16x32_bf16 v[56:59], v[60:63], v[52:55], 0
    v_mfma_f32_16x16x32_bf16 v[60:63], v[16:19], v[52:55], 0
    v_smfmac_f32_16x16x64_bf16 v[24:27], v[36:39], v[192:199], v11
    ds_read_b128 v[36:39], v4 offset:2048
    s_waitcnt lgkmcnt(5)
    v_smfmac_f32_16x16x64_bf16 v[24:27], v[32:35], v[184:191], v11
    ds_read_b128 v[32:35], v4 offset:1536
    s_cmp_eq_u32 s20, 0
    s_cbranch_scc1 ns_25_s
    s_and_b32 s55, s20, 3
    s_cmp_gt_u32 s20, 56
    s_cselect_b32 s55, 0, s55
    s_cmp_lg_u32 s55, 0
    s_cbranch_scc1 ns_25_s
    s_sub_u32 s55, s20, 1
    s_cmp_lg_u32 s19, 0
    s_cbranch_scc1 sg_26_s
    s_lshl_b32 s57, s55, 7
    s_add_u32 s57, s57, 61874176
    v_mov_b32 v13, 0
    v_mov_b32 v14, 1
    s_mov_b64 exec, 1
    buffer_atomic_add v14, v13, s[24:27], s57 offen
    s_mov_b64 exec, -1
sg_26_s:
ns_25_s:
    v_add_u32 v13, s73, v0
    v_add_u32 v14, s73, v6
    v_cndmask_b32 v20, v20, v56, s[28:29]
    v_cndmask_b32 v21, v21, v57, s[28:29]
    v_cndmask_b32 v22, v22, v58, s[28:29]
    v_cndmask_b32 v23, v23, v59, s[28:29]
    ds_write_b128 v13, v[20:23]
    v_cndmask_b32 v60, v60, v62, s[28:29]
    v_cndmask_b32 v61, v61, v63, s[28:29]
    ds_write_b64 v14, v[60:61] offset:1024
    s_waitcnt lgkmcnt(7)
    v_smfmac_f32_16x16x64_bf16 v[24:27], v[28:31], v[176:183], v11
    ds_read_b128 v[28:31], v4 offset:1024
    s_waitcnt lgkmcnt(7)
    v_smfmac_f32_16x16x64_bf16 v[24:27], v[48:51], v[168:175], v11
    ds_read_b128 v[48:51], v4 offset:512
    s_waitcnt lgkmcnt(7)
    v_smfmac_f32_16x16x64_bf16 v[24:27], v[44:47], v[160:167], v11
    ds_read_b128 v[44:47], v4 offset:0
    s_waitcnt lgkmcnt(7)
    v_smfmac_f32_16x16x64_bf16 v[24:27], v[40:43], v[152:159], v11
    s_waitcnt lgkmcnt(3)
    s_barrier
    ds_read_b128 v[16:19], v0 offset:9216
    ds_read_b128 v[20:23], v0 offset:10752
    ds_read_b128 v[52:55], v0 offset:12288
    ds_read_b128 v[56:59], v0 offset:13824
    ds_read2st64_b64 v[60:63], v6 offset0:20 offset1:23
    ds_read_b64 v[14:15], v6 offset:13312
    v_smfmac_f32_16x16x64_bf16 v[24:27], v[36:39], v[144:151], v11
    v_smfmac_f32_16x16x64_bf16 v[24:27], v[32:35], v[136:143], v11
    s_waitcnt lgkmcnt(8)
    v_smfmac_f32_16x16x64_bf16 v[24:27], v[28:31], v[128:135], v11
    s_waitcnt lgkmcnt(7)
    v_smfmac_f32_16x16x64_bf16 v[24:27], v[48:51], v[120:127], v11
    s_waitcnt lgkmcnt(6)
    v_smfmac_f32_16x16x64_bf16 v[24:27], v[44:47], v[112:119], v11
    s_waitcnt lgkmcnt(0)
    v_add_f32 v16, v16, v20
    v_add_f32 v17, v17, v21
    v_add_f32 v18, v18, v22
    v_add_f32 v19, v19, v23
    ds_read_b64 v[22:23], v6 offset:14848
    v_add_f32 v52, v52, v56
    v_add_f32 v53, v53, v57
    v_add_f32 v54, v54, v58
    v_add_f32 v55, v55, v59
    v_add_f32 v20, v60, v62
    v_add_f32 v20, v20, v14
    v_add_f32 v21, v61, v63
    v_add_f32 v21, v21, v15
    v_add_f32 v16, v16, v52
    v_add_f32 v17, v17, v53
    v_add_f32 v18, v18, v54
    v_add_f32 v19, v19, v55
    ds_read_b128 v[56:59], v4 offset:15360
    ds_read_b128 v[60:63], v4 offset:15360
    s_waitcnt lgkmcnt(2)
    v_add_f32 v20, v20, v22
    v_add_f32 v21, v21, v23
    v_add_u32 v15, s41, v0
    ds_read_b128 v[36:39], v15 offset:0
    ds_read_b128 v[40:43], v15 offset:1024
    ds_read_b128 v[44:47], v15 offset:2048
    ds_read_b128 v[48:51], v15 offset:3072
    v_max3_f32 v13, v16, v17, v18
    v_max3_f32 v13, v13, v19, v20
    v_max_f32 v13, v13, v21
    v_cvt_pk_bf16_f32 v28, v24, v26
    v_cvt_pk_bf16_f32 v29, v24, v26
    v_max_f32_dpp v13, v13, v13 quad_perm:[1,0,3,2] row_mask:0xf bank_mask:0xf
    v_mov_b32 v14, v13
    v_cvt_pk_bf16_f32 v30, v24, v26
    buffer_store_dword v30, v3, s[24:27], s43 offen offset:512 sc1
    v_permlane16_swap_b32 v14, v13
    v_max_f32 v13, v13, v14
    v_mov_b32 v14, v13
    v_cvt_pk_bf16_f32 v32, v25, v27
    v_cvt_pk_bf16_f32 v33, v25, v27
    v_permlane32_swap_b32 v14, v13
    v_max_f32 v13, v13, v14
    v_mul_f32 v13, s35, v13
    v_fma_f32 v16, v16, s35, -v13
    v_fma_f32 v17, v17, s35, -v13
    v_fma_f32 v18, v18, s35, -v13
    v_fma_f32 v19, v19, s35, -v13
    v_fma_f32 v20, v20, s35, -v13
    v_fma_f32 v21, v21, s35, -v13
    v_exp_f32 v16, v16
    v_exp_f32 v17, v17
    v_exp_f32 v18, v18
    v_exp_f32 v19, v19
    v_exp_f32 v20, v20
    v_exp_f32 v21, v21
    v_add_f32 v13, v16, v17
    v_add_f32 v14, v18, v19
    v_cndmask_b32 v20, v20, 0, s[32:33]
    v_cndmask_b32 v21, v21, 0, s[32:33]
    v_add_f32 v13, v13, v20
    v_add_f32 v14, v14, v21
    v_add_f32 v13, v13, v14
    v_cvt_pk_bf16_f32 v34, v25, v27
    buffer_store_dword v34, v3, s[24:27], s43 offen offset:576 sc1
    v_add_f32_dpp v13, v13, v13 quad_perm:[1,0,3,2] row_mask:0xf bank_mask:0xf
    v_mov_b32 v14, v13
    v_permlane16_swap_b32 v28, v29
    v_permlane16_swap_b32 v32, v33
    v_permlane16_swap_b32 v14, v13
    v_add_f32 v13, v13, v14
    v_mov_b32 v14, v13
    v_cndmask_b32 v64, v64, v28, s[30:31]
    v_cndmask_b32 v65, v65, v29, s[30:31]
    v_permlane32_swap_b32 v14, v13
    v_add_f32 v13, v13, v14
    v_rcp_f32 v13, v13
    v_cndmask_b32 v72, v72, v32, s[30:31]
    v_cndmask_b32 v73, v73, v33, s[30:31]
    v_mul_f32 v16, v16, v13
    v_mul_f32 v17, v17, v13
    v_mul_f32 v18, v18, v13
    v_mul_f32 v19, v19, v13
    v_mul_f32 v20, v20, v13
    v_mul_f32 v21, v21, v13
    v_cvt_pk_bf16_f32 v52, v16, v17
    v_cvt_pk_bf16_f32 v53, v18, v19
    v_cvt_pk_bf16_f32 v54, v20, v21
    v_mov_b32 v55, 0
    s_cmp_eq_u32 s20, 63
    s_cbranch_scc1 chain_done_27
    s_waitcnt lgkmcnt(4)
    v_smfmac_f32_16x16x64_bf16 v[56:59], v[52:55], v[64:71], v11
    v_smfmac_f32_16x16x64_bf16 v[60:63], v[52:55], v[72:79], v11
    ds_read_b128 v[28:31], v15 offset:4096
    ds_read_b128 v[32:35], v15 offset:5120
    ds_read_b128 v[64:67], v15 offset:6144
    ds_read_b128 v[68:71], v15 offset:7168
    v_add_u32 v14, s74, v3
    s_nop 1
    v_add_f32 v56, v56, v57
    v_add_f32 v57, v58, v59
    v_add_f32 v60, v60, v61
    v_add_f32 v61, v62, v63
    v_cvt_pk_bf16_f32 v58, v56, v60
    v_cvt_pk_bf16_f32 v59, v57, v61
    ds_write2_b32 v14, v58, v59 offset0:0 offset1:16
    ds_read_b128 v[56:59], v4 offset:15360
    ds_read_b128 v[60:63], v4 offset:15360
    ds_read_b128 v[72:75], v4 offset:15360
    ds_read_b128 v[76:79], v4 offset:15360
    s_waitcnt lgkmcnt(4)
    s_barrier
    ds_read_b128 v[16:19], v4 offset:6144
    ds_read_b128 v[20:23], v4 offset:6656
    ds_read_b128 v[24:27], v4 offset:7168
    ds_read_b128 v[52:55], v4 offset:7680
    s_waitcnt lgkmcnt(3)
    v_smfmac_f32_16x16x64_bf16 v[56:59], v[16:19], v[36:43], v11
    ds_read_b128 v[36:39], v15 offset:32768
    ds_read_b128 v[40:43], v15 offset:33792
    s_waitcnt lgkmcnt(4)
    v_smfmac_f32_16x16x64_bf16 v[56:59], v[20:23], v[44:51], v11
    ds_read_b128 v[44:47], v15 offset:34816
    ds_read_b128 v[48:51], v15 offset:35840
    s_waitcnt lgkmcnt(5)
    v_smfmac_f32_16x16x64_bf16 v[56:59], v[24:27], v[28:35], v11
    ds_read_b128 v[28:31], v15 offset:36864
    ds_read_b128 v[32:35], v15 offset:37888
    s_waitcnt lgkmcnt(6)
    v_smfmac_f32_16x16x64_bf16 v[56:59], v[52:55], v[64:71], v11
    ds_read_b128 v[64:67], v15 offset:38912
    ds_read_b128 v[68:71], v15 offset:39936
    s_waitcnt lgkmcnt(6)
    v_smfmac_f32_16x16x64_bf16 v[60:63], v[16:19], v[36:43], v11
    v_add_u32 v15, 65536, v15
    ds_read_b128 v[36:39], v15 offset:0
    ds_read_b128 v[40:43], v15 offset:1024
    s_waitcnt lgkmcnt(6)
    v_smfmac_f32_16x16x64_bf16 v[60:63], v[20:23], v[44:51], v11
    ds_read_b128 v[44:47], v15 offset:2048
    ds_read_b128 v[48:51], v15 offset:3072
    v_cvt_pk_bf16_f32 v56, v56, v57
    v_cvt_pk_bf16_f32 v57, v58, v59
    v_and_or_b32 v56, v56, -2, s34
    buffer_store_dwordx2 v[56:57], v7, s[24:27], s64 offen sc1
    s_nop 0
    ds_read_b128 v[56:59], v4 offset:15360
    s_waitcnt lgkmcnt(7)
    v_smfmac_f32_16x16x64_bf16 v[60:63], v[24:27], v[28:35], v11
    ds_read_b128 v[28:31], v15 offset:4096
    ds_read_b128 v[32:35], v15 offset:5120
    s_waitcnt lgkmcnt(7)
    v_smfmac_f32_16x16x64_bf16 v[60:63], v[52:55], v[64:71], v11
    ds_read_b128 v[64:67], v15 offset:6144
    ds_read_b128 v[68:71], v15 offset:7168
    s_waitcnt lgkmcnt(7)
    v_smfmac_f32_16x16x64_bf16 v[72:75], v[16:19], v[36:43], v11
    ds_read_b128 v[36:39], v15 offset:32768
    ds_read_b128 v[40:43], v15 offset:33792
    s_waitcnt lgkmcnt(7)
    v_smfmac_f32_16x16x64_bf16 v[72:75], v[20:23], v[44:51], v11
    ds_read_b128 v[44:47], v15 offset:34816
    ds_read_b128 v[48:51], v15 offset:35840
    v_cvt_pk_bf16_f32 v60, v60, v61
    v_cvt_pk_bf16_f32 v61, v62, v63
    v_and_or_b32 v60, v60, -2, s34
    buffer_store_dwordx2 v[60:61], v7, s[24:27], s65 offen sc1
    s_waitcnt lgkmcnt(6)
    v_smfmac_f32_16x16x64_bf16 v[72:75], v[24:27], v[28:35], v11
    ds_read_b128 v[28:31], v15 offset:36864
    ds_read_b128 v[32:35], v15 offset:37888
    s_waitcnt lgkmcnt(6)
    v_smfmac_f32_16x16x64_bf16 v[72:75], v[52:55], v[64:71], v11
    ds_read_b128 v[64:67], v15 offset:38912
    ds_read_b128 v[68:71], v15 offset:39936
    s_waitcnt lgkmcnt(6)
    v_smfmac_f32_16x16x64_bf16 v[76:79], v[16:19], v[36:43], v11
    v_add_u32 v15, 65536, v15
    ds_read_b128 v[36:39], v15 offset:0
    ds_read_b128 v[40:43], v15 offset:1024
    s_waitcnt lgkmcnt(6)
    v_smfmac_f32_16x16x64_bf16 v[76:79], v[20:23], v[44:51], v11
    ds_read_b128 v[44:47], v15 offset:2048
    ds_read_b128 v[48:51], v15 offset:3072
    v_cvt_pk_bf16_f32 v72, v72, v73
    v_cvt_pk_bf16_f32 v73, v74, v75
    v_and_or_b32 v72, v72, -2, s34
    buffer_store_dwordx2 v[72:73], v7, s[24:27], s66 offen sc1
    s_waitcnt lgkmcnt(6)
    v_smfmac_f32_16x16x64_bf16 v[76:79], v[24:27], v[28:35], v11
    ds_read_b128 v[28:31], v15 offset:4096
    ds_read_b128 v[32:35], v15 offset:5120
    s_waitcnt lgkmcnt(6)
    v_smfmac_f32_16x16x64_bf16 v[76:79], v[52:55], v[64:71], v11
    ds_read_b128 v[64:67], v15 offset:6144
    ds_read_b128 v[68:71], v15 offset:7168
    s_nop 5
    v_cvt_pk_bf16_f32 v76, v76, v77
    v_cvt_pk_bf16_f32 v77, v78, v79
    v_and_or_b32 v76, v76, -2, s34
    buffer_store_dwordx2 v[76:77], v7, s[24:27], s67 offen sc1
    s_waitcnt lgkmcnt(0)
    s_cmp_ge_u32 s19, 2
    s_cbranch_scc1 wo_last_28_s
    v_smfmac_f32_16x16x64_bf16 v[56:59], v[16:19], v[36:43], v11
    v_smfmac_f32_16x16x64_bf16 v[56:59], v[20:23], v[44:51], v11
    v_smfmac_f32_16x16x64_bf16 v[56:59], v[24:27], v[28:35], v11
    v_smfmac_f32_16x16x64_bf16 v[56:59], v[52:55], v[64:71], v11
    s_nop 7
    v_cvt_pk_bf16_f32 v56, v56, v57
    v_cvt_pk_bf16_f32 v57, v58, v59
    v_and_or_b32 v56, v56, -2, s34
    buffer_store_dwordx2 v[56:57], v7, s[24:27], s68 offen sc1
wo_last_28_s:
    s_add_u32 s40, s40, 262144
    s_add_u32 s42, s42, 262144
    s_add_u32 s43, s43, 131072
    s_add_u32 s52, s39, s69
    s_add_u32 s53, s39, s70
    s_cmp_eq_u32 s71, 0
    s_cbranch_scc1 poll1_30_s
unit2_31_s:
    buffer_load_dwordx4 v[64:67], v0, s[24:27], s45 offen offset:0 sc1
    buffer_load_dwordx4 v[68:71], v0, s[24:27], s45 offen offset:1024 sc1
    buffer_load_dwordx4 v[28:31], v0, s[24:27], s46 offen offset:0 sc1
    buffer_load_dwordx4 v[32:35], v0, s[24:27], s46 offen offset:1024 sc1
    s_waitcnt vmcnt(2)
    v_bitop3_b32 v13, v64, v66, s34 bitop3:0x7e
    v_bitop3_b32 v14, v68, v70, s34 bitop3:0x7e
    v_bitop3_b32 v13, v13, v14, 1 bitop3:0xa8
    v_cmp_ne_u32 vcc, 0, v13
    v_lshlrev_b32 v72, 16, v64
    v_lshlrev_b32 v76, 16, v68
    v_lshlrev_b32 v73, 16, v65
    v_lshlrev_b32 v77, 16, v69
    v_lshlrev_b32 v74, 16, v66
    v_lshlrev_b32 v78, 16, v70
    v_lshlrev_b32 v75, 16, v67
    v_lshlrev_b32 v79, 16, v71
    s_mov_b64 s[56:57], vcc
    s_waitcnt vmcnt(0)
    v_bitop3_b32 v13, v28, v30, s34 bitop3:0x7e
    v_bitop3_b32 v14, v32, v34, s34 bitop3:0x7e
    v_bitop3_b32 v13, v13, v14, 1 bitop3:0xa8
    v_cmp_ne_u32 vcc, 0, v13
    v_lshlrev_b32 v36, 16, v28
    v_lshlrev_b32 v40, 16, v32
    v_lshlrev_b32 v37, 16, v29
    v_lshlrev_b32 v41, 16, v33
    v_lshlrev_b32 v38, 16, v30
    v_lshlrev_b32 v42, 16, v34
    v_lshlrev_b32 v39, 16, v31
    v_lshlrev_b32 v43, 16, v35
    s_or_b64 vcc, vcc, s[56:57]
    s_cbranch_vccnz unit2_31_s
    v_add_f32 v72, v72, v76
    v_add_f32 v73, v73, v77
    v_add_f32 v74, v74, v78
    v_add_f32 v75, v75, v79
    v_and_b32 v64, 0xffff0000, v64
    v_and_b32 v68, 0xffff0000, v68
    v_and_b32 v65, 0xffff0000, v65
    v_and_b32 v69, 0xffff0000, v69
    v_and_b32 v66, 0xffff0000, v66
    v_and_b32 v70, 0xffff0000, v70
    v_and_b32 v67, 0xffff0000, v67
    v_and_b32 v71, 0xffff0000, v71
    v_permlane32_swap_b32 v72, v74
    v_permlane32_swap_b32 v73, v75
    v_add_f32 v64, v64, v68
    v_add_f32 v65, v65, v69
    v_add_f32 v66, v66, v70
    v_add_f32 v67, v67, v71
    v_add_f32 v72, v72, v74
    v_add_f32 v73, v73, v75
    v_permlane32_swap_b32 v64, v66
    v_permlane32_swap_b32 v65, v67
    v_permlane16_swap_b32 v72, v73
    v_add_f32 v64, v64, v66
    v_add_f32 v65, v65, v67
    v_add_f32 v72, v72, v73
    s_nop 0
    v_permlane16_swap_b32 v64, v65
    v_add_f32_dpp v72, v72, v72 row_ror:8 row_mask:0xf bank_mask:0xf
    v_add_f32 v64, v64, v65
    s_nop 0
    v_add_f32_dpp v72, v72, v72 row_ror:4 row_mask:0xf bank_mask:0xf
    v_add_f32_dpp v64, v64, v64 row_ror:8 row_mask:0xf bank_mask:0xf
    s_nop 1
    v_add_f32_dpp v64, v64, v64 row_ror:4 row_mask:0xf bank_mask:0xf
    v_cvt_pk_bf16_f32 v66, v72, v64
    v_min_u32 v66, 0xfffffffe, v66
    buffer_store_dword v66, v8, s[24:27], s52 offen sc1
    v_add_f32 v36, v36, v40
    v_add_f32 v37, v37, v41
    v_add_f32 v38, v38, v42
    v_add_f32 v39, v39, v43
    s_add_u32 s54, s39, 4096
    s_add_u32 s55, s39, 8192
    buffer_load_dwordx4 v[56:59], v1, s[24:27], s39 offen sc1
    buffer_load_dwordx4 v[60:63], v1, s[24:27], s54 offen sc1
    buffer_load_dword v79, v2, s[24:27], s55 offen sc1
    v_and_b32 v28, 0xffff0000, v28
    v_and_b32 v32, 0xffff0000, v32
    v_and_b32 v29, 0xffff0000, v29
    v_and_b32 v33, 0xffff0000, v33
    v_and_b32 v30, 0xffff0000, v30
    v_and_b32 v34, 0xffff0000, v34
    v_and_b32 v31, 0xffff0000, v31
    v_and_b32 v35, 0xffff0000, v35
    v_permlane32_swap_b32 v36, v38
    v_permlane32_swap_b32 v37, v39
    v_add_f32 v28, v28, v32
    v_add_f32 v29, v29, v33
    v_add_f32 v30, v30, v34
    v_add_f32 v31, v31, v35
    v_add_f32 v36, v36, v38
    v_add_f32 v37, v37, v39
    v_permlane32_swap_b32 v28, v30
    v_permlane32_swap_b32 v29, v31
    v_permlane16_swap_b32 v36, v37
    v_add_f32 v28, v28, v30
    v_add_f32 v29, v29, v31
    v_add_f32 v36, v36, v37
    s_nop 0
    v_permlane16_swap_b32 v28, v29
    v_add_f32_dpp v36, v36, v36 row_ror:8 row_mask:0xf bank_mask:0xf
    v_add_f32 v28, v28, v29
    s_nop 0
    v_add_f32_dpp v36, v36, v36 row_ror:4 row_mask:0xf bank_mask:0xf
    v_add_f32_dpp v28, v28, v28 row_ror:8 row_mask:0xf bank_mask:0xf
    s_nop 1
    v_add_f32_dpp v28, v28, v28 row_ror:4 row_mask:0xf bank_mask:0xf
    v_cvt_pk_bf16_f32 v30, v36, v28
    v_min_u32 v30, 0xfffffffe, v30
    buffer_store_dword v30, v8, s[24:27], s53 offen sc1
    s_branch red_end_29_s
poll1_30_s:
    s_branch okA_35_s
pr_34_s:
okA_35_s:
    buffer_load_dwordx4 v[64:67], v0, s[24:27], s45 offen offset:0 sc1
    buffer_load_dwordx4 v[68:71], v0, s[24:27], s45 offen offset:1024 sc1
    s_waitcnt vmcnt(0)
    v_bitop3_b32 v13, v64, v66, s34 bitop3:0x7e
    v_bitop3_b32 v14, v68, v70, s34 bitop3:0x7e
    v_bitop3_b32 v13, v13, v14, 1 bitop3:0xa8
    v_cmp_ne_u32 vcc, 0, v13
    v_lshlrev_b32 v72, 16, v64
    v_lshlrev_b32 v76, 16, v68
    v_lshlrev_b32 v73, 16, v65
    v_lshlrev_b32 v77, 16, v69
    v_lshlrev_b32 v74, 16, v66
    v_lshlrev_b32 v78, 16, v70
    v_lshlrev_b32 v75, 16, v67
    v_lshlrev_b32 v79, 16, v71
    s_cbranch_vccnz pr_34_s
    v_add_f32 v72, v72, v76
    v_add_f32 v73, v73, v77
    v_add_f32 v74, v74, v78
    v_add_f32 v75, v75, v79
    s_add_u32 s54, s39, 4096
    s_add_u32 s55, s39, 8192
    buffer_load_dwordx4 v[56:59], v1, s[24:27], s39 offen sc1
    buffer_load_dwordx4 v[60:63], v1, s[24:27], s54 offen sc1
    buffer_load_dword v79, v2, s[24:27], s55 offen sc1
    v_and_b32 v64, 0xffff0000, v64
    v_and_b32 v68, 0xffff0000, v68
    v_and_b32 v65, 0xffff0000, v65
    v_and_b32 v69, 0xffff0000, v69
    v_and_b32 v66, 0xffff0000, v66
    v_and_b32 v70, 0xffff0000, v70
    v_and_b32 v67, 0xffff0000, v67
    v_and_b32 v71, 0xffff0000, v71
    v_permlane32_swap_b32 v72, v74
    v_permlane32_swap_b32 v73, v75
    v_add_f32 v64, v64, v68
    v_add_f32 v65, v65, v69
    v_add_f32 v66, v66, v70
    v_add_f32 v67, v67, v71
    v_add_f32 v72, v72, v74
    v_add_f32 v73, v73, v75
    v_permlane32_swap_b32 v64, v66
    v_permlane32_swap_b32 v65, v67
    v_permlane16_swap_b32 v72, v73
    v_add_f32 v64, v64, v66
    v_add_f32 v65, v65, v67
    v_add_f32 v72, v72, v73
    s_nop 0
    v_permlane16_swap_b32 v64, v65
    v_add_f32_dpp v72, v72, v72 row_ror:8 row_mask:0xf bank_mask:0xf
    v_add_f32 v64, v64, v65
    s_nop 0
    v_add_f32_dpp v72, v72, v72 row_ror:4 row_mask:0xf bank_mask:0xf
    v_add_f32_dpp v64, v64, v64 row_ror:8 row_mask:0xf bank_mask:0xf
    s_nop 1
    v_add_f32_dpp v64, v64, v64 row_ror:4 row_mask:0xf bank_mask:0xf
    v_cvt_pk_bf16_f32 v66, v72, v64
    v_min_u32 v66, 0xfffffffe, v66
    buffer_store_dword v66, v8, s[24:27], s52 offen sc1
    s_branch red_end_29_s
red_end_29_s:
nd_37_s:
    s_add_u32 s36, s36, 9216
    s_add_u32 s37, s37, 9216
    s_add_u32 s38, s38, 9216
    s_add_u32 s39, s39, 9216
    s_xor_b32 s34, s34, 1
    s_add_u32 s20, s20, 1
    s_waitcnt lgkmcnt(0)
    s_branch step_18_s
chain_done_27:
    s_waitcnt vmcnt(0)
    s_barrier
    s_cmp_lg_u32 s19, 0
    s_cbranch_scc1 sg_38
    s_lshl_b32 s57, s20, 7
    s_add_u32 s57, s57, 61874176
    v_mov_b32 v13, 0
    v_mov_b32 v14, 1
    s_mov_b64 exec, 1
    buffer_atomic_add v14, v13, s[24:27], s57 offen
    s_mov_b64 exec, -1
sg_38:
    s_waitcnt vmcnt(0)
    s_endpgm
L_wexit:
L_exit:
    s_endpgm
.section .rodata,"a"
.p2align 6
.amdhsa_kernel mega_kernel
  .amdhsa_next_free_vgpr 512
  .amdhsa_next_free_sgpr 102
  .amdhsa_accum_offset 256
  .amdhsa_group_segment_fixed_size 0
  .amdhsa_kernarg_size 160
  .amdhsa_user_sgpr_count 2
  .amdhsa_user_sgpr_kernarg_segment_ptr 1
  .amdhsa_system_sgpr_workgroup_id_x 1
.end_amdhsa_kernel
```
